```python
import torch

def _softmax(x, axis=-1):
    return torch.softmax(x, dim=axis)
def _gelu(x):
    return torch.nn.functional.gelu(x, approximate="tanh")
def _silu(x):
    return torch.nn.functional.silu(x)
def _sigmoid(x):
    return torch.sigmoid(x)
def _layernorm(x, axis=-1, eps=1e-5):
    m = x.mean(dim=axis, keepdim=True)
    v = x.var(dim=axis, keepdim=True, unbiased=False)
    return (x - m) / torch.sqrt(v + eps)
def _scatter_add(tgt, idx, src, axis=0):
    return tgt.clone().index_add_(axis, idx, src)
def _segment_sum(src, seg, n):
    out = torch.zeros((n,) + src.shape[1:], dtype=src.dtype)
    return out.index_add_(0, seg, src)
def _pad(x, pw):
    flat = tuple(v for pair in reversed(pw) for v in pair)
    return torch.nn.functional.pad(x, flat)

kernel_name = 'parallel_sum__spectral_gfnet__glu_gated_geglu__prompt'

def setup_inputs():

    _w = (lambda a: (lambda t: t.to(torch.bfloat16) if t.is_floating_point() else t)(torch.as_tensor(a)))
    def _A_setup():
        B, S, D = 1, 2048, 1024
        Df = D // 2 + 1
        return {
            "x": _w((lambda *s: torch.randn(*s, dtype=torch.bfloat16) * 0.05)(B, S, D)),
            "w_r": _w((lambda *s: torch.randn(*s, dtype=torch.bfloat16) * 0.8)(S, Df) * 0.02),
            "w_i": _w((lambda *s: torch.randn(*s, dtype=torch.bfloat16) * 0.8)(S, Df) * 0.02),
        }
    _A_in = _A_setup()

    def _B_setup():
        B, S, Dm, Df = 1, 2048, 1024, 3584
        return {
            "x": _w((lambda *s: torch.randn(*s, dtype=torch.bfloat16) * 0.05)(B, S, Dm)),
            "w_gate": _w((lambda *s: torch.randn(*s, dtype=torch.bfloat16) * 0.4)(Dm, Df) * (Dm ** -0.5)),
            "w_up": _w((lambda *s: torch.randn(*s, dtype=torch.bfloat16) * 0.4)(Dm, Df) * (Dm ** -0.5)),
            "w_down": _w((lambda *s: torch.randn(*s, dtype=torch.bfloat16) * 0.4)(Df, Dm) * (Df ** -0.5)),
        }
    _B_in = _B_setup()

    return {
        "A_x": _A_in["x"],
        "A_w_r": _A_in["w_r"],
        "A_w_i": _A_in["w_i"],
        "B_x": _B_in["x"],
        "B_w_gate": _B_in["w_gate"],
        "B_w_up": _B_in["w_up"],
        "B_w_down": _B_in["w_down"],
    }

def reference(A_x, A_w_r, A_w_i, B_x, B_w_gate, B_w_up, B_w_down):
    def _A_ref(x, w_r, w_i):
        B, S, D = x.shape
        X = (lambda x, axes=(-2,-1): torch.fft.rfft2(x.float(), dim=axes))(x, axes=(-2, -1))
        W = w_r + 1j * w_i
        X = X * W
        y = (lambda x, s, axes=(-2,-1): torch.fft.irfft2(x, s=s, dim=axes).to(torch.bfloat16))(X, (S, D), axes=(-2, -1))
        return y

    def _B_ref(x, w_gate, w_up, w_down):
        g = torch.einsum("bsd,df->bsf", x, w_gate)
        u = torch.einsum("bsd,df->bsf", x, w_up)
        h = _gelu(g) * u
        return torch.einsum("bsf,fd->bsd", h, w_down)

    x = A_x
    xn = _layernorm(x, axis=-1)
    return x + _A_ref(xn, A_w_r, A_w_i) + _B_ref(xn, B_w_gate, B_w_up, B_w_down)
```

```asm
; @launch grid=(256,1,1) block=(512,1,1) lds=163840
.amdgcn_target "amdgcn-amd-amdhsa--gfx950"
.text
.globl parallel_sum__spectral_gfnet__glu_gated_geglu__prompt_kernel
.p2align 8
.type parallel_sum__spectral_gfnet__glu_gated_geglu__prompt_kernel,@function
parallel_sum__spectral_gfnet__glu_gated_geglu__prompt_kernel:
    s_load_dwordx2 s[94:95], s[0:1], 0
    s_load_dwordx4 s[48:51], s[0:1], 64
    s_load_dwordx4 s[4:7], s[0:1], 32
    s_load_dwordx4 s[88:91], s[0:1], 8
    s_load_dwordx2 s[92:93], s[0:1], 48
    s_cmp_ge_u32 s2, 256
    s_cbranch_scc1 ka_done_1
    v_lshrrev_b32 v2, 6, v0
    v_and_b32 v1, 63, v0
    s_and_b32 s55, s2, 7
    v_readfirstlane_b32 s30, v2
    s_lshr_b32 s54, s2, 3
    v_lshlrev_b32 v2, 4, v1
    v_mov_b32 v229, v1
    s_lshl_b32 s81, s55, 5
    s_add_u32 s81, s81, s54
    s_lshr_b32 s26, s55, 2
    s_lshl_b32 s26, s26, 5
    s_add_u32 s82, s54, s26
    s_and_b32 s26, s55, 2
    s_lshl_b32 s26, s26, 1
    s_and_b32 s27, s55, 1
    s_add_u32 s83, s26, s27
    s_lshr_b32 s26, s30, 2
    s_lshl_b32 s26, s26, 1
    s_add_u32 s26, s26, s83
    s_lshl_b32 s80, s26, 8
    s_and_b32 s32, s30, 3
    s_lshl_b32 s26, s32, 6
    s_add_u32 s80, s80, s26
    s_add_u32 s80, s80, s82
    s_lshl_b32 s26, s80, 11
    s_and_b32 s37, s55, 1
    s_lshl_b32 s37, s37, 2
    s_and_b32 s28, s54, 3
    s_add_u32 s37, s37, s28
    s_lshr_b32 s38, s55, 1
    s_mul_i32 s38, s38, 7
    s_lshr_b32 s28, s54, 2
    s_add_u32 s38, s38, s28
    s_and_b32 s56, s55, 1
    s_lshl_b32 s56, s56, 4
    s_waitcnt lgkmcnt(0)
    s_mov_b32 s72, s94
    s_mov_b32 s73, s95
    s_and_b32 s73, s73, 0xffff
    s_mov_b32 s74, 0x400000
    s_mov_b32 s75, 0x20000
    buffer_load_dwordx4 v[4:7], v2, s[72:75], s26 offen
    buffer_load_dwordx4 v[8:11], v2, s[72:75], s26 offen offset:1024
    s_mov_b64 s[24:25], s[50:51]
    s_add_u32 s52, s24, 0x3d00000
    s_addc_u32 s53, s25, 0
    s_lshl_b32 s26, s2, 3
    s_add_u32 s26, s26, s30
    s_cmp_eq_u32 s26, 3
    s_cselect_b32 s62, 1, 0
    s_cbranch_scc0 ka_notag_5
    s_memrealtime s[50:51]
    s_waitcnt lgkmcnt(0)
    s_or_b32 s51, s51, 0x80000000
    s_mov_b32 s26, 64
    v_mov_b32 v12, s50
    v_mov_b32 v13, s51
    v_mov_b32 v14, s26
    s_mov_b64 exec, 1
    global_store_dwordx2 v14, v[12:13], s[48:49] sc1
    s_mov_b64 exec, -1
ka_notag_5:
    s_and_b32 s26, s2, 63
    s_lshl_b32 s26, s26, 3
    s_add_u32 s26, s26, s30
    s_bfe_u32 s27, s26, 0x20006
    s_lshl_b32 s27, s27, 4
    s_bfe_u32 s28, s26, 0x10005
    s_lshl_b32 s28, s28, 2
    s_add_u32 s27, s27, s28
    s_lshl_b32 s27, s27, 5
    s_and_b32 s28, s26, 31
    s_add_u32 s27, s27, s28
    s_mul_i32 s27, s27, 1026
    s_lshr_b32 s28, s2, 6
    s_lshl_b32 s28, s28, 8
    s_add_u32 s28, s28, s27
    s_add_u32 s29, s28, 262656
    s_bitcmp1_b32 s2, 5
    s_cselect_b32 s88, s90, s88
    s_cselect_b32 s89, s91, s89
    s_mov_b32 s76, s88
    s_mov_b32 s77, s89
    s_and_b32 s77, s77, 0xffff
    s_mov_b32 s78, 0x201000
    s_mov_b32 s79, 0x20000
    v_lshrrev_b32 v192, 4, v1
    v_mul_u32_u24 v192, 32832, v192
    v_and_b32 v193, 15, v1
    v_lshl_add_u32 v192, v193, 4, v192
    buffer_load_dwordx4 v[128:131], v192, s[76:79], s28 offen
    buffer_load_dwordx4 v[132:135], v192, s[76:79], s29 offen
    v_and_b32 v192, 3, v1
    v_bfe_u32 v193, v1, 2, 1
    v_lshl_add_u32 v192, v193, 3, v192
    v_lshrrev_b32 v193, 3, v1
    v_lshl_add_u32 v192, v192, 5, v193
    v_mul_u32_u24 v192, 1026, v192
    v_lshlrev_b32 v195, 1, v1
    s_sub_u32 s27, s27, 3080
    s_cmp_ge_u32 s2, 192
    s_cselect_b32 s27, s27, 0x40000000
    s_cmp_eq_u32 s30, 4
    s_cselect_b32 s27, s27, 0x40000000
    buffer_load_ushort v194, v192, s[76:79], s27 offen
    s_bitcmp1_b32 s30, 1
    s_cselect_b32 s4, s6, s4
    s_cselect_b32 s5, s7, s5
    s_mov_b32 s12, s4
    s_mov_b32 s13, s5
    s_and_b32 s13, s13, 0xffff
    s_mov_b32 s14, 0x700000
    s_mov_b32 s15, 0x20000
    v_lshrrev_b32 v239, 4, v1
    v_and_b32 v241, 15, v1
    v_lshlrev_b32 v240, 1, v239
    v_xor_b32 v241, v241, v240
    v_mul_u32_u24 v239, 7168, v239
    v_lshl_add_u32 v224, v241, 4, v239
    v_xor_b32 v240, 128, v224
    v_add_u32 v225, 27648, v224
    v_add_u32 v226, 55296, v240
    v_add_u32 v227, 82944, v240
    s_and_b32 s36, s30, 1
    s_mul_i32 s36, s36, 114688
    s_lshl_b32 s26, s38, 8
    s_add_u32 s59, s36, s26
    s_add_u32 s57, s59, 7340032
    s_mul_i32 s26, s56, 229376
    s_add_u32 s36, s59, s26
    s_lshl_b32 s33, s30, 12
    s_add_u32 s34, s33, 16384
    s_cmp_lt_u32 s54, 28
    s_cselect_b32 s84, 1, 0
    s_cmp_lt_u32 s30, 4
    s_cselect_b32 s84, s84, 0
    v_and_b32 v12, 31, v1
    v_add_u32 v20, 65536, v2
    s_xor_b32 s29, s30, 4
    s_cmp_ge_u32 s29, 6
    s_cbranch_scc1 ka_jend_7
    s_lshr_b32 s26, s29, 1
    s_cmp_eq_u32 s26, 1
    s_cselect_b32 s27, 15, 31
    s_mov_b32 s28, 0xbd000000
    s_cselect_b32 s28, 0x3d000000, s28
    s_cselect_b32 s85, 0x3e800000, 0
    v_and_b32 v13, s27, v1
    v_bfe_u32 v15, v1, 4, 1
    v_cvt_f32_u32 v15, v15
    v_mul_f32 v15, s85, v15
    s_cmp_eq_u32 s26, 2
    s_cselect_b32 s27, 1023, 31
    s_cselect_b32 s28, 0xba800000, s28
    s_and_b32 s85, s29, 1
    s_lshl_b32 s86, s85, 4
    v_lshrrev_b32 v14, 5, v1
    v_lshl_add_u32 v14, v14, 2, s86
    v_mul_u32_u24 v14, v14, v13
    v_mad_u32_u24 v64, 0, v13, v14
    v_mad_u32_u24 v65, 1, v13, v14
    v_mad_u32_u24 v66, 2, v13, v14
    v_mad_u32_u24 v67, 3, v13, v14
    v_mad_u32_u24 v68, 8, v13, v14
    v_mad_u32_u24 v69, 9, v13, v14
    v_mad_u32_u24 v70, 10, v13, v14
    v_mad_u32_u24 v71, 11, v13, v14
    v_and_b32 v64, s27, v64
    v_and_b32 v65, s27, v65
    v_and_b32 v66, s27, v66
    v_and_b32 v67, s27, v67
    v_and_b32 v68, s27, v68
    v_and_b32 v69, s27, v69
    v_and_b32 v70, s27, v70
    v_and_b32 v71, s27, v71
    v_cvt_f32_u32 v64, v64
    v_cvt_f32_u32 v65, v65
    v_cvt_f32_u32 v66, v66
    v_cvt_f32_u32 v67, v67
    v_cvt_f32_u32 v68, v68
    v_cvt_f32_u32 v69, v69
    v_cvt_f32_u32 v70, v70
    v_cvt_f32_u32 v71, v71
    v_fma_f32 v64, v64, s28, v15
    v_fma_f32 v65, v65, s28, v15
    v_fma_f32 v66, v66, s28, v15
    v_fma_f32 v67, v67, s28, v15
    v_fma_f32 v68, v68, s28, v15
    v_fma_f32 v69, v69, s28, v15
    v_fma_f32 v70, v70, s28, v15
    v_fma_f32 v71, v71, s28, v15
    v_cos_f32 v72, v64
    v_cos_f32 v73, v65
    v_cos_f32 v74, v66
    v_cos_f32 v75, v67
    v_cos_f32 v76, v68
    v_cos_f32 v77, v69
    v_cos_f32 v78, v70
    v_cos_f32 v79, v71
    v_sin_f32 v80, v64
    v_sin_f32 v81, v65
    v_sin_f32 v82, v66
    v_sin_f32 v83, v67
    v_sin_f32 v84, v68
    v_sin_f32 v85, v69
    v_sin_f32 v86, v70
    v_sin_f32 v87, v71
    s_cmp_eq_u32 s26, 2
    s_cbranch_scc1 ka_jtw_8
    s_lshl_b32 s26, s26, 12
    s_lshl_b32 s85, s85, 10
    s_add_u32 s26, s26, s85
    v_add_u32 v14, s26, v20
    v_cvt_pk_bf16_f32 v88, v72, v73
    v_cvt_pk_bf16_f32 v89, v74, v75
    v_cvt_pk_bf16_f32 v90, v76, v77
    v_cvt_pk_bf16_f32 v91, v78, v79
    v_cvt_pk_bf16_f32 v92, v80, v81
    v_cvt_pk_bf16_f32 v93, v82, v83
    v_cvt_pk_bf16_f32 v94, v84, v85
    v_cvt_pk_bf16_f32 v95, v86, v87
    ds_write_b128 v14, v[88:91]
    ds_write_b128 v14, v[92:95] offset:2048
    s_branch ka_jend_7
ka_jtw_8:
    s_lshl_b32 s85, s85, 11
    v_add_u32 v14, s85, v20
    ds_write_b128 v14, v[72:75] offset:8192
    ds_write_b128 v14, v[80:83] offset:12288
    ds_write_b128 v14, v[76:79] offset:9216
    ds_write_b128 v14, v[84:87] offset:13312
ka_jend_7:
    s_lshl_b32 s26, s30, 11
    s_add_u32 s26, s26, 98304
    s_lshl_b32 s27, s32, 6
    v_xor_b32 v21, s27, v2
    v_add_u32 v21, s26, v21
    v_lshrrev_b32 v17, 5, v1
    v_lshlrev_b32 v23, 11, v17
    v_lshlrev_b32 v17, 8, v17
    v_bfe_u32 v18, v1, 2, 2
    v_lshl_add_u32 v17, v18, 6, v17
    v_and_b32 v18, 16, v1
    v_lshl_add_u32 v17, v18, 1, v17
    v_and_b32 v19, 3, v1
    v_lshl_add_u32 v17, v19, 3, v17
    v_xor_b32 v17, s27, v17
    v_add_u32 v22, s26, v17
    v_lshl_add_u32 v23, v12, 4, v23
    s_lshl_b32 s26, s30, 1
    s_add_u32 s26, s26, 131072
    v_add_u32 v23, s26, v23
    v_cmp_eq_u32 s[96:97], 0, v1
    v_mov_b32 v24, 1.0
    s_add_u32 s8, s24, 0x10000
    s_addc_u32 s9, s25, 0
    s_and_b32 s9, s9, 0xffff
    s_mov_b32 s10, 0x400000
    s_mov_b32 s11, 0x20000
    v_cndmask_b32 v24, v24, 0.5, s[96:97]
    s_cmp_lg_u32 s30, 2
    s_cbranch_scc1 ka_tlbw_9
    v_min_u32 v220, 34, v1
    v_lshlrev_b32 v220, 21, v220
    v_add_u32 v220, 0x1000, v220
    global_load_dword v221, v220, s[24:25] sc1
ka_tlbw_9:
    v_mov_b32 v218, 64
    global_load_dwordx2 v[216:217], v218, s[48:49] sc1
    s_cmp_eq_u32 s84, 0
    s_cbranch_scc1 ka_nodma_6
    s_add_u32 m0, s34, 0x0
    s_nop 0
    buffer_load_dwordx4 v224, s[12:15], s36 offen offset:0  lds
    buffer_load_dwordx4 v225, s[12:15], s36 offen offset:1024  lds
    buffer_load_dwordx4 v226, s[12:15], s36 offen offset:2048  lds
    buffer_load_dwordx4 v227, s[12:15], s36 offen offset:3072  lds
    s_add_u32 s36, s36, 229376
    s_cmp_eq_u32 s36, s57
    s_cselect_b32 s36, s59, s36
    s_add_u32 m0, s34, 0x8000
    s_nop 0
    buffer_load_dwordx4 v224, s[12:15], s36 offen offset:0  lds
    buffer_load_dwordx4 v225, s[12:15], s36 offen offset:1024  lds
    buffer_load_dwordx4 v226, s[12:15], s36 offen offset:2048  lds
    buffer_load_dwordx4 v227, s[12:15], s36 offen offset:3072  lds
    s_add_u32 s36, s36, 229376
    s_cmp_eq_u32 s36, s57
    s_cselect_b32 s36, s59, s36
    s_waitcnt vmcnt(12)
    s_branch ka_wd_10
ka_nodma_6:
    s_waitcnt vmcnt(4)
ka_wd_10:
    v_lshlrev_b32 v32, 16, v4
    v_and_b32 v33, 0xffff0000, v4
    v_lshlrev_b32 v34, 16, v5
    v_and_b32 v35, 0xffff0000, v5
    v_lshlrev_b32 v36, 16, v6
    v_and_b32 v37, 0xffff0000, v6
    v_lshlrev_b32 v38, 16, v7
    v_and_b32 v39, 0xffff0000, v7
    v_lshlrev_b32 v40, 16, v8
    v_and_b32 v41, 0xffff0000, v8
    v_lshlrev_b32 v42, 16, v9
    v_and_b32 v43, 0xffff0000, v9
    v_lshlrev_b32 v44, 16, v10
    v_and_b32 v45, 0xffff0000, v10
    v_lshlrev_b32 v46, 16, v11
    v_and_b32 v47, 0xffff0000, v11
    v_readfirstlane_b32 s29, v32
    s_nop 1
    v_subrev_f32 v48, s29, v32
    v_subrev_f32 v49, s29, v33
    v_subrev_f32 v50, s29, v34
    v_subrev_f32 v51, s29, v35
    v_subrev_f32 v52, s29, v36
    v_subrev_f32 v53, s29, v37
    v_subrev_f32 v54, s29, v38
    v_subrev_f32 v55, s29, v39
    v_subrev_f32 v56, s29, v40
    v_subrev_f32 v57, s29, v41
    v_subrev_f32 v58, s29, v42
    v_subrev_f32 v59, s29, v43
    v_subrev_f32 v60, s29, v44
    v_subrev_f32 v61, s29, v45
    v_subrev_f32 v62, s29, v46
    v_subrev_f32 v63, s29, v47
    v_add_f32 v25, v48, v49
    v_mul_f32 v26, v48, v48
    v_add_f32 v27, v50, v51
    v_mul_f32 v28, v49, v49
    v_fmac_f32 v26, v50, v50
    v_fmac_f32 v28, v51, v51
    v_add_f32 v25, v25, v52
    v_add_f32 v27, v27, v53
    v_fmac_f32 v26, v52, v52
    v_fmac_f32 v28, v53, v53
    v_add_f32 v25, v25, v54
    v_add_f32 v27, v27, v55
    v_fmac_f32 v26, v54, v54
    v_fmac_f32 v28, v55, v55
    v_add_f32 v25, v25, v56
    v_add_f32 v27, v27, v57
    v_fmac_f32 v26, v56, v56
    v_fmac_f32 v28, v57, v57
    v_add_f32 v25, v25, v58
    v_add_f32 v27, v27, v59
    v_fmac_f32 v26, v58, v58
    v_fmac_f32 v28, v59, v59
    v_add_f32 v25, v25, v60
    v_add_f32 v27, v27, v61
    v_fmac_f32 v26, v60, v60
    v_fmac_f32 v28, v61, v61
    v_add_f32 v25, v25, v62
    v_add_f32 v27, v27, v63
    v_fmac_f32 v26, v62, v62
    v_fmac_f32 v28, v63, v63
    v_add_f32 v25, v25, v27
    v_add_f32 v26, v26, v28
    s_nop 1
    v_add_f32_dpp v25, v25, v25 quad_perm:[1,0,3,2] row_mask:0xf bank_mask:0xf
    v_add_f32_dpp v26, v26, v26 quad_perm:[1,0,3,2] row_mask:0xf bank_mask:0xf
    s_nop 1
    v_add_f32_dpp v25, v25, v25 quad_perm:[2,3,0,1] row_mask:0xf bank_mask:0xf
    v_add_f32_dpp v26, v26, v26 quad_perm:[2,3,0,1] row_mask:0xf bank_mask:0xf
    s_nop 1
    v_add_f32_dpp v25, v25, v25 row_half_mirror row_mask:0xf bank_mask:0xf
    v_add_f32_dpp v26, v26, v26 row_half_mirror row_mask:0xf bank_mask:0xf
    s_nop 1
    v_add_f32_dpp v25, v25, v25 row_mirror row_mask:0xf bank_mask:0xf
    v_add_f32_dpp v26, v26, v26 row_mirror row_mask:0xf bank_mask:0xf
    s_nop 1
    v_mov_b32 v27, v25
    v_mov_b32 v28, v26
    s_nop 1
    v_permlane16_swap_b32 v25, v27
    v_permlane16_swap_b32 v26, v28
    s_nop 1
    v_add_f32 v25, v25, v27
    v_add_f32 v26, v26, v28
    v_mov_b32 v27, v25
    v_mov_b32 v28, v26
    s_nop 1
    v_permlane32_swap_b32 v25, v27
    v_permlane32_swap_b32 v26, v28
    s_nop 1
    v_add_f32 v25, v25, v27
    v_add_f32 v26, v26, v28
    v_mul_f32 v29, 0x3a800000, v25
    v_mul_f32 v30, 0x3a800000, v26
    v_fma_f32 v30, -v29, v29, v30
    v_add_f32 v29, s29, v29
    v_max_f32 v30, 0, v30
    v_cvt_pk_bf16_f32 v30, v30, v30
    v_and_b32 v30, 0xffff0000, v30
    v_cvt_pk_bf16_f32 v29, v29, v29
    v_and_b32 v29, 0xffff0000, v29
    v_add_f32 v30, 0x3727c5ac, v30
    v_cvt_pk_bf16_f32 v30, v30, v30
    v_and_b32 v30, 0xffff0000, v30
    v_sqrt_f32 v30, v30
    v_sub_f32 v48, v32, v29
    v_sub_f32 v49, v33, v29
    v_sub_f32 v50, v34, v29
    v_sub_f32 v51, v35, v29
    v_sub_f32 v52, v36, v29
    v_sub_f32 v53, v37, v29
    v_sub_f32 v54, v38, v29
    v_sub_f32 v55, v39, v29
    v_sub_f32 v56, v40, v29
    v_sub_f32 v57, v41, v29
    v_sub_f32 v58, v42, v29
    v_sub_f32 v59, v43, v29
    v_sub_f32 v60, v44, v29
    v_sub_f32 v61, v45, v29
    v_sub_f32 v62, v46, v29
    v_sub_f32 v63, v47, v29
    v_cvt_pk_bf16_f32 v30, v30, v30
    v_and_b32 v30, 0xffff0000, v30
    v_rcp_f32 v30, v30
    v_cvt_pk_bf16_f32 v4, v48, v49
    v_cvt_pk_bf16_f32 v5, v50, v51
    v_cvt_pk_bf16_f32 v6, v52, v53
    v_cvt_pk_bf16_f32 v7, v54, v55
    v_cvt_pk_bf16_f32 v8, v56, v57
    v_cvt_pk_bf16_f32 v9, v58, v59
    v_cvt_pk_bf16_f32 v10, v60, v61
    v_cvt_pk_bf16_f32 v11, v62, v63
    v_lshlrev_b32 v48, 16, v4
    v_and_b32 v49, 0xffff0000, v4
    v_lshlrev_b32 v50, 16, v5
    v_and_b32 v51, 0xffff0000, v5
    v_lshlrev_b32 v52, 16, v6
    v_and_b32 v53, 0xffff0000, v6
    v_lshlrev_b32 v54, 16, v7
    v_and_b32 v55, 0xffff0000, v7
    v_lshlrev_b32 v56, 16, v8
    v_and_b32 v57, 0xffff0000, v8
    v_lshlrev_b32 v58, 16, v9
    v_and_b32 v59, 0xffff0000, v9
    v_lshlrev_b32 v60, 16, v10
    v_and_b32 v61, 0xffff0000, v10
    v_lshlrev_b32 v62, 16, v11
    v_and_b32 v63, 0xffff0000, v11
    v_mul_f32 v48, v48, v30
    v_mul_f32 v49, v49, v30
    v_mul_f32 v50, v50, v30
    v_mul_f32 v51, v51, v30
    v_mul_f32 v52, v52, v30
    v_mul_f32 v53, v53, v30
    v_mul_f32 v54, v54, v30
    v_mul_f32 v55, v55, v30
    v_mul_f32 v56, v56, v30
    v_mul_f32 v57, v57, v30
    v_mul_f32 v58, v58, v30
    v_mul_f32 v59, v59, v30
    v_mul_f32 v60, v60, v30
    v_mul_f32 v61, v61, v30
    v_mul_f32 v62, v62, v30
    v_mul_f32 v63, v63, v30
    v_cvt_pk_bf16_f32 v4, v48, v49
    v_cvt_pk_bf16_f32 v5, v50, v51
    v_cvt_pk_bf16_f32 v6, v52, v53
    v_cvt_pk_bf16_f32 v7, v54, v55
    v_cvt_pk_bf16_f32 v8, v56, v57
    v_cvt_pk_bf16_f32 v9, v58, v59
    v_cvt_pk_bf16_f32 v10, v60, v61
    v_cvt_pk_bf16_f32 v11, v62, v63
    ds_write_b128 v21, v[4:7]
    ds_write_b128 v21, v[8:11] offset:1024
    s_cmp_eq_u32 s84, 0
    s_cbranch_scc1 ka_w1_11
    s_waitcnt vmcnt(9)
    s_branch ka_w2_12
ka_w1_11:
    s_waitcnt vmcnt(1)
ka_w2_12:
    s_lshl_b32 s26, s30, 11
    s_add_u32 s26, s26, 131072
    v_add_u32 v136, s26, v2
    ds_write_b128 v136, v[128:131]
    ds_write_b128 v136, v[132:135] offset:1024
    v_bfe_u32 v137, v1, 2, 2
    v_lshlrev_b32 v137, 8, v137
    v_lshrrev_b32 v138, 4, v1
    v_lshl_add_u32 v137, v138, 5, v137
    v_and_b32 v138, 3, v1
    v_lshl_add_u32 v137, v138, 3, v137
    v_add_u32 v137, s26, v137
    v_and_b32 v138, 7, v1
    v_xor_b32 v138, s30, v138
    v_lshlrev_b32 v138, 4, v138
    v_lshl_add_u32 v138, v1, 7, v138
    v_add_u32 v138, 147456, v138
    s_waitcnt lgkmcnt(0)
    ds_read_b64_tr_b16 v[140:141], v137 offset:0
    ds_read_b64_tr_b16 v[142:143], v137 offset:1024
    ds_read_b64_tr_b16 v[144:145], v137 offset:128
    ds_read_b64_tr_b16 v[146:147], v137 offset:1152
    s_waitcnt lgkmcnt(0)
    ds_write_b128 v138, v[140:143] offset:0
    ds_write_b128 v138, v[144:147] offset:8192
    s_waitcnt lgkmcnt(0)
    s_barrier
    s_cmp_lt_u32 s30, 4
    s_cbranch_scc1 ka_nco_13
    s_setprio 2
    v_and_b32 v212, 255, v0
    v_bfe_u32 v213, v0, 2, 2
    v_lshrrev_b32 v214, 4, v212
    v_xor_b32 v215, v214, v213
    v_lshlrev_b32 v215, 6, v215
    v_lshl_add_u32 v215, v213, 11, v215
    s_and_b32 s26, s82, 2
    v_and_b32 v213, 3, v0
    v_xor_b32 v213, s26, v213
    v_lshl_add_u32 v215, v213, 4, v215
    v_add_u32 v215, 98304, v215
    ds_read_b128 v[196:199], v215 offset:0
    ds_read_b128 v[200:203], v215 offset:1024
    ds_read_b128 v[204:207], v215 offset:8192
    ds_read_b128 v[208:211], v215 offset:9216
    v_and_b32 v213, 15, v0
    v_lshlrev_b32 v213, 4, v213
    v_lshl_add_u32 v213, v214, 14, v213
    s_lshl_b32 s26, s83, 19
    s_lshl_b32 s27, s82, 8
    s_add_u32 s26, s26, s27
    s_add_u32 s27, s26, 0
    s_waitcnt lgkmcnt(3)
    buffer_store_dwordx4 v[196:199], v213, s[8:11], s27 offen sc1
    s_add_u32 s27, s26, 262144
    s_waitcnt lgkmcnt(2)
    buffer_store_dwordx4 v[200:203], v213, s[8:11], s27 offen sc1
    s_add_u32 s27, s26, 1048576
    s_waitcnt lgkmcnt(1)
    buffer_store_dwordx4 v[204:207], v213, s[8:11], s27 offen sc1
    s_add_u32 s27, s26, 1310720
    s_waitcnt lgkmcnt(0)
    buffer_store_dwordx4 v[208:211], v213, s[8:11], s27 offen sc1
ka_nco_13:
    ds_read_b64_tr_b16 v[12:13], v22 offset:0
    ds_read_b64_tr_b16 v[14:15], v22 offset:512
    ds_read_b64_tr_b16 v[16:17], v22 offset:1024
    ds_read_b64_tr_b16 v[18:19], v22 offset:1536
    ds_read_b128 v[64:67], v20 offset:0
    ds_read_b128 v[68:71], v20 offset:1024
    ds_read_b128 v[72:75], v20 offset:2048
    ds_read_b128 v[76:79], v20 offset:3072
    ds_read_b128 v[80:83], v20 offset:4096
    ds_read_b128 v[84:87], v20 offset:5120
    ds_read_b128 v[88:91], v20 offset:6144
    ds_read_b128 v[92:95], v20 offset:7168
    ds_read_b128 v[96:99], v20 offset:8192
    ds_read_b128 v[100:103], v20 offset:9216
    ds_read_b128 v[104:107], v20 offset:10240
    ds_read_b128 v[108:111], v20 offset:11264
    ds_read_b128 v[112:115], v20 offset:12288
    ds_read_b128 v[116:119], v20 offset:13312
    ds_read_b128 v[120:123], v20 offset:14336
    ds_read_b128 v[124:127], v20 offset:15360
    s_waitcnt lgkmcnt(12)
    v_mfma_f32_32x32x16_bf16 v[32:47], v[12:15], v[64:67], 0
    v_mfma_f32_32x32x16_bf16 v[48:63], v[12:15], v[72:75], 0
    v_mfma_f32_32x32x16_bf16 v[32:47], v[16:19], v[68:71], v[32:47]
    v_mfma_f32_32x32x16_bf16 v[48:63], v[16:19], v[76:79], v[48:63]
    s_add_u32 s72, s24, 0x1800000
    s_addc_u32 s73, s25, 0
    s_and_b32 s73, s73, 0xffff
    s_mov_b32 s74, 0x400000
    s_mov_b32 s75, 0x20000
    s_lshr_b32 s31, s30, 2
    v_and_b32 v239, 15, v229
    v_lshrrev_b32 v240, 4, v229
    v_lshrrev_b32 v241, 2, v229
    v_and_b32 v242, 2, v241
    v_xor_b32 v242, v242, v240
    v_lshlrev_b32 v242, 4, v242
    v_lshl_add_u32 v242, v239, 6, v242
    s_lshl_b32 s26, s31, 13
    v_add_u32 v230, s26, v242
    v_add_u32 v231, 0x10000, v230
    v_and_b32 v241, 3, v241
    v_lshlrev_b32 v242, 11, v240
    v_lshl_add_u32 v242, v241, 8, v242
    v_and_b32 v240, 1, v240
    v_lshl_or_b32 v241, v240, 2, v241
    s_lshl_b32 s26, s32, 1
    v_xor_b32 v241, s26, v241
    v_lshl_add_u32 v242, v241, 5, v242
    v_and_b32 v241, 3, v229
    v_lshl_add_u32 v242, v241, 3, v242
    v_add_u32 v233, 16384, v242
    v_xor_b32 v236, 32, v233
    v_add_u32 v234, 0x10000, v233
    v_add_u32 v237, 0x10000, v236
    v_lshrrev_b32 v240, 5, v229
    v_lshrrev_b32 v241, 3, v229
    v_and_b32 v241, 2, v241
    v_or_b32 v240, v240, v241
    v_lshlrev_b32 v240, 8, v240
    v_lshl_add_u32 v240, v239, 4, v240
    s_lshl_b32 s26, s37, 1
    s_add_u32 s26, s26, s31
    s_mul_i32 s26, s26, 112
    s_lshl_b32 s27, s38, 2
    s_add_u32 s26, s26, s27
    s_add_u32 s26, s26, s32
    s_lshl_b32 s26, s26, 13
    v_add_u32 v243, s26, v240
    v_mov_b32 v244, 0xc0135761
    v_mov_b32 v245, 0xc0135761
    v_mov_b32 v246, 0xbdd2d3e8
    v_mov_b32 v247, 0xbdd2d3e8
    v_mov_b32 v248, 0x3f800000
    v_mov_b32 v249, 0x3f800000
    s_add_u32 s20, s24, 0x800000
    s_addc_u32 s21, s25, 0
    s_and_b32 s21, s21, 0xffff
    s_mov_b32 s22, 0xe00000
    s_mov_b32 s23, 0x20000
    v_lshlrev_b32 v228, 4, v229
    s_cmp_eq_u32 s84, 0
    s_cbranch_scc1 ka_ng_14
    s_add_u32 m0, s34, 0x10000
    s_nop 0
    buffer_load_dwordx4 v224, s[12:15], s36 offen offset:0  lds
    buffer_load_dwordx4 v225, s[12:15], s36 offen offset:1024  lds
    buffer_load_dwordx4 v226, s[12:15], s36 offen offset:2048  lds
    buffer_load_dwordx4 v227, s[12:15], s36 offen offset:3072  lds
    s_add_u32 s36, s36, 229376
    s_cmp_eq_u32 s36, s57
    s_cselect_b32 s36, s59, s36
    s_add_u32 m0, s34, 0x18000
    s_nop 0
    buffer_load_dwordx4 v224, s[12:15], s36 offen offset:0  lds
    buffer_load_dwordx4 v225, s[12:15], s36 offen offset:1024  lds
    buffer_load_dwordx4 v226, s[12:15], s36 offen offset:2048  lds
    buffer_load_dwordx4 v227, s[12:15], s36 offen offset:3072  lds
    s_add_u32 s36, s36, 229376
    s_cmp_eq_u32 s36, s57
    s_cselect_b32 s36, s59, s36
ka_ng_14:
    s_waitcnt lgkmcnt(0)
    s_nop 5
    v_sub_f32 v27, v32, v33
    v_sub_f32 v28, v34, v35
    v_add_f32 v27, v27, v36
    v_add_f32 v28, v28, v38
    v_sub_f32 v27, v27, v37
    v_sub_f32 v28, v28, v39
    v_add_f32 v27, v27, v40
    v_add_f32 v28, v28, v42
    v_sub_f32 v27, v27, v41
    v_sub_f32 v28, v28, v43
    v_add_f32 v27, v27, v44
    v_add_f32 v28, v28, v46
    v_sub_f32 v27, v27, v45
    v_sub_f32 v28, v28, v47
    v_add_f32 v27, v27, v28
    v_mov_b32 v28, v27
    v_pk_mul_f32 v[64:65], v[32:33], v[96:97]
    v_pk_mul_f32 v[66:67], v[34:35], v[98:99]
    v_pk_mul_f32 v[68:69], v[36:37], v[100:101]
    v_pk_mul_f32 v[70:71], v[38:39], v[102:103]
    v_pk_mul_f32 v[72:73], v[40:41], v[104:105]
    v_pk_mul_f32 v[74:75], v[42:43], v[106:107]
    v_pk_mul_f32 v[76:77], v[44:45], v[108:109]
    v_pk_mul_f32 v[78:79], v[46:47], v[110:111]
    v_pk_mul_f32 v[32:33], v[32:33], v[112:113]
    v_pk_mul_f32 v[34:35], v[34:35], v[114:115]
    v_pk_mul_f32 v[36:37], v[36:37], v[116:117]
    v_pk_mul_f32 v[38:39], v[38:39], v[118:119]
    v_pk_mul_f32 v[40:41], v[40:41], v[120:121]
    v_pk_mul_f32 v[42:43], v[42:43], v[122:123]
    v_pk_mul_f32 v[44:45], v[44:45], v[124:125]
    v_pk_mul_f32 v[46:47], v[46:47], v[126:127]
    v_pk_fma_f32 v[64:65], v[48:49], v[112:113], v[64:65] neg_lo:[1,0,0] neg_hi:[1,0,0]
    v_pk_fma_f32 v[66:67], v[50:51], v[114:115], v[66:67] neg_lo:[1,0,0] neg_hi:[1,0,0]
    v_pk_fma_f32 v[68:69], v[52:53], v[116:117], v[68:69] neg_lo:[1,0,0] neg_hi:[1,0,0]
    v_pk_fma_f32 v[70:71], v[54:55], v[118:119], v[70:71] neg_lo:[1,0,0] neg_hi:[1,0,0]
    v_pk_fma_f32 v[72:73], v[56:57], v[120:121], v[72:73] neg_lo:[1,0,0] neg_hi:[1,0,0]
    v_pk_fma_f32 v[74:75], v[58:59], v[122:123], v[74:75] neg_lo:[1,0,0] neg_hi:[1,0,0]
    v_pk_fma_f32 v[76:77], v[60:61], v[124:125], v[76:77] neg_lo:[1,0,0] neg_hi:[1,0,0]
    v_pk_fma_f32 v[78:79], v[62:63], v[126:127], v[78:79] neg_lo:[1,0,0] neg_hi:[1,0,0]
    v_cvt_pk_bf16_f32 v4, v64, v65
    v_cvt_pk_bf16_f32 v5, v66, v67
    v_cvt_pk_bf16_f32 v6, v68, v69
    v_cvt_pk_bf16_f32 v7, v70, v71
    v_cvt_pk_bf16_f32 v8, v72, v73
    v_cvt_pk_bf16_f32 v9, v74, v75
    v_cvt_pk_bf16_f32 v10, v76, v77
    v_cvt_pk_bf16_f32 v11, v78, v79
    v_pk_fma_f32 v[32:33], v[48:49], v[96:97], v[32:33]
    v_pk_fma_f32 v[34:35], v[50:51], v[98:99], v[34:35]
    v_pk_fma_f32 v[36:37], v[52:53], v[100:101], v[36:37]
    v_pk_fma_f32 v[38:39], v[54:55], v[102:103], v[38:39]
    v_pk_fma_f32 v[40:41], v[56:57], v[104:105], v[40:41]
    v_pk_fma_f32 v[42:43], v[58:59], v[106:107], v[42:43]
    v_pk_fma_f32 v[44:45], v[60:61], v[108:109], v[44:45]
    v_pk_fma_f32 v[46:47], v[62:63], v[110:111], v[46:47]
    v_mfma_f32_32x32x16_bf16 v[64:79], v[80:83], v[4:7], 0
    v_mfma_f32_32x32x16_bf16 v[64:79], v[84:87], v[8:11], v[64:79]
    v_cvt_pk_bf16_f32 v12, v32, v33
    v_cvt_pk_bf16_f32 v13, v34, v35
    v_cvt_pk_bf16_f32 v14, v36, v37
    v_cvt_pk_bf16_f32 v15, v38, v39
    v_cvt_pk_bf16_f32 v16, v40, v41
    v_cvt_pk_bf16_f32 v17, v42, v43
    v_cvt_pk_bf16_f32 v18, v44, v45
    v_cvt_pk_bf16_f32 v19, v46, v47
    v_permlane32_swap_b32 v27, v28
    s_nop 0
    v_mfma_f32_32x32x16_bf16 v[64:79], v[88:91], v[12:15], v[64:79]
    v_mfma_f32_32x32x16_bf16 v[64:79], v[92:95], v[16:19], v[64:79]
    v_add_f32 v27, v27, v28
    v_mul_f32 v27, 0.5, v27
    s_nop 9
    v_mul_f32 v64, v64, v24
    v_cndmask_b32 v72, v72, v27, s[96:97]
    v_cvt_pk_bf16_f32 v32, v64, v65
    v_cvt_pk_bf16_f32 v33, v66, v67
    v_cvt_pk_bf16_f32 v34, v68, v69
    v_cvt_pk_bf16_f32 v35, v70, v71
    v_cvt_pk_bf16_f32 v36, v72, v73
    v_cvt_pk_bf16_f32 v37, v74, v75
    v_cvt_pk_bf16_f32 v38, v76, v77
    v_cvt_pk_bf16_f32 v39, v78, v79
    ds_write_b16 v23, v32 offset:0
    ds_write_b16_d16_hi v23, v32 offset:512
    ds_write_b16 v23, v33 offset:1024
    ds_write_b16_d16_hi v23, v33 offset:1536
    ds_write_b16 v23, v34 offset:4096
    ds_write_b16_d16_hi v23, v34 offset:4608
    ds_write_b16 v23, v35 offset:5120
    ds_write_b16_d16_hi v23, v35 offset:5632
    ds_write_b16 v23, v36 offset:8192
    ds_write_b16_d16_hi v23, v36 offset:8704
    ds_write_b16 v23, v37 offset:9216
    ds_write_b16_d16_hi v23, v37 offset:9728
    ds_write_b16 v23, v38 offset:12288
    ds_write_b16_d16_hi v23, v38 offset:12800
    ds_write_b16 v23, v39 offset:13312
    ds_write_b16_d16_hi v23, v39 offset:13824
    s_cmp_lt_u32 s30, 4
    s_cbranch_scc1 ka_nx2_15
    s_waitcnt vmcnt(0)
    v_readfirstlane_b32 s50, v216
    v_readfirstlane_b32 s51, v217
    s_nop 3
    s_cmp_lg_u32 s51, 0
    s_cbranch_scc1 tagok_16
    v_mov_b32 v218, 64
tag_17:
    global_load_dwordx2 v[216:217], v218, s[48:49] sc1
    s_waitcnt vmcnt(0)
    v_readfirstlane_b32 s50, v216
    v_readfirstlane_b32 s51, v217
    s_nop 3
    s_cmp_eq_u32 s51, 0
    s_cbranch_scc1 tag_17
tagok_16:
ka_nx2_15:
    s_waitcnt lgkmcnt(0)
    s_barrier
    s_cmp_ge_u32 s30, 4
    s_cbranch_scc1 ka_ny0_19
    s_waitcnt vmcnt(8)
    s_cmp_eq_u32 s84, 1
    s_cbranch_scc1 ka_tg2_20
    s_waitcnt vmcnt(0)
ka_tg2_20:
    v_readfirstlane_b32 s50, v216
    v_readfirstlane_b32 s51, v217
    s_nop 3
    s_cmp_lg_u32 s51, 0
    s_cbranch_scc1 tagok_21
    v_mov_b32 v218, 64
tag_22:
    global_load_dwordx2 v[216:217], v218, s[48:49] sc1
    s_waitcnt vmcnt(0)
    v_readfirstlane_b32 s50, v216
    v_readfirstlane_b32 s51, v217
    s_nop 3
    s_cmp_eq_u32 s51, 0
    s_cbranch_scc1 tag_22
tagok_21:
    s_branch ka_ny_18
ka_ny0_19:
    s_cmp_lg_u32 s30, 4
    s_cbranch_scc1 ka_xw_23
    s_and_b32 s26, s55, 3
    s_lshl_b32 s26, s26, 6
    s_add_u32 s26, s26, s82
    s_lshl_b32 s26, s26, 2
    s_add_u32 s26, s26, s32
    s_lshl_b32 s26, s26, 7
    v_mov_b32 v40, s50
    v_mov_b32 v41, s51
    v_mov_b32 v42, s26
    s_mov_b64 exec, 1
    global_store_dwordx2 v42, v[40:41], s[52:53] sc1
    s_mov_b64 exec, -1
ka_xw_23:
    v_lshrrev_b32 v213, 1, v212
    v_and_b32 v214, 1, v212
    v_lshlrev_b32 v213, 4, v213
    v_lshl_add_u32 v213, v214, 13, v213
    v_add_u32 v213, 131072, v213
    ds_read_b128 v[196:199], v213 offset:0
    ds_read_b128 v[200:203], v213 offset:2048
    ds_read_b128 v[204:207], v213 offset:4096
    ds_read_b128 v[208:211], v213 offset:6144
    v_lshlrev_b32 v214, 4, v212
    s_lshl_b32 s26, s81, 14
    s_add_u32 s27, s26, 0
    s_waitcnt lgkmcnt(3)
    buffer_store_dwordx4 v[196:199], v214, s[72:75], s27 offen sc1
    s_add_u32 s27, s26, 4096
    s_waitcnt lgkmcnt(2)
    buffer_store_dwordx4 v[200:203], v214, s[72:75], s27 offen sc1
    s_add_u32 s27, s26, 8192
    s_waitcnt lgkmcnt(1)
    buffer_store_dwordx4 v[204:207], v214, s[72:75], s27 offen sc1
    s_add_u32 s27, s26, 12288
    s_waitcnt lgkmcnt(0)
    buffer_store_dwordx4 v[208:211], v214, s[72:75], s27 offen sc1
    s_add_u32 s76, s24, 0x2000000
    s_addc_u32 s77, s25, 0
    s_and_b32 s77, s77, 0xffff
    s_mov_b32 s78, 0x402000
    s_mov_b32 s79, 0x20000
    v_and_b32 v40, 7, v212
    v_lshrrev_b32 v41, 3, v212
    v_xor_b32 v42, v41, v40
    v_and_b32 v42, 7, v42
    v_lshlrev_b32 v42, 4, v42
    v_lshl_add_u32 v42, v41, 7, v42
    v_add_u32 v42, 147456, v42
    ds_read_b128 v[128:131], v42 offset:0
    ds_read_b128 v[132:135], v42 offset:4096
    ds_read_b128 v[136:139], v42 offset:8192
    ds_read_b128 v[140:143], v42 offset:12288
    v_mul_u32_u24 v41, 8192, v41
    v_lshl_add_u32 v41, v40, 4, v41
    s_and_b32 s26, s2, 63
    s_lshl_b32 s26, s26, 7
    s_add_u32 s28, s26, 4194304
    s_lshr_b32 s27, s2, 6
    s_mul_i32 s27, s27, 1048576
    s_add_u32 s26, s26, s27
    s_add_u32 s27, s26, 0
    s_waitcnt lgkmcnt(3)
    buffer_store_dwordx4 v[128:131], v41, s[76:79], s27 offen sc1
    s_add_u32 s27, s26, 262144
    s_waitcnt lgkmcnt(2)
    buffer_store_dwordx4 v[132:135], v41, s[76:79], s27 offen sc1
    s_add_u32 s27, s26, 524288
    s_waitcnt lgkmcnt(1)
    buffer_store_dwordx4 v[136:139], v41, s[76:79], s27 offen sc1
    s_add_u32 s27, s26, 786432
    s_waitcnt lgkmcnt(0)
    buffer_store_dwordx4 v[140:143], v41, s[76:79], s27 offen sc1
    s_cmp_eq_u32 s30, 4
    s_cselect_b32 s28, s28, 0x40000000
    s_cmp_ge_u32 s2, 192
    s_cselect_b32 s28, s28, 0x40000000
    buffer_store_short v194, v195, s[76:79], s28 offen sc1
    s_setprio 0
ka_ny_18:
    s_cmp_ge_u32 s54, 28
    s_cbranch_scc1 ka_fft_2
    s_cmp_ge_u32 s30, 4
    s_cbranch_scc1 ka_pf_3
    s_lshl_b32 s35, s37, 19
    s_add_u32 s60, s35, s33
    s_add_u32 s58, s60, 524288
    s_lshl_b32 s26, s56, 14
    s_add_u32 s35, s60, s26
    s_lshr_b32 s26, s37, 2
    s_lshl_b32 s26, s26, 1
    s_and_b32 s27, s37, 1
    s_add_u32 s26, s26, s27
    s_lshl_b32 s26, s26, 15
    v_and_b32 v44, 15, v229
    s_lshl_b32 s27, s30, 13
    s_add_u32 s26, s26, s27
    v_lshlrev_b32 v44, 9, v44
    v_add_u32 v44, s26, v44
pollf_24:
    s_sleep 2
    global_load_dwordx2 v[40:41], v44, s[52:53] offset:0 sc1
    s_waitcnt vmcnt(0)
    v_cmp_eq_u64 vcc, s[50:51], v[40:41]
    s_nop 1
    s_cmp_eq_u64 vcc, -1
    s_cbranch_scc0 pollf_24
    s_add_u32 m0, s33, 0x0
    s_nop 0
    buffer_load_dwordx4 v228, s[8:11], s35 offen offset:0 sc1 lds
    buffer_load_dwordx4 v228, s[8:11], s35 offen offset:1024 sc1 lds
    buffer_load_dwordx4 v228, s[8:11], s35 offen offset:2048 sc1 lds
    buffer_load_dwordx4 v228, s[8:11], s35 offen offset:3072 sc1 lds
    s_add_u32 s35, s35, 16384
    s_cmp_eq_u32 s35, s58
    s_cselect_b32 s35, s60, s35
    s_add_u32 m0, s33, 0x8000
    s_nop 0
    buffer_load_dwordx4 v228, s[8:11], s35 offen offset:0 sc1 lds
    buffer_load_dwordx4 v228, s[8:11], s35 offen offset:1024 sc1 lds
    buffer_load_dwordx4 v228, s[8:11], s35 offen offset:2048 sc1 lds
    buffer_load_dwordx4 v228, s[8:11], s35 offen offset:3072 sc1 lds
    s_add_u32 s35, s35, 16384
    s_cmp_eq_u32 s35, s58
    s_cselect_b32 s35, s60, s35
    s_add_u32 m0, s33, 0x10000
    s_nop 0
    buffer_load_dwordx4 v228, s[8:11], s35 offen offset:0 sc1 lds
    buffer_load_dwordx4 v228, s[8:11], s35 offen offset:1024 sc1 lds
    buffer_load_dwordx4 v228, s[8:11], s35 offen offset:2048 sc1 lds
    buffer_load_dwordx4 v228, s[8:11], s35 offen offset:3072 sc1 lds
    s_add_u32 s35, s35, 16384
    s_cmp_eq_u32 s35, s58
    s_cselect_b32 s35, s60, s35
    s_add_u32 m0, s33, 0x18000
    s_nop 0
    buffer_load_dwordx4 v228, s[8:11], s35 offen offset:0 sc1 lds
    buffer_load_dwordx4 v228, s[8:11], s35 offen offset:1024 sc1 lds
    buffer_load_dwordx4 v228, s[8:11], s35 offen offset:2048 sc1 lds
    buffer_load_dwordx4 v228, s[8:11], s35 offen offset:3072 sc1 lds
    s_add_u32 s35, s35, 16384
    s_cmp_eq_u32 s35, s58
    s_cselect_b32 s35, s60, s35
    s_waitcnt vmcnt(12)
    s_barrier
    ds_read_b64_tr_b16 v[160:161], v233 offset:0
    ds_read_b64_tr_b16 v[162:163], v233 offset:1024
    ds_read_b64_tr_b16 v[164:165], v236 offset:0
    ds_read_b64_tr_b16 v[166:167], v236 offset:1024
    ds_read_b64_tr_b16 v[168:169], v233 offset:8192
    ds_read_b64_tr_b16 v[170:171], v233 offset:9216
    ds_read_b64_tr_b16 v[172:173], v236 offset:8192
    ds_read_b64_tr_b16 v[174:175], v236 offset:9216
    ds_read_b128 v[128:131], v230 offset:0
    ds_read_b128 v[132:135], v230 offset:1024
    ds_read_b128 v[136:139], v230 offset:2048
    ds_read_b128 v[140:143], v230 offset:3072
    ds_read_b128 v[144:147], v230 offset:4096
    ds_read_b128 v[148:151], v230 offset:5120
    ds_read_b128 v[152:155], v230 offset:6144
    ds_read_b128 v[156:159], v230 offset:7168
    s_waitcnt vmcnt(8) lgkmcnt(0)
    s_barrier
    v_mfma_f32_16x16x32_bf16 v[0:3], v[160:163], v[128:131], 0
    ds_read_b64_tr_b16 v[208:209], v233 offset:32768
    v_mfma_f32_16x16x32_bf16 v[4:7], v[164:167], v[128:131], 0
    ds_read_b64_tr_b16 v[210:211], v233 offset:33792
    v_mfma_f32_16x16x32_bf16 v[8:11], v[168:171], v[128:131], 0
    ds_read_b64_tr_b16 v[212:213], v236 offset:32768
    v_mfma_f32_16x16x32_bf16 v[12:15], v[172:175], v[128:131], 0
    ds_read_b64_tr_b16 v[214:215], v236 offset:33792
    s_add_u32 m0, s34, 0x0
    v_mfma_f32_16x16x32_bf16 v[16:19], v[160:163], v[132:135], 0
    ds_read_b64_tr_b16 v[216:217], v233 offset:40960
    v_mfma_f32_16x16x32_bf16 v[20:23], v[164:167], v[132:135], 0
    s_nop 0
    v_mfma_f32_16x16x32_bf16 v[24:27], v[168:171], v[132:135], 0
    ds_read_b64_tr_b16 v[218:219], v233 offset:41984
    buffer_load_dwordx4 v224, s[12:15], s36 offen offset:0  lds
    v_mfma_f32_16x16x32_bf16 v[28:31], v[172:175], v[132:135], 0
    ds_read_b64_tr_b16 v[220:221], v236 offset:40960
    v_mfma_f32_16x16x32_bf16 v[32:35], v[160:163], v[136:139], 0
    ds_read_b64_tr_b16 v[222:223], v236 offset:41984
    buffer_load_dwordx4 v225, s[12:15], s36 offen offset:1024  lds
    v_mfma_f32_16x16x32_bf16 v[36:39], v[164:167], v[136:139], 0
    ds_read_b128 v[176:179], v230 offset:32768
    v_mfma_f32_16x16x32_bf16 v[40:43], v[168:171], v[136:139], 0
    ds_read_b128 v[180:183], v230 offset:33792
    buffer_load_dwordx4 v226, s[12:15], s36 offen offset:2048  lds
    v_mfma_f32_16x16x32_bf16 v[44:47], v[172:175], v[136:139], 0
    v_mfma_f32_16x16x32_bf16 v[48:51], v[160:163], v[140:143], 0
    ds_read_b128 v[184:187], v230 offset:34816
    buffer_load_dwordx4 v227, s[12:15], s36 offen offset:3072  lds
    v_mfma_f32_16x16x32_bf16 v[52:55], v[164:167], v[140:143], 0
    ds_read_b128 v[188:191], v230 offset:35840
    v_mfma_f32_16x16x32_bf16 v[56:59], v[168:171], v[140:143], 0
    ds_read_b128 v[192:195], v230 offset:36864
    s_add_u32 s36, s36, 229376
    s_cmp_eq_u32 s36, s57
    s_cselect_b32 s36, s59, s36
    v_mfma_f32_16x16x32_bf16 v[60:63], v[172:175], v[140:143], 0
    ds_read_b128 v[196:199], v230 offset:37888
    v_mfma_f32_16x16x32_bf16 v[64:67], v[160:163], v[144:147], 0
    ds_read_b128 v[200:203], v230 offset:38912
    s_add_u32 m0, s33, 0x0
    v_mfma_f32_16x16x32_bf16 v[68:71], v[164:167], v[144:147], 0
    s_nop 0
    v_mfma_f32_16x16x32_bf16 v[72:75], v[168:171], v[144:147], 0
    ds_read_b128 v[204:207], v230 offset:39936
    v_mfma_f32_16x16x32_bf16 v[76:79], v[172:175], v[144:147], 0
    buffer_load_dwordx4 v228, s[8:11], s35 offen offset:0 sc1 lds
    v_mfma_f32_16x16x32_bf16 v[80:83], v[160:163], v[148:151], 0
    v_mfma_f32_16x16x32_bf16 v[84:87], v[164:167], v[148:151], 0
    buffer_load_dwordx4 v228, s[8:11], s35 offen offset:1024 sc1 lds
    v_mfma_f32_16x16x32_bf16 v[88:91], v[168:171], v[148:151], 0
    v_mfma_f32_16x16x32_bf16 v[92:95], v[172:175], v[148:151], 0
    buffer_load_dwordx4 v228, s[8:11], s35 offen offset:2048 sc1 lds
    v_mfma_f32_16x16x32_bf16 v[96:99], v[160:163], v[152:155], 0
    v_mfma_f32_16x16x32_bf16 v[100:103], v[164:167], v[152:155], 0
    buffer_load_dwordx4 v228, s[8:11], s35 offen offset:3072 sc1 lds
    v_mfma_f32_16x16x32_bf16 v[104:107], v[168:171], v[152:155], 0
    s_add_u32 s35, s35, 16384
    s_cmp_eq_u32 s35, s58
    s_cselect_b32 s35, s60, s35
    v_mfma_f32_16x16x32_bf16 v[108:111], v[172:175], v[152:155], 0
    v_mfma_f32_16x16x32_bf16 v[112:115], v[160:163], v[156:159], 0
    v_mfma_f32_16x16x32_bf16 v[116:119], v[164:167], v[156:159], 0
    v_mfma_f32_16x16x32_bf16 v[120:123], v[168:171], v[156:159], 0
    v_mfma_f32_16x16x32_bf16 v[124:127], v[172:175], v[156:159], 0
    s_waitcnt vmcnt(12) lgkmcnt(0)
    s_barrier
    v_mfma_f32_16x16x32_bf16 v[0:3], v[208:211], v[176:179], v[0:3]
    ds_read_b64_tr_b16 v[160:161], v234 offset:0
    v_mfma_f32_16x16x32_bf16 v[4:7], v[212:215], v[176:179], v[4:7]
    ds_read_b64_tr_b16 v[162:163], v234 offset:1024
    v_mfma_f32_16x16x32_bf16 v[8:11], v[216:219], v[176:179], v[8:11]
    ds_read_b64_tr_b16 v[164:165], v237 offset:0
    v_mfma_f32_16x16x32_bf16 v[12:15], v[220:223], v[176:179], v[12:15]
    ds_read_b64_tr_b16 v[166:167], v237 offset:1024
    s_add_u32 m0, s34, 0x8000
    v_mfma_f32_16x16x32_bf16 v[16:19], v[208:211], v[180:183], v[16:19]
    ds_read_b64_tr_b16 v[168:169], v234 offset:8192
    v_mfma_f32_16x16x32_bf16 v[20:23], v[212:215], v[180:183], v[20:23]
    s_nop 0
    v_mfma_f32_16x16x32_bf16 v[24:27], v[216:219], v[180:183], v[24:27]
    ds_read_b64_tr_b16 v[170:171], v234 offset:9216
    buffer_load_dwordx4 v224, s[12:15], s36 offen offset:0  lds
    v_mfma_f32_16x16x32_bf16 v[28:31], v[220:223], v[180:183], v[28:31]
    ds_read_b64_tr_b16 v[172:173], v237 offset:8192
    v_mfma_f32_16x16x32_bf16 v[32:35], v[208:211], v[184:187], v[32:35]
    ds_read_b64_tr_b16 v[174:175], v237 offset:9216
    buffer_load_dwordx4 v225, s[12:15], s36 offen offset:1024  lds
    v_mfma_f32_16x16x32_bf16 v[36:39], v[212:215], v[184:187], v[36:39]
    ds_read_b128 v[128:131], v231 offset:0
    v_mfma_f32_16x16x32_bf16 v[40:43], v[216:219], v[184:187], v[40:43]
    ds_read_b128 v[132:135], v231 offset:1024
    buffer_load_dwordx4 v226, s[12:15], s36 offen offset:2048  lds
    v_mfma_f32_16x16x32_bf16 v[44:47], v[220:223], v[184:187], v[44:47]
    v_mfma_f32_16x16x32_bf16 v[48:51], v[208:211], v[188:191], v[48:51]
    ds_read_b128 v[136:139], v231 offset:2048
    buffer_load_dwordx4 v227, s[12:15], s36 offen offset:3072  lds
    v_mfma_f32_16x16x32_bf16 v[52:55], v[212:215], v[188:191], v[52:55]
    ds_read_b128 v[140:143], v231 offset:3072
    v_mfma_f32_16x16x32_bf16 v[56:59], v[216:219], v[188:191], v[56:59]
    ds_read_b128 v[144:147], v231 offset:4096
    s_add_u32 s36, s36, 229376
    s_cmp_eq_u32 s36, s57
    s_cselect_b32 s36, s59, s36
    v_mfma_f32_16x16x32_bf16 v[60:63], v[220:223], v[188:191], v[60:63]
    ds_read_b128 v[148:151], v231 offset:5120
    v_mfma_f32_16x16x32_bf16 v[64:67], v[208:211], v[192:195], v[64:67]
    ds_read_b128 v[152:155], v231 offset:6144
    s_add_u32 m0, s33, 0x8000
    v_mfma_f32_16x16x32_bf16 v[68:71], v[212:215], v[192:195], v[68:71]
    s_nop 0
    v_mfma_f32_16x16x32_bf16 v[72:75], v[216:219], v[192:195], v[72:75]
    ds_read_b128 v[156:159], v231 offset:7168
    v_mfma_f32_16x16x32_bf16 v[76:79], v[220:223], v[192:195], v[76:79]
    buffer_load_dwordx4 v228, s[8:11], s35 offen offset:0 sc1 lds
    v_mfma_f32_16x16x32_bf16 v[80:83], v[208:211], v[196:199], v[80:83]
    v_mfma_f32_16x16x32_bf16 v[84:87], v[212:215], v[196:199], v[84:87]
    buffer_load_dwordx4 v228, s[8:11], s35 offen offset:1024 sc1 lds
    v_mfma_f32_16x16x32_bf16 v[88:91], v[216:219], v[196:199], v[88:91]
    v_mfma_f32_16x16x32_bf16 v[92:95], v[220:223], v[196:199], v[92:95]
    buffer_load_dwordx4 v228, s[8:11], s35 offen offset:2048 sc1 lds
    v_mfma_f32_16x16x32_bf16 v[96:99], v[208:211], v[200:203], v[96:99]
    v_mfma_f32_16x16x32_bf16 v[100:103], v[212:215], v[200:203], v[100:103]
    buffer_load_dwordx4 v228, s[8:11], s35 offen offset:3072 sc1 lds
    v_mfma_f32_16x16x32_bf16 v[104:107], v[216:219], v[200:203], v[104:107]
    s_add_u32 s35, s35, 16384
    s_cmp_eq_u32 s35, s58
    s_cselect_b32 s35, s60, s35
    v_mfma_f32_16x16x32_bf16 v[108:111], v[220:223], v[200:203], v[108:111]
    v_mfma_f32_16x16x32_bf16 v[112:115], v[208:211], v[204:207], v[112:115]
    v_mfma_f32_16x16x32_bf16 v[116:119], v[212:215], v[204:207], v[116:119]
    v_mfma_f32_16x16x32_bf16 v[120:123], v[216:219], v[204:207], v[120:123]
    v_mfma_f32_16x16x32_bf16 v[124:127], v[220:223], v[204:207], v[124:127]
    s_waitcnt vmcnt(16) lgkmcnt(0)
    s_barrier
    v_mfma_f32_16x16x32_bf16 v[0:3], v[160:163], v[128:131], v[0:3]
    ds_read_b64_tr_b16 v[208:209], v234 offset:32768
    v_mfma_f32_16x16x32_bf16 v[4:7], v[164:167], v[128:131], v[4:7]
    ds_read_b64_tr_b16 v[210:211], v234 offset:33792
    v_mfma_f32_16x16x32_bf16 v[8:11], v[168:171], v[128:131], v[8:11]
    ds_read_b64_tr_b16 v[212:213], v237 offset:32768
    v_mfma_f32_16x16x32_bf16 v[12:15], v[172:175], v[128:131], v[12:15]
    ds_read_b64_tr_b16 v[214:215], v237 offset:33792
    s_add_u32 m0, s34, 0x10000
    v_mfma_f32_16x16x32_bf16 v[16:19], v[160:163], v[132:135], v[16:19]
    ds_read_b64_tr_b16 v[216:217], v234 offset:40960
    v_mfma_f32_16x16x32_bf16 v[20:23], v[164:167], v[132:135], v[20:23]
    s_nop 0
    v_mfma_f32_16x16x32_bf16 v[24:27], v[168:171], v[132:135], v[24:27]
    ds_read_b64_tr_b16 v[218:219], v234 offset:41984
    buffer_load_dwordx4 v224, s[12:15], s36 offen offset:0  lds
    v_mfma_f32_16x16x32_bf16 v[28:31], v[172:175], v[132:135], v[28:31]
    ds_read_b64_tr_b16 v[220:221], v237 offset:40960
    v_mfma_f32_16x16x32_bf16 v[32:35], v[160:163], v[136:139], v[32:35]
    ds_read_b64_tr_b16 v[222:223], v237 offset:41984
    buffer_load_dwordx4 v225, s[12:15], s36 offen offset:1024  lds
    v_mfma_f32_16x16x32_bf16 v[36:39], v[164:167], v[136:139], v[36:39]
    ds_read_b128 v[176:179], v231 offset:32768
    v_mfma_f32_16x16x32_bf16 v[40:43], v[168:171], v[136:139], v[40:43]
    ds_read_b128 v[180:183], v231 offset:33792
    buffer_load_dwordx4 v226, s[12:15], s36 offen offset:2048  lds
    v_mfma_f32_16x16x32_bf16 v[44:47], v[172:175], v[136:139], v[44:47]
    v_mfma_f32_16x16x32_bf16 v[48:51], v[160:163], v[140:143], v[48:51]
    ds_read_b128 v[184:187], v231 offset:34816
    buffer_load_dwordx4 v227, s[12:15], s36 offen offset:3072  lds
    v_mfma_f32_16x16x32_bf16 v[52:55], v[164:167], v[140:143], v[52:55]
    ds_read_b128 v[188:191], v231 offset:35840
    v_mfma_f32_16x16x32_bf16 v[56:59], v[168:171], v[140:143], v[56:59]
    ds_read_b128 v[192:195], v231 offset:36864
    s_add_u32 s36, s36, 229376
    s_cmp_eq_u32 s36, s57
    s_cselect_b32 s36, s59, s36
    v_mfma_f32_16x16x32_bf16 v[60:63], v[172:175], v[140:143], v[60:63]
    ds_read_b128 v[196:199], v231 offset:37888
    v_mfma_f32_16x16x32_bf16 v[64:67], v[160:163], v[144:147], v[64:67]
    ds_read_b128 v[200:203], v231 offset:38912
    s_add_u32 m0, s33, 0x10000
    v_mfma_f32_16x16x32_bf16 v[68:71], v[164:167], v[144:147], v[68:71]
    s_nop 0
    v_mfma_f32_16x16x32_bf16 v[72:75], v[168:171], v[144:147], v[72:75]
    ds_read_b128 v[204:207], v231 offset:39936
    v_mfma_f32_16x16x32_bf16 v[76:79], v[172:175], v[144:147], v[76:79]
    buffer_load_dwordx4 v228, s[8:11], s35 offen offset:0 sc1 lds
    v_mfma_f32_16x16x32_bf16 v[80:83], v[160:163], v[148:151], v[80:83]
    v_mfma_f32_16x16x32_bf16 v[84:87], v[164:167], v[148:151], v[84:87]
    buffer_load_dwordx4 v228, s[8:11], s35 offen offset:1024 sc1 lds
    v_mfma_f32_16x16x32_bf16 v[88:91], v[168:171], v[148:151], v[88:91]
    v_mfma_f32_16x16x32_bf16 v[92:95], v[172:175], v[148:151], v[92:95]
    buffer_load_dwordx4 v228, s[8:11], s35 offen offset:2048 sc1 lds
    v_mfma_f32_16x16x32_bf16 v[96:99], v[160:163], v[152:155], v[96:99]
    v_mfma_f32_16x16x32_bf16 v[100:103], v[164:167], v[152:155], v[100:103]
    buffer_load_dwordx4 v228, s[8:11], s35 offen offset:3072 sc1 lds
    v_mfma_f32_16x16x32_bf16 v[104:107], v[168:171], v[152:155], v[104:107]
    s_add_u32 s35, s35, 16384
    s_cmp_eq_u32 s35, s58
    s_cselect_b32 s35, s60, s35
    v_mfma_f32_16x16x32_bf16 v[108:111], v[172:175], v[152:155], v[108:111]
    v_mfma_f32_16x16x32_bf16 v[112:115], v[160:163], v[156:159], v[112:115]
    v_mfma_f32_16x16x32_bf16 v[116:119], v[164:167], v[156:159], v[116:119]
    v_mfma_f32_16x16x32_bf16 v[120:123], v[168:171], v[156:159], v[120:123]
    v_mfma_f32_16x16x32_bf16 v[124:127], v[172:175], v[156:159], v[124:127]
    s_waitcnt vmcnt(16) lgkmcnt(0)
    s_barrier
    v_mfma_f32_16x16x32_bf16 v[0:3], v[208:211], v[176:179], v[0:3]
    ds_read_b64_tr_b16 v[160:161], v233 offset:0
    v_mfma_f32_16x16x32_bf16 v[4:7], v[212:215], v[176:179], v[4:7]
    ds_read_b64_tr_b16 v[162:163], v233 offset:1024
    v_mfma_f32_16x16x32_bf16 v[8:11], v[216:219], v[176:179], v[8:11]
    ds_read_b64_tr_b16 v[164:165], v236 offset:0
    v_mfma_f32_16x16x32_bf16 v[12:15], v[220:223], v[176:179], v[12:15]
    ds_read_b64_tr_b16 v[166:167], v236 offset:1024
    s_add_u32 m0, s34, 0x18000
    v_mfma_f32_16x16x32_bf16 v[16:19], v[208:211], v[180:183], v[16:19]
    ds_read_b64_tr_b16 v[168:169], v233 offset:8192
    v_mfma_f32_16x16x32_bf16 v[20:23], v[212:215], v[180:183], v[20:23]
    s_nop 0
    v_mfma_f32_16x16x32_bf16 v[24:27], v[216:219], v[180:183], v[24:27]
    ds_read_b64_tr_b16 v[170:171], v233 offset:9216
    buffer_load_dwordx4 v224, s[12:15], s36 offen offset:0  lds
    v_mfma_f32_16x16x32_bf16 v[28:31], v[220:223], v[180:183], v[28:31]
    ds_read_b64_tr_b16 v[172:173], v236 offset:8192
    v_mfma_f32_16x16x32_bf16 v[32:35], v[208:211], v[184:187], v[32:35]
    ds_read_b64_tr_b16 v[174:175], v236 offset:9216
    buffer_load_dwordx4 v225, s[12:15], s36 offen offset:1024  lds
    v_mfma_f32_16x16x32_bf16 v[36:39], v[212:215], v[184:187], v[36:39]
    ds_read_b128 v[128:131], v230 offset:0
    v_mfma_f32_16x16x32_bf16 v[40:43], v[216:219], v[184:187], v[40:43]
    ds_read_b128 v[132:135], v230 offset:1024
    buffer_load_dwordx4 v226, s[12:15], s36 offen offset:2048  lds
    v_mfma_f32_16x16x32_bf16 v[44:47], v[220:223], v[184:187], v[44:47]
    v_mfma_f32_16x16x32_bf16 v[48:51], v[208:211], v[188:191], v[48:51]
    ds_read_b128 v[136:139], v230 offset:2048
    buffer_load_dwordx4 v227, s[12:15], s36 offen offset:3072  lds
    v_mfma_f32_16x16x32_bf16 v[52:55], v[212:215], v[188:191], v[52:55]
    ds_read_b128 v[140:143], v230 offset:3072
    v_mfma_f32_16x16x32_bf16 v[56:59], v[216:219], v[188:191], v[56:59]
    ds_read_b128 v[144:147], v230 offset:4096
    s_add_u32 s36, s36, 229376
    s_cmp_eq_u32 s36, s57
    s_cselect_b32 s36, s59, s36
    v_mfma_f32_16x16x32_bf16 v[60:63], v[220:223], v[188:191], v[60:63]
    ds_read_b128 v[148:151], v230 offset:5120
    v_mfma_f32_16x16x32_bf16 v[64:67], v[208:211], v[192:195], v[64:67]
    ds_read_b128 v[152:155], v230 offset:6144
    s_add_u32 m0, s33, 0x18000
    v_mfma_f32_16x16x32_bf16 v[68:71], v[212:215], v[192:195], v[68:71]
    s_nop 0
    v_mfma_f32_16x16x32_bf16 v[72:75], v[216:219], v[192:195], v[72:75]
    ds_read_b128 v[156:159], v230 offset:7168
    v_mfma_f32_16x16x32_bf16 v[76:79], v[220:223], v[192:195], v[76:79]
    buffer_load_dwordx4 v228, s[8:11], s35 offen offset:0 sc1 lds
    v_mfma_f32_16x16x32_bf16 v[80:83], v[208:211], v[196:199], v[80:83]
    v_mfma_f32_16x16x32_bf16 v[84:87], v[212:215], v[196:199], v[84:87]
    buffer_load_dwordx4 v228, s[8:11], s35 offen offset:1024 sc1 lds
    v_mfma_f32_16x16x32_bf16 v[88:91], v[216:219], v[196:199], v[88:91]
    v_mfma_f32_16x16x32_bf16 v[92:95], v[220:223], v[196:199], v[92:95]
    buffer_load_dwordx4 v228, s[8:11], s35 offen offset:2048 sc1 lds
    v_mfma_f32_16x16x32_bf16 v[96:99], v[208:211], v[200:203], v[96:99]
    v_mfma_f32_16x16x32_bf16 v[100:103], v[212:215], v[200:203], v[100:103]
    buffer_load_dwordx4 v228, s[8:11], s35 offen offset:3072 sc1 lds
    v_mfma_f32_16x16x32_bf16 v[104:107], v[216:219], v[200:203], v[104:107]
    s_add_u32 s35, s35, 16384
    s_cmp_eq_u32 s35, s58
    s_cselect_b32 s35, s60, s35
    v_mfma_f32_16x16x32_bf16 v[108:111], v[220:223], v[200:203], v[108:111]
    v_mfma_f32_16x16x32_bf16 v[112:115], v[208:211], v[204:207], v[112:115]
    v_mfma_f32_16x16x32_bf16 v[116:119], v[212:215], v[204:207], v[116:119]
    v_mfma_f32_16x16x32_bf16 v[120:123], v[216:219], v[204:207], v[120:123]
    v_mfma_f32_16x16x32_bf16 v[124:127], v[220:223], v[204:207], v[124:127]
    s_waitcnt vmcnt(16) lgkmcnt(0)
    s_barrier
    v_mfma_f32_16x16x32_bf16 v[0:3], v[160:163], v[128:131], v[0:3]
    ds_read_b64_tr_b16 v[208:209], v233 offset:32768
    v_mfma_f32_16x16x32_bf16 v[4:7], v[164:167], v[128:131], v[4:7]
    ds_read_b64_tr_b16 v[210:211], v233 offset:33792
    v_mfma_f32_16x16x32_bf16 v[8:11], v[168:171], v[128:131], v[8:11]
    ds_read_b64_tr_b16 v[212:213], v236 offset:32768
    v_mfma_f32_16x16x32_bf16 v[12:15], v[172:175], v[128:131], v[12:15]
    ds_read_b64_tr_b16 v[214:215], v236 offset:33792
    s_add_u32 m0, s34, 0x0
    v_mfma_f32_16x16x32_bf16 v[16:19], v[160:163], v[132:135], v[16:19]
    ds_read_b64_tr_b16 v[216:217], v233 offset:40960
    v_mfma_f32_16x16x32_bf16 v[20:23], v[164:167], v[132:135], v[20:23]
    s_nop 0
    v_mfma_f32_16x16x32_bf16 v[24:27], v[168:171], v[132:135], v[24:27]
    ds_read_b64_tr_b16 v[218:219], v233 offset:41984
    buffer_load_dwordx4 v224, s[12:15], s36 offen offset:0  lds
    v_mfma_f32_16x16x32_bf16 v[28:31], v[172:175], v[132:135], v[28:31]
    ds_read_b64_tr_b16 v[220:221], v236 offset:40960
    v_mfma_f32_16x16x32_bf16 v[32:35], v[160:163], v[136:139], v[32:35]
    ds_read_b64_tr_b16 v[222:223], v236 offset:41984
    buffer_load_dwordx4 v225, s[12:15], s36 offen offset:1024  lds
    v_mfma_f32_16x16x32_bf16 v[36:39], v[164:167], v[136:139], v[36:39]
    ds_read_b128 v[176:179], v230 offset:32768
    v_mfma_f32_16x16x32_bf16 v[40:43], v[168:171], v[136:139], v[40:43]
    ds_read_b128 v[180:183], v230 offset:33792
    buffer_load_dwordx4 v226, s[12:15], s36 offen offset:2048  lds
    v_mfma_f32_16x16x32_bf16 v[44:47], v[172:175], v[136:139], v[44:47]
    v_mfma_f32_16x16x32_bf16 v[48:51], v[160:163], v[140:143], v[48:51]
    ds_read_b128 v[184:187], v230 offset:34816
    buffer_load_dwordx4 v227, s[12:15], s36 offen offset:3072  lds
    v_mfma_f32_16x16x32_bf16 v[52:55], v[164:167], v[140:143], v[52:55]
    ds_read_b128 v[188:191], v230 offset:35840
    v_mfma_f32_16x16x32_bf16 v[56:59], v[168:171], v[140:143], v[56:59]
    ds_read_b128 v[192:195], v230 offset:36864
    s_add_u32 s36, s36, 229376
    s_cmp_eq_u32 s36, s57
    s_cselect_b32 s36, s59, s36
    v_mfma_f32_16x16x32_bf16 v[60:63], v[172:175], v[140:143], v[60:63]
    ds_read_b128 v[196:199], v230 offset:37888
    v_mfma_f32_16x16x32_bf16 v[64:67], v[160:163], v[144:147], v[64:67]
    ds_read_b128 v[200:203], v230 offset:38912
    s_add_u32 m0, s33, 0x0
    v_mfma_f32_16x16x32_bf16 v[68:71], v[164:167], v[144:147], v[68:71]
    s_nop 0
    v_mfma_f32_16x16x32_bf16 v[72:75], v[168:171], v[144:147], v[72:75]
    ds_read_b128 v[204:207], v230 offset:39936
    v_mfma_f32_16x16x32_bf16 v[76:79], v[172:175], v[144:147], v[76:79]
    buffer_load_dwordx4 v228, s[8:11], s35 offen offset:0 sc1 lds
    v_mfma_f32_16x16x32_bf16 v[80:83], v[160:163], v[148:151], v[80:83]
    v_mfma_f32_16x16x32_bf16 v[84:87], v[164:167], v[148:151], v[84:87]
    buffer_load_dwordx4 v228, s[8:11], s35 offen offset:1024 sc1 lds
    v_mfma_f32_16x16x32_bf16 v[88:91], v[168:171], v[148:151], v[88:91]
    v_mfma_f32_16x16x32_bf16 v[92:95], v[172:175], v[148:151], v[92:95]
    buffer_load_dwordx4 v228, s[8:11], s35 offen offset:2048 sc1 lds
    v_mfma_f32_16x16x32_bf16 v[96:99], v[160:163], v[152:155], v[96:99]
    v_mfma_f32_16x16x32_bf16 v[100:103], v[164:167], v[152:155], v[100:103]
    buffer_load_dwordx4 v228, s[8:11], s35 offen offset:3072 sc1 lds
    v_mfma_f32_16x16x32_bf16 v[104:107], v[168:171], v[152:155], v[104:107]
    s_add_u32 s35, s35, 16384
    s_cmp_eq_u32 s35, s58
    s_cselect_b32 s35, s60, s35
    v_mfma_f32_16x16x32_bf16 v[108:111], v[172:175], v[152:155], v[108:111]
    v_mfma_f32_16x16x32_bf16 v[112:115], v[160:163], v[156:159], v[112:115]
    v_mfma_f32_16x16x32_bf16 v[116:119], v[164:167], v[156:159], v[116:119]
    v_mfma_f32_16x16x32_bf16 v[120:123], v[168:171], v[156:159], v[120:123]
    v_mfma_f32_16x16x32_bf16 v[124:127], v[172:175], v[156:159], v[124:127]
    s_mov_b32 s39, 5
loop_25:
    s_waitcnt vmcnt(16) lgkmcnt(0)
    s_barrier
    v_mfma_f32_16x16x32_bf16 v[0:3], v[208:211], v[176:179], v[0:3]
    ds_read_b64_tr_b16 v[160:161], v234 offset:0
    v_mfma_f32_16x16x32_bf16 v[4:7], v[212:215], v[176:179], v[4:7]
    ds_read_b64_tr_b16 v[162:163], v234 offset:1024
    v_mfma_f32_16x16x32_bf16 v[8:11], v[216:219], v[176:179], v[8:11]
    ds_read_b64_tr_b16 v[164:165], v237 offset:0
    v_mfma_f32_16x16x32_bf16 v[12:15], v[220:223], v[176:179], v[12:15]
    ds_read_b64_tr_b16 v[166:167], v237 offset:1024
    s_add_u32 m0, s34, 0x8000
    v_mfma_f32_16x16x32_bf16 v[16:19], v[208:211], v[180:183], v[16:19]
    ds_read_b64_tr_b16 v[168:169], v234 offset:8192
    v_mfma_f32_16x16x32_bf16 v[20:23], v[212:215], v[180:183], v[20:23]
    s_nop 0
    v_mfma_f32_16x16x32_bf16 v[24:27], v[216:219], v[180:183], v[24:27]
    ds_read_b64_tr_b16 v[170:171], v234 offset:9216
    buffer_load_dwordx4 v224, s[12:15], s36 offen offset:0  lds
    v_mfma_f32_16x16x32_bf16 v[28:31], v[220:223], v[180:183], v[28:31]
    ds_read_b64_tr_b16 v[172:173], v237 offset:8192
    v_mfma_f32_16x16x32_bf16 v[32:35], v[208:211], v[184:187], v[32:35]
    ds_read_b64_tr_b16 v[174:175], v237 offset:9216
    buffer_load_dwordx4 v225, s[12:15], s36 offen offset:1024  lds
    v_mfma_f32_16x16x32_bf16 v[36:39], v[212:215], v[184:187], v[36:39]
    ds_read_b128 v[128:131], v231 offset:0
    v_mfma_f32_16x16x32_bf16 v[40:43], v[216:219], v[184:187], v[40:43]
    ds_read_b128 v[132:135], v231 offset:1024
    buffer_load_dwordx4 v226, s[12:15], s36 offen offset:2048  lds
    v_mfma_f32_16x16x32_bf16 v[44:47], v[220:223], v[184:187], v[44:47]
    v_mfma_f32_16x16x32_bf16 v[48:51], v[208:211], v[188:191], v[48:51]
    ds_read_b128 v[136:139], v231 offset:2048
    buffer_load_dwordx4 v227, s[12:15], s36 offen offset:3072  lds
    v_mfma_f32_16x16x32_bf16 v[52:55], v[212:215], v[188:191], v[52:55]
    ds_read_b128 v[140:143], v231 offset:3072
    v_mfma_f32_16x16x32_bf16 v[56:59], v[216:219], v[188:191], v[56:59]
    ds_read_b128 v[144:147], v231 offset:4096
    s_add_u32 s36, s36, 229376
    s_cmp_eq_u32 s36, s57
    s_cselect_b32 s36, s59, s36
    v_mfma_f32_16x16x32_bf16 v[60:63], v[220:223], v[188:191], v[60:63]
    ds_read_b128 v[148:151], v231 offset:5120
    v_mfma_f32_16x16x32_bf16 v[64:67], v[208:211], v[192:195], v[64:67]
    ds_read_b128 v[152:155], v231 offset:6144
    s_add_u32 m0, s33, 0x8000
    v_mfma_f32_16x16x32_bf16 v[68:71], v[212:215], v[192:195], v[68:71]
    s_nop 0
    v_mfma_f32_16x16x32_bf16 v[72:75], v[216:219], v[192:195], v[72:75]
    ds_read_b128 v[156:159], v231 offset:7168
    v_mfma_f32_16x16x32_bf16 v[76:79], v[220:223], v[192:195], v[76:79]
    buffer_load_dwordx4 v228, s[8:11], s35 offen offset:0 sc1 lds
    v_mfma_f32_16x16x32_bf16 v[80:83], v[208:211], v[196:199], v[80:83]
    v_mfma_f32_16x16x32_bf16 v[84:87], v[212:215], v[196:199], v[84:87]
    buffer_load_dwordx4 v228, s[8:11], s35 offen offset:1024 sc1 lds
    v_mfma_f32_16x16x32_bf16 v[88:91], v[216:219], v[196:199], v[88:91]
    v_mfma_f32_16x16x32_bf16 v[92:95], v[220:223], v[196:199], v[92:95]
    buffer_load_dwordx4 v228, s[8:11], s35 offen offset:2048 sc1 lds
    v_mfma_f32_16x16x32_bf16 v[96:99], v[208:211], v[200:203], v[96:99]
    v_mfma_f32_16x16x32_bf16 v[100:103], v[212:215], v[200:203], v[100:103]
    buffer_load_dwordx4 v228, s[8:11], s35 offen offset:3072 sc1 lds
    v_mfma_f32_16x16x32_bf16 v[104:107], v[216:219], v[200:203], v[104:107]
    s_add_u32 s35, s35, 16384
    s_cmp_eq_u32 s35, s58
    s_cselect_b32 s35, s60, s35
    v_mfma_f32_16x16x32_bf16 v[108:111], v[220:223], v[200:203], v[108:111]
    v_mfma_f32_16x16x32_bf16 v[112:115], v[208:211], v[204:207], v[112:115]
    v_mfma_f32_16x16x32_bf16 v[116:119], v[212:215], v[204:207], v[116:119]
    v_mfma_f32_16x16x32_bf16 v[120:123], v[216:219], v[204:207], v[120:123]
    v_mfma_f32_16x16x32_bf16 v[124:127], v[220:223], v[204:207], v[124:127]
    s_waitcnt vmcnt(16) lgkmcnt(0)
    s_barrier
    v_mfma_f32_16x16x32_bf16 v[0:3], v[160:163], v[128:131], v[0:3]
    ds_read_b64_tr_b16 v[208:209], v234 offset:32768
    v_mfma_f32_16x16x32_bf16 v[4:7], v[164:167], v[128:131], v[4:7]
    ds_read_b64_tr_b16 v[210:211], v234 offset:33792
    v_mfma_f32_16x16x32_bf16 v[8:11], v[168:171], v[128:131], v[8:11]
    ds_read_b64_tr_b16 v[212:213], v237 offset:32768
    v_mfma_f32_16x16x32_bf16 v[12:15], v[172:175], v[128:131], v[12:15]
    ds_read_b64_tr_b16 v[214:215], v237 offset:33792
    s_add_u32 m0, s34, 0x10000
    v_mfma_f32_16x16x32_bf16 v[16:19], v[160:163], v[132:135], v[16:19]
    ds_read_b64_tr_b16 v[216:217], v234 offset:40960
    v_mfma_f32_16x16x32_bf16 v[20:23], v[164:167], v[132:135], v[20:23]
    s_nop 0
    v_mfma_f32_16x16x32_bf16 v[24:27], v[168:171], v[132:135], v[24:27]
    ds_read_b64_tr_b16 v[218:219], v234 offset:41984
    buffer_load_dwordx4 v224, s[12:15], s36 offen offset:0  lds
    v_mfma_f32_16x16x32_bf16 v[28:31], v[172:175], v[132:135], v[28:31]
    ds_read_b64_tr_b16 v[220:221], v237 offset:40960
    v_mfma_f32_16x16x32_bf16 v[32:35], v[160:163], v[136:139], v[32:35]
    ds_read_b64_tr_b16 v[222:223], v237 offset:41984
    buffer_load_dwordx4 v225, s[12:15], s36 offen offset:1024  lds
    v_mfma_f32_16x16x32_bf16 v[36:39], v[164:167], v[136:139], v[36:39]
    ds_read_b128 v[176:179], v231 offset:32768
    v_mfma_f32_16x16x32_bf16 v[40:43], v[168:171], v[136:139], v[40:43]
    ds_read_b128 v[180:183], v231 offset:33792
    buffer_load_dwordx4 v226, s[12:15], s36 offen offset:2048  lds
    v_mfma_f32_16x16x32_bf16 v[44:47], v[172:175], v[136:139], v[44:47]
    v_mfma_f32_16x16x32_bf16 v[48:51], v[160:163], v[140:143], v[48:51]
    ds_read_b128 v[184:187], v231 offset:34816
    buffer_load_dwordx4 v227, s[12:15], s36 offen offset:3072  lds
    v_mfma_f32_16x16x32_bf16 v[52:55], v[164:167], v[140:143], v[52:55]
    ds_read_b128 v[188:191], v231 offset:35840
    v_mfma_f32_16x16x32_bf16 v[56:59], v[168:171], v[140:143], v[56:59]
    ds_read_b128 v[192:195], v231 offset:36864
    s_add_u32 s36, s36, 229376
    s_cmp_eq_u32 s36, s57
    s_cselect_b32 s36, s59, s36
    v_mfma_f32_16x16x32_bf16 v[60:63], v[172:175], v[140:143], v[60:63]
    ds_read_b128 v[196:199], v231 offset:37888
    v_mfma_f32_16x16x32_bf16 v[64:67], v[160:163], v[144:147], v[64:67]
    ds_read_b128 v[200:203], v231 offset:38912
    s_add_u32 m0, s33, 0x10000
    v_mfma_f32_16x16x32_bf16 v[68:71], v[164:167], v[144:147], v[68:71]
    s_nop 0
    v_mfma_f32_16x16x32_bf16 v[72:75], v[168:171], v[144:147], v[72:75]
    ds_read_b128 v[204:207], v231 offset:39936
    v_mfma_f32_16x16x32_bf16 v[76:79], v[172:175], v[144:147], v[76:79]
    buffer_load_dwordx4 v228, s[8:11], s35 offen offset:0 sc1 lds
    v_mfma_f32_16x16x32_bf16 v[80:83], v[160:163], v[148:151], v[80:83]
    v_mfma_f32_16x16x32_bf16 v[84:87], v[164:167], v[148:151], v[84:87]
    buffer_load_dwordx4 v228, s[8:11], s35 offen offset:1024 sc1 lds
    v_mfma_f32_16x16x32_bf16 v[88:91], v[168:171], v[148:151], v[88:91]
    v_mfma_f32_16x16x32_bf16 v[92:95], v[172:175], v[148:151], v[92:95]
    buffer_load_dwordx4 v228, s[8:11], s35 offen offset:2048 sc1 lds
    v_mfma_f32_16x16x32_bf16 v[96:99], v[160:163], v[152:155], v[96:99]
    v_mfma_f32_16x16x32_bf16 v[100:103], v[164:167], v[152:155], v[100:103]
    buffer_load_dwordx4 v228, s[8:11], s35 offen offset:3072 sc1 lds
    v_mfma_f32_16x16x32_bf16 v[104:107], v[168:171], v[152:155], v[104:107]
    s_add_u32 s35, s35, 16384
    s_cmp_eq_u32 s35, s58
    s_cselect_b32 s35, s60, s35
    v_mfma_f32_16x16x32_bf16 v[108:111], v[172:175], v[152:155], v[108:111]
    v_mfma_f32_16x16x32_bf16 v[112:115], v[160:163], v[156:159], v[112:115]
    v_mfma_f32_16x16x32_bf16 v[116:119], v[164:167], v[156:159], v[116:119]
    v_mfma_f32_16x16x32_bf16 v[120:123], v[168:171], v[156:159], v[120:123]
    v_mfma_f32_16x16x32_bf16 v[124:127], v[172:175], v[156:159], v[124:127]
    s_waitcnt vmcnt(16) lgkmcnt(0)
    s_barrier
    v_mfma_f32_16x16x32_bf16 v[0:3], v[208:211], v[176:179], v[0:3]
    ds_read_b64_tr_b16 v[160:161], v233 offset:0
    v_mfma_f32_16x16x32_bf16 v[4:7], v[212:215], v[176:179], v[4:7]
    ds_read_b64_tr_b16 v[162:163], v233 offset:1024
    v_mfma_f32_16x16x32_bf16 v[8:11], v[216:219], v[176:179], v[8:11]
    ds_read_b64_tr_b16 v[164:165], v236 offset:0
    v_mfma_f32_16x16x32_bf16 v[12:15], v[220:223], v[176:179], v[12:15]
    ds_read_b64_tr_b16 v[166:167], v236 offset:1024
    s_add_u32 m0, s34, 0x18000
    v_mfma_f32_16x16x32_bf16 v[16:19], v[208:211], v[180:183], v[16:19]
    ds_read_b64_tr_b16 v[168:169], v233 offset:8192
    v_mfma_f32_16x16x32_bf16 v[20:23], v[212:215], v[180:183], v[20:23]
    s_nop 0
    v_mfma_f32_16x16x32_bf16 v[24:27], v[216:219], v[180:183], v[24:27]
    ds_read_b64_tr_b16 v[170:171], v233 offset:9216
    buffer_load_dwordx4 v224, s[12:15], s36 offen offset:0  lds
    v_mfma_f32_16x16x32_bf16 v[28:31], v[220:223], v[180:183], v[28:31]
    ds_read_b64_tr_b16 v[172:173], v236 offset:8192
    v_mfma_f32_16x16x32_bf16 v[32:35], v[208:211], v[184:187], v[32:35]
    ds_read_b64_tr_b16 v[174:175], v236 offset:9216
    buffer_load_dwordx4 v225, s[12:15], s36 offen offset:1024  lds
    v_mfma_f32_16x16x32_bf16 v[36:39], v[212:215], v[184:187], v[36:39]
    ds_read_b128 v[128:131], v230 offset:0
    v_mfma_f32_16x16x32_bf16 v[40:43], v[216:219], v[184:187], v[40:43]
    ds_read_b128 v[132:135], v230 offset:1024
    buffer_load_dwordx4 v226, s[12:15], s36 offen offset:2048  lds
    v_mfma_f32_16x16x32_bf16 v[44:47], v[220:223], v[184:187], v[44:47]
    v_mfma_f32_16x16x32_bf16 v[48:51], v[208:211], v[188:191], v[48:51]
    ds_read_b128 v[136:139], v230 offset:2048
    buffer_load_dwordx4 v227, s[12:15], s36 offen offset:3072  lds
    v_mfma_f32_16x16x32_bf16 v[52:55], v[212:215], v[188:191], v[52:55]
    ds_read_b128 v[140:143], v230 offset:3072
    v_mfma_f32_16x16x32_bf16 v[56:59], v[216:219], v[188:191], v[56:59]
    ds_read_b128 v[144:147], v230 offset:4096
    s_add_u32 s36, s36, 229376
    s_cmp_eq_u32 s36, s57
    s_cselect_b32 s36, s59, s36
    v_mfma_f32_16x16x32_bf16 v[60:63], v[220:223], v[188:191], v[60:63]
    ds_read_b128 v[148:151], v230 offset:5120
    v_mfma_f32_16x16x32_bf16 v[64:67], v[208:211], v[192:195], v[64:67]
    ds_read_b128 v[152:155], v230 offset:6144
    s_add_u32 m0, s33, 0x18000
    v_mfma_f32_16x16x32_bf16 v[68:71], v[212:215], v[192:195], v[68:71]
    s_nop 0
    v_mfma_f32_16x16x32_bf16 v[72:75], v[216:219], v[192:195], v[72:75]
    ds_read_b128 v[156:159], v230 offset:7168
    v_mfma_f32_16x16x32_bf16 v[76:79], v[220:223], v[192:195], v[76:79]
    buffer_load_dwordx4 v228, s[8:11], s35 offen offset:0 sc1 lds
    v_mfma_f32_16x16x32_bf16 v[80:83], v[208:211], v[196:199], v[80:83]
    v_mfma_f32_16x16x32_bf16 v[84:87], v[212:215], v[196:199], v[84:87]
    buffer_load_dwordx4 v228, s[8:11], s35 offen offset:1024 sc1 lds
    v_mfma_f32_16x16x32_bf16 v[88:91], v[216:219], v[196:199], v[88:91]
    v_mfma_f32_16x16x32_bf16 v[92:95], v[220:223], v[196:199], v[92:95]
    buffer_load_dwordx4 v228, s[8:11], s35 offen offset:2048 sc1 lds
    v_mfma_f32_16x16x32_bf16 v[96:99], v[208:211], v[200:203], v[96:99]
    v_mfma_f32_16x16x32_bf16 v[100:103], v[212:215], v[200:203], v[100:103]
    buffer_load_dwordx4 v228, s[8:11], s35 offen offset:3072 sc1 lds
    v_mfma_f32_16x16x32_bf16 v[104:107], v[216:219], v[200:203], v[104:107]
    s_add_u32 s35, s35, 16384
    s_cmp_eq_u32 s35, s58
    s_cselect_b32 s35, s60, s35
    v_mfma_f32_16x16x32_bf16 v[108:111], v[220:223], v[200:203], v[108:111]
    v_mfma_f32_16x16x32_bf16 v[112:115], v[208:211], v[204:207], v[112:115]
    v_mfma_f32_16x16x32_bf16 v[116:119], v[212:215], v[204:207], v[116:119]
    v_mfma_f32_16x16x32_bf16 v[120:123], v[216:219], v[204:207], v[120:123]
    v_mfma_f32_16x16x32_bf16 v[124:127], v[220:223], v[204:207], v[124:127]
    s_waitcnt vmcnt(16) lgkmcnt(0)
    s_barrier
    v_mfma_f32_16x16x32_bf16 v[0:3], v[160:163], v[128:131], v[0:3]
    ds_read_b64_tr_b16 v[208:209], v233 offset:32768
    v_mfma_f32_16x16x32_bf16 v[4:7], v[164:167], v[128:131], v[4:7]
    ds_read_b64_tr_b16 v[210:211], v233 offset:33792
    v_mfma_f32_16x16x32_bf16 v[8:11], v[168:171], v[128:131], v[8:11]
    ds_read_b64_tr_b16 v[212:213], v236 offset:32768
    v_mfma_f32_16x16x32_bf16 v[12:15], v[172:175], v[128:131], v[12:15]
    ds_read_b64_tr_b16 v[214:215], v236 offset:33792
    s_add_u32 m0, s34, 0x0
    v_mfma_f32_16x16x32_bf16 v[16:19], v[160:163], v[132:135], v[16:19]
    ds_read_b64_tr_b16 v[216:217], v233 offset:40960
    v_mfma_f32_16x16x32_bf16 v[20:23], v[164:167], v[132:135], v[20:23]
    s_nop 0
    v_mfma_f32_16x16x32_bf16 v[24:27], v[168:171], v[132:135], v[24:27]
    ds_read_b64_tr_b16 v[218:219], v233 offset:41984
    buffer_load_dwordx4 v224, s[12:15], s36 offen offset:0  lds
    v_mfma_f32_16x16x32_bf16 v[28:31], v[172:175], v[132:135], v[28:31]
    ds_read_b64_tr_b16 v[220:221], v236 offset:40960
    v_mfma_f32_16x16x32_bf16 v[32:35], v[160:163], v[136:139], v[32:35]
    ds_read_b64_tr_b16 v[222:223], v236 offset:41984
    buffer_load_dwordx4 v225, s[12:15], s36 offen offset:1024  lds
    v_mfma_f32_16x16x32_bf16 v[36:39], v[164:167], v[136:139], v[36:39]
    ds_read_b128 v[176:179], v230 offset:32768
    v_mfma_f32_16x16x32_bf16 v[40:43], v[168:171], v[136:139], v[40:43]
    ds_read_b128 v[180:183], v230 offset:33792
    buffer_load_dwordx4 v226, s[12:15], s36 offen offset:2048  lds
    v_mfma_f32_16x16x32_bf16 v[44:47], v[172:175], v[136:139], v[44:47]
    v_mfma_f32_16x16x32_bf16 v[48:51], v[160:163], v[140:143], v[48:51]
    ds_read_b128 v[184:187], v230 offset:34816
    buffer_load_dwordx4 v227, s[12:15], s36 offen offset:3072  lds
    v_mfma_f32_16x16x32_bf16 v[52:55], v[164:167], v[140:143], v[52:55]
    ds_read_b128 v[188:191], v230 offset:35840
    v_mfma_f32_16x16x32_bf16 v[56:59], v[168:171], v[140:143], v[56:59]
    ds_read_b128 v[192:195], v230 offset:36864
    s_add_u32 s36, s36, 229376
    s_cmp_eq_u32 s36, s57
    s_cselect_b32 s36, s59, s36
    v_mfma_f32_16x16x32_bf16 v[60:63], v[172:175], v[140:143], v[60:63]
    ds_read_b128 v[196:199], v230 offset:37888
    v_mfma_f32_16x16x32_bf16 v[64:67], v[160:163], v[144:147], v[64:67]
    ds_read_b128 v[200:203], v230 offset:38912
    s_add_u32 m0, s33, 0x0
    v_mfma_f32_16x16x32_bf16 v[68:71], v[164:167], v[144:147], v[68:71]
    s_nop 0
    v_mfma_f32_16x16x32_bf16 v[72:75], v[168:171], v[144:147], v[72:75]
    ds_read_b128 v[204:207], v230 offset:39936
    v_mfma_f32_16x16x32_bf16 v[76:79], v[172:175], v[144:147], v[76:79]
    buffer_load_dwordx4 v228, s[8:11], s35 offen offset:0 sc1 lds
    v_mfma_f32_16x16x32_bf16 v[80:83], v[160:163], v[148:151], v[80:83]
    v_mfma_f32_16x16x32_bf16 v[84:87], v[164:167], v[148:151], v[84:87]
    buffer_load_dwordx4 v228, s[8:11], s35 offen offset:1024 sc1 lds
    v_mfma_f32_16x16x32_bf16 v[88:91], v[168:171], v[148:151], v[88:91]
    v_mfma_f32_16x16x32_bf16 v[92:95], v[172:175], v[148:151], v[92:95]
    buffer_load_dwordx4 v228, s[8:11], s35 offen offset:2048 sc1 lds
    v_mfma_f32_16x16x32_bf16 v[96:99], v[160:163], v[152:155], v[96:99]
    v_mfma_f32_16x16x32_bf16 v[100:103], v[164:167], v[152:155], v[100:103]
    buffer_load_dwordx4 v228, s[8:11], s35 offen offset:3072 sc1 lds
    v_mfma_f32_16x16x32_bf16 v[104:107], v[168:171], v[152:155], v[104:107]
    s_add_u32 s35, s35, 16384
    s_cmp_eq_u32 s35, s58
    s_cselect_b32 s35, s60, s35
    v_mfma_f32_16x16x32_bf16 v[108:111], v[172:175], v[152:155], v[108:111]
    v_mfma_f32_16x16x32_bf16 v[112:115], v[160:163], v[156:159], v[112:115]
    v_mfma_f32_16x16x32_bf16 v[116:119], v[164:167], v[156:159], v[116:119]
    v_mfma_f32_16x16x32_bf16 v[120:123], v[168:171], v[156:159], v[120:123]
    v_mfma_f32_16x16x32_bf16 v[124:127], v[172:175], v[156:159], v[124:127]
    s_sub_u32 s39, s39, 1
    s_cmp_lg_u32 s39, 0
    s_cbranch_scc1 loop_25
    s_waitcnt vmcnt(16) lgkmcnt(0)
    s_barrier
    v_mfma_f32_16x16x32_bf16 v[0:3], v[208:211], v[176:179], v[0:3]
    ds_read_b64_tr_b16 v[160:161], v234 offset:0
    v_mfma_f32_16x16x32_bf16 v[4:7], v[212:215], v[176:179], v[4:7]
    ds_read_b64_tr_b16 v[162:163], v234 offset:1024
    v_mfma_f32_16x16x32_bf16 v[8:11], v[216:219], v[176:179], v[8:11]
    ds_read_b64_tr_b16 v[164:165], v237 offset:0
    v_mfma_f32_16x16x32_bf16 v[12:15], v[220:223], v[176:179], v[12:15]
    ds_read_b64_tr_b16 v[166:167], v237 offset:1024
    s_add_u32 m0, s34, 0x8000
    v_mfma_f32_16x16x32_bf16 v[16:19], v[208:211], v[180:183], v[16:19]
    ds_read_b64_tr_b16 v[168:169], v234 offset:8192
    v_mfma_f32_16x16x32_bf16 v[20:23], v[212:215], v[180:183], v[20:23]
    s_nop 0
    v_mfma_f32_16x16x32_bf16 v[24:27], v[216:219], v[180:183], v[24:27]
    ds_read_b64_tr_b16 v[170:171], v234 offset:9216
    buffer_load_dwordx4 v224, s[12:15], s36 offen offset:0  lds
    v_mfma_f32_16x16x32_bf16 v[28:31], v[220:223], v[180:183], v[28:31]
    ds_read_b64_tr_b16 v[172:173], v237 offset:8192
    v_mfma_f32_16x16x32_bf16 v[32:35], v[208:211], v[184:187], v[32:35]
    ds_read_b64_tr_b16 v[174:175], v237 offset:9216
    buffer_load_dwordx4 v225, s[12:15], s36 offen offset:1024  lds
    v_mfma_f32_16x16x32_bf16 v[36:39], v[212:215], v[184:187], v[36:39]
    ds_read_b128 v[128:131], v231 offset:0
    v_mfma_f32_16x16x32_bf16 v[40:43], v[216:219], v[184:187], v[40:43]
    ds_read_b128 v[132:135], v231 offset:1024
    buffer_load_dwordx4 v226, s[12:15], s36 offen offset:2048  lds
    v_mfma_f32_16x16x32_bf16 v[44:47], v[220:223], v[184:187], v[44:47]
    v_mfma_f32_16x16x32_bf16 v[48:51], v[208:211], v[188:191], v[48:51]
    ds_read_b128 v[136:139], v231 offset:2048
    buffer_load_dwordx4 v227, s[12:15], s36 offen offset:3072  lds
    v_mfma_f32_16x16x32_bf16 v[52:55], v[212:215], v[188:191], v[52:55]
    ds_read_b128 v[140:143], v231 offset:3072
    v_mfma_f32_16x16x32_bf16 v[56:59], v[216:219], v[188:191], v[56:59]
    ds_read_b128 v[144:147], v231 offset:4096
    s_add_u32 s36, s36, 229376
    s_cmp_eq_u32 s36, s57
    s_cselect_b32 s36, s59, s36
    v_mfma_f32_16x16x32_bf16 v[60:63], v[220:223], v[188:191], v[60:63]
    ds_read_b128 v[148:151], v231 offset:5120
    v_mfma_f32_16x16x32_bf16 v[64:67], v[208:211], v[192:195], v[64:67]
    ds_read_b128 v[152:155], v231 offset:6144
    s_add_u32 m0, s33, 0x8000
    v_mfma_f32_16x16x32_bf16 v[68:71], v[212:215], v[192:195], v[68:71]
    s_nop 0
    v_mfma_f32_16x16x32_bf16 v[72:75], v[216:219], v[192:195], v[72:75]
    ds_read_b128 v[156:159], v231 offset:7168
    v_mfma_f32_16x16x32_bf16 v[76:79], v[220:223], v[192:195], v[76:79]
    buffer_load_dwordx4 v228, s[8:11], s35 offen offset:0 sc1 lds
    v_mfma_f32_16x16x32_bf16 v[80:83], v[208:211], v[196:199], v[80:83]
    v_mfma_f32_16x16x32_bf16 v[84:87], v[212:215], v[196:199], v[84:87]
    buffer_load_dwordx4 v228, s[8:11], s35 offen offset:1024 sc1 lds
    v_mfma_f32_16x16x32_bf16 v[88:91], v[216:219], v[196:199], v[88:91]
    v_mfma_f32_16x16x32_bf16 v[92:95], v[220:223], v[196:199], v[92:95]
    buffer_load_dwordx4 v228, s[8:11], s35 offen offset:2048 sc1 lds
    v_mfma_f32_16x16x32_bf16 v[96:99], v[208:211], v[200:203], v[96:99]
    v_mfma_f32_16x16x32_bf16 v[100:103], v[212:215], v[200:203], v[100:103]
    buffer_load_dwordx4 v228, s[8:11], s35 offen offset:3072 sc1 lds
    v_mfma_f32_16x16x32_bf16 v[104:107], v[216:219], v[200:203], v[104:107]
    s_add_u32 s35, s35, 16384
    s_cmp_eq_u32 s35, s58
    s_cselect_b32 s35, s60, s35
    v_mfma_f32_16x16x32_bf16 v[108:111], v[220:223], v[200:203], v[108:111]
    v_mfma_f32_16x16x32_bf16 v[112:115], v[208:211], v[204:207], v[112:115]
    v_mfma_f32_16x16x32_bf16 v[116:119], v[212:215], v[204:207], v[116:119]
    v_mfma_f32_16x16x32_bf16 v[120:123], v[216:219], v[204:207], v[120:123]
    v_mfma_f32_16x16x32_bf16 v[124:127], v[220:223], v[204:207], v[124:127]
    s_waitcnt vmcnt(16) lgkmcnt(0)
    s_barrier
    v_mfma_f32_16x16x32_bf16 v[0:3], v[160:163], v[128:131], v[0:3]
    ds_read_b64_tr_b16 v[208:209], v234 offset:32768
    v_mfma_f32_16x16x32_bf16 v[4:7], v[164:167], v[128:131], v[4:7]
    ds_read_b64_tr_b16 v[210:211], v234 offset:33792
    v_mfma_f32_16x16x32_bf16 v[8:11], v[168:171], v[128:131], v[8:11]
    ds_read_b64_tr_b16 v[212:213], v237 offset:32768
    v_mfma_f32_16x16x32_bf16 v[12:15], v[172:175], v[128:131], v[12:15]
    ds_read_b64_tr_b16 v[214:215], v237 offset:33792
    s_add_u32 m0, s34, 0x10000
    v_mfma_f32_16x16x32_bf16 v[16:19], v[160:163], v[132:135], v[16:19]
    ds_read_b64_tr_b16 v[216:217], v234 offset:40960
    v_mfma_f32_16x16x32_bf16 v[20:23], v[164:167], v[132:135], v[20:23]
    s_nop 0
    v_mfma_f32_16x16x32_bf16 v[24:27], v[168:171], v[132:135], v[24:27]
    ds_read_b64_tr_b16 v[218:219], v234 offset:41984
    buffer_load_dwordx4 v224, s[12:15], s36 offen offset:0  lds
    v_mfma_f32_16x16x32_bf16 v[28:31], v[172:175], v[132:135], v[28:31]
    ds_read_b64_tr_b16 v[220:221], v237 offset:40960
    v_mfma_f32_16x16x32_bf16 v[32:35], v[160:163], v[136:139], v[32:35]
    ds_read_b64_tr_b16 v[222:223], v237 offset:41984
    buffer_load_dwordx4 v225, s[12:15], s36 offen offset:1024  lds
    v_mfma_f32_16x16x32_bf16 v[36:39], v[164:167], v[136:139], v[36:39]
    ds_read_b128 v[176:179], v231 offset:32768
    v_mfma_f32_16x16x32_bf16 v[40:43], v[168:171], v[136:139], v[40:43]
    ds_read_b128 v[180:183], v231 offset:33792
    buffer_load_dwordx4 v226, s[12:15], s36 offen offset:2048  lds
    v_mfma_f32_16x16x32_bf16 v[44:47], v[172:175], v[136:139], v[44:47]
    v_mfma_f32_16x16x32_bf16 v[48:51], v[160:163], v[140:143], v[48:51]
    ds_read_b128 v[184:187], v231 offset:34816
    buffer_load_dwordx4 v227, s[12:15], s36 offen offset:3072  lds
    v_mfma_f32_16x16x32_bf16 v[52:55], v[164:167], v[140:143], v[52:55]
    ds_read_b128 v[188:191], v231 offset:35840
    v_mfma_f32_16x16x32_bf16 v[56:59], v[168:171], v[140:143], v[56:59]
    ds_read_b128 v[192:195], v231 offset:36864
    s_add_u32 s36, s36, 229376
    s_cmp_eq_u32 s36, s57
    s_cselect_b32 s36, s59, s36
    v_mfma_f32_16x16x32_bf16 v[60:63], v[172:175], v[140:143], v[60:63]
    ds_read_b128 v[196:199], v231 offset:37888
    v_mfma_f32_16x16x32_bf16 v[64:67], v[160:163], v[144:147], v[64:67]
    ds_read_b128 v[200:203], v231 offset:38912
    s_add_u32 m0, s33, 0x10000
    v_mfma_f32_16x16x32_bf16 v[68:71], v[164:167], v[144:147], v[68:71]
    s_nop 0
    v_mfma_f32_16x16x32_bf16 v[72:75], v[168:171], v[144:147], v[72:75]
    ds_read_b128 v[204:207], v231 offset:39936
    v_mfma_f32_16x16x32_bf16 v[76:79], v[172:175], v[144:147], v[76:79]
    buffer_load_dwordx4 v228, s[8:11], s35 offen offset:0 sc1 lds
    v_mfma_f32_16x16x32_bf16 v[80:83], v[160:163], v[148:151], v[80:83]
    v_mfma_f32_16x16x32_bf16 v[84:87], v[164:167], v[148:151], v[84:87]
    buffer_load_dwordx4 v228, s[8:11], s35 offen offset:1024 sc1 lds
    v_mfma_f32_16x16x32_bf16 v[88:91], v[168:171], v[148:151], v[88:91]
    v_mfma_f32_16x16x32_bf16 v[92:95], v[172:175], v[148:151], v[92:95]
    buffer_load_dwordx4 v228, s[8:11], s35 offen offset:2048 sc1 lds
    v_mfma_f32_16x16x32_bf16 v[96:99], v[160:163], v[152:155], v[96:99]
    v_mfma_f32_16x16x32_bf16 v[100:103], v[164:167], v[152:155], v[100:103]
    buffer_load_dwordx4 v228, s[8:11], s35 offen offset:3072 sc1 lds
    v_mfma_f32_16x16x32_bf16 v[104:107], v[168:171], v[152:155], v[104:107]
    s_add_u32 s35, s35, 16384
    s_cmp_eq_u32 s35, s58
    s_cselect_b32 s35, s60, s35
    v_mfma_f32_16x16x32_bf16 v[108:111], v[172:175], v[152:155], v[108:111]
    v_mfma_f32_16x16x32_bf16 v[112:115], v[160:163], v[156:159], v[112:115]
    v_mfma_f32_16x16x32_bf16 v[116:119], v[164:167], v[156:159], v[116:119]
    v_mfma_f32_16x16x32_bf16 v[120:123], v[168:171], v[156:159], v[120:123]
    v_mfma_f32_16x16x32_bf16 v[124:127], v[172:175], v[156:159], v[124:127]
    s_waitcnt vmcnt(16) lgkmcnt(0)
    s_barrier
    v_mfma_f32_16x16x32_bf16 v[0:3], v[208:211], v[176:179], v[0:3]
    ds_read_b64_tr_b16 v[160:161], v233 offset:0
    v_mfma_f32_16x16x32_bf16 v[4:7], v[212:215], v[176:179], v[4:7]
    ds_read_b64_tr_b16 v[162:163], v233 offset:1024
    v_mfma_f32_16x16x32_bf16 v[8:11], v[216:219], v[176:179], v[8:11]
    ds_read_b64_tr_b16 v[164:165], v236 offset:0
    v_mfma_f32_16x16x32_bf16 v[12:15], v[220:223], v[176:179], v[12:15]
    ds_read_b64_tr_b16 v[166:167], v236 offset:1024
    s_add_u32 m0, s34, 0x18000
    v_mfma_f32_16x16x32_bf16 v[16:19], v[208:211], v[180:183], v[16:19]
    ds_read_b64_tr_b16 v[168:169], v233 offset:8192
    v_mfma_f32_16x16x32_bf16 v[20:23], v[212:215], v[180:183], v[20:23]
    s_nop 0
    v_mfma_f32_16x16x32_bf16 v[24:27], v[216:219], v[180:183], v[24:27]
    ds_read_b64_tr_b16 v[170:171], v233 offset:9216
    buffer_load_dwordx4 v224, s[12:15], s36 offen offset:0  lds
    v_mfma_f32_16x16x32_bf16 v[28:31], v[220:223], v[180:183], v[28:31]
    ds_read_b64_tr_b16 v[172:173], v236 offset:8192
    v_mfma_f32_16x16x32_bf16 v[32:35], v[208:211], v[184:187], v[32:35]
    ds_read_b64_tr_b16 v[174:175], v236 offset:9216
    buffer_load_dwordx4 v225, s[12:15], s36 offen offset:1024  lds
    v_mfma_f32_16x16x32_bf16 v[36:39], v[212:215], v[184:187], v[36:39]
    ds_read_b128 v[128:131], v230 offset:0
    v_mfma_f32_16x16x32_bf16 v[40:43], v[216:219], v[184:187], v[40:43]
    ds_read_b128 v[132:135], v230 offset:1024
    buffer_load_dwordx4 v226, s[12:15], s36 offen offset:2048  lds
    v_mfma_f32_16x16x32_bf16 v[44:47], v[220:223], v[184:187], v[44:47]
    v_mfma_f32_16x16x32_bf16 v[48:51], v[208:211], v[188:191], v[48:51]
    ds_read_b128 v[136:139], v230 offset:2048
    buffer_load_dwordx4 v227, s[12:15], s36 offen offset:3072  lds
    v_mfma_f32_16x16x32_bf16 v[52:55], v[212:215], v[188:191], v[52:55]
    ds_read_b128 v[140:143], v230 offset:3072
    v_mfma_f32_16x16x32_bf16 v[56:59], v[216:219], v[188:191], v[56:59]
    ds_read_b128 v[144:147], v230 offset:4096
    s_add_u32 s36, s36, 229376
    s_cmp_eq_u32 s36, s57
    s_cselect_b32 s36, s59, s36
    v_mfma_f32_16x16x32_bf16 v[60:63], v[220:223], v[188:191], v[60:63]
    ds_read_b128 v[148:151], v230 offset:5120
    v_mfma_f32_16x16x32_bf16 v[64:67], v[208:211], v[192:195], v[64:67]
    ds_read_b128 v[152:155], v230 offset:6144
    s_add_u32 m0, s33, 0x18000
    v_mfma_f32_16x16x32_bf16 v[68:71], v[212:215], v[192:195], v[68:71]
    s_nop 0
    v_mfma_f32_16x16x32_bf16 v[72:75], v[216:219], v[192:195], v[72:75]
    ds_read_b128 v[156:159], v230 offset:7168
    v_mfma_f32_16x16x32_bf16 v[76:79], v[220:223], v[192:195], v[76:79]
    buffer_load_dwordx4 v228, s[8:11], s35 offen offset:0 sc1 lds
    v_mfma_f32_16x16x32_bf16 v[80:83], v[208:211], v[196:199], v[80:83]
    v_mfma_f32_16x16x32_bf16 v[84:87], v[212:215], v[196:199], v[84:87]
    buffer_load_dwordx4 v228, s[8:11], s35 offen offset:1024 sc1 lds
    v_mfma_f32_16x16x32_bf16 v[88:91], v[216:219], v[196:199], v[88:91]
    v_mfma_f32_16x16x32_bf16 v[92:95], v[220:223], v[196:199], v[92:95]
    buffer_load_dwordx4 v228, s[8:11], s35 offen offset:2048 sc1 lds
    v_mfma_f32_16x16x32_bf16 v[96:99], v[208:211], v[200:203], v[96:99]
    v_mfma_f32_16x16x32_bf16 v[100:103], v[212:215], v[200:203], v[100:103]
    buffer_load_dwordx4 v228, s[8:11], s35 offen offset:3072 sc1 lds
    v_mfma_f32_16x16x32_bf16 v[104:107], v[216:219], v[200:203], v[104:107]
    s_add_u32 s35, s35, 16384
    s_cmp_eq_u32 s35, s58
    s_cselect_b32 s35, s60, s35
    v_mfma_f32_16x16x32_bf16 v[108:111], v[220:223], v[200:203], v[108:111]
    v_mfma_f32_16x16x32_bf16 v[112:115], v[208:211], v[204:207], v[112:115]
    v_mfma_f32_16x16x32_bf16 v[116:119], v[212:215], v[204:207], v[116:119]
    v_mfma_f32_16x16x32_bf16 v[120:123], v[216:219], v[204:207], v[120:123]
    v_mfma_f32_16x16x32_bf16 v[124:127], v[220:223], v[204:207], v[124:127]
    s_waitcnt vmcnt(16) lgkmcnt(0)
    s_barrier
    v_mfma_f32_16x16x32_bf16 v[0:3], v[160:163], v[128:131], v[0:3]
    ds_read_b64_tr_b16 v[208:209], v233 offset:32768
    v_mfma_f32_16x16x32_bf16 v[4:7], v[164:167], v[128:131], v[4:7]
    ds_read_b64_tr_b16 v[210:211], v233 offset:33792
    v_mfma_f32_16x16x32_bf16 v[8:11], v[168:171], v[128:131], v[8:11]
    ds_read_b64_tr_b16 v[212:213], v236 offset:32768
    v_mfma_f32_16x16x32_bf16 v[12:15], v[172:175], v[128:131], v[12:15]
    ds_read_b64_tr_b16 v[214:215], v236 offset:33792
    v_mfma_f32_16x16x32_bf16 v[16:19], v[160:163], v[132:135], v[16:19]
    ds_read_b64_tr_b16 v[216:217], v233 offset:40960
    v_mfma_f32_16x16x32_bf16 v[20:23], v[164:167], v[132:135], v[20:23]
    v_mfma_f32_16x16x32_bf16 v[24:27], v[168:171], v[132:135], v[24:27]
    ds_read_b64_tr_b16 v[218:219], v233 offset:41984
    v_mfma_f32_16x16x32_bf16 v[28:31], v[172:175], v[132:135], v[28:31]
    ds_read_b64_tr_b16 v[220:221], v236 offset:40960
    v_mfma_f32_16x16x32_bf16 v[32:35], v[160:163], v[136:139], v[32:35]
    ds_read_b64_tr_b16 v[222:223], v236 offset:41984
    v_mfma_f32_16x16x32_bf16 v[36:39], v[164:167], v[136:139], v[36:39]
    ds_read_b128 v[176:179], v230 offset:32768
    v_mfma_f32_16x16x32_bf16 v[40:43], v[168:171], v[136:139], v[40:43]
    ds_read_b128 v[180:183], v230 offset:33792
    v_mfma_f32_16x16x32_bf16 v[44:47], v[172:175], v[136:139], v[44:47]
    v_mfma_f32_16x16x32_bf16 v[48:51], v[160:163], v[140:143], v[48:51]
    ds_read_b128 v[184:187], v230 offset:34816
    v_mfma_f32_16x16x32_bf16 v[52:55], v[164:167], v[140:143], v[52:55]
    ds_read_b128 v[188:191], v230 offset:35840
    v_mfma_f32_16x16x32_bf16 v[56:59], v[168:171], v[140:143], v[56:59]
    ds_read_b128 v[192:195], v230 offset:36864
    v_mfma_f32_16x16x32_bf16 v[60:63], v[172:175], v[140:143], v[60:63]
    ds_read_b128 v[196:199], v230 offset:37888
    v_mfma_f32_16x16x32_bf16 v[64:67], v[160:163], v[144:147], v[64:67]
    ds_read_b128 v[200:203], v230 offset:38912
    v_mfma_f32_16x16x32_bf16 v[68:71], v[164:167], v[144:147], v[68:71]
    v_mfma_f32_16x16x32_bf16 v[72:75], v[168:171], v[144:147], v[72:75]
    ds_read_b128 v[204:207], v230 offset:39936
    v_mfma_f32_16x16x32_bf16 v[76:79], v[172:175], v[144:147], v[76:79]
    v_mfma_f32_16x16x32_bf16 v[80:83], v[160:163], v[148:151], v[80:83]
    v_mfma_f32_16x16x32_bf16 v[84:87], v[164:167], v[148:151], v[84:87]
    v_mfma_f32_16x16x32_bf16 v[88:91], v[168:171], v[148:151], v[88:91]
    v_mfma_f32_16x16x32_bf16 v[92:95], v[172:175], v[148:151], v[92:95]
    v_mfma_f32_16x16x32_bf16 v[96:99], v[160:163], v[152:155], v[96:99]
    v_mfma_f32_16x16x32_bf16 v[100:103], v[164:167], v[152:155], v[100:103]
    v_mfma_f32_16x16x32_bf16 v[104:107], v[168:171], v[152:155], v[104:107]
    v_mfma_f32_16x16x32_bf16 v[108:111], v[172:175], v[152:155], v[108:111]
    v_mfma_f32_16x16x32_bf16 v[112:115], v[160:163], v[156:159], v[112:115]
    v_mfma_f32_16x16x32_bf16 v[116:119], v[164:167], v[156:159], v[116:119]
    v_mfma_f32_16x16x32_bf16 v[120:123], v[168:171], v[156:159], v[120:123]
    v_mfma_f32_16x16x32_bf16 v[124:127], v[172:175], v[156:159], v[124:127]
    s_waitcnt vmcnt(0) lgkmcnt(0)
    s_barrier
    v_mfma_f32_16x16x32_bf16 v[0:3], v[208:211], v[176:179], v[0:3]
    ds_read_b64_tr_b16 v[160:161], v234 offset:0
    v_mfma_f32_16x16x32_bf16 v[4:7], v[212:215], v[176:179], v[4:7]
    ds_read_b64_tr_b16 v[162:163], v234 offset:1024
    v_mfma_f32_16x16x32_bf16 v[8:11], v[216:219], v[176:179], v[8:11]
    ds_read_b64_tr_b16 v[164:165], v237 offset:0
    v_mfma_f32_16x16x32_bf16 v[12:15], v[220:223], v[176:179], v[12:15]
    ds_read_b64_tr_b16 v[166:167], v237 offset:1024
    v_mfma_f32_16x16x32_bf16 v[16:19], v[208:211], v[180:183], v[16:19]
    ds_read_b64_tr_b16 v[168:169], v234 offset:8192
    v_mfma_f32_16x16x32_bf16 v[20:23], v[212:215], v[180:183], v[20:23]
    v_mfma_f32_16x16x32_bf16 v[24:27], v[216:219], v[180:183], v[24:27]
    ds_read_b64_tr_b16 v[170:171], v234 offset:9216
    v_mfma_f32_16x16x32_bf16 v[28:31], v[220:223], v[180:183], v[28:31]
    ds_read_b64_tr_b16 v[172:173], v237 offset:8192
    v_mfma_f32_16x16x32_bf16 v[32:35], v[208:211], v[184:187], v[32:35]
    ds_read_b64_tr_b16 v[174:175], v237 offset:9216
    v_mfma_f32_16x16x32_bf16 v[36:39], v[212:215], v[184:187], v[36:39]
    ds_read_b128 v[128:131], v231 offset:0
    v_mfma_f32_16x16x32_bf16 v[40:43], v[216:219], v[184:187], v[40:43]
    ds_read_b128 v[132:135], v231 offset:1024
    v_mfma_f32_16x16x32_bf16 v[44:47], v[220:223], v[184:187], v[44:47]
    v_mfma_f32_16x16x32_bf16 v[48:51], v[208:211], v[188:191], v[48:51]
    ds_read_b128 v[136:139], v231 offset:2048
    v_mfma_f32_16x16x32_bf16 v[52:55], v[212:215], v[188:191], v[52:55]
    ds_read_b128 v[140:143], v231 offset:3072
    v_mfma_f32_16x16x32_bf16 v[56:59], v[216:219], v[188:191], v[56:59]
    ds_read_b128 v[144:147], v231 offset:4096
    v_mfma_f32_16x16x32_bf16 v[60:63], v[220:223], v[188:191], v[60:63]
    ds_read_b128 v[148:151], v231 offset:5120
    v_mfma_f32_16x16x32_bf16 v[64:67], v[208:211], v[192:195], v[64:67]
    ds_read_b128 v[152:155], v231 offset:6144
    v_mfma_f32_16x16x32_bf16 v[68:71], v[212:215], v[192:195], v[68:71]
    v_mfma_f32_16x16x32_bf16 v[72:75], v[216:219], v[192:195], v[72:75]
    ds_read_b128 v[156:159], v231 offset:7168
    v_mfma_f32_16x16x32_bf16 v[76:79], v[220:223], v[192:195], v[76:79]
    v_mfma_f32_16x16x32_bf16 v[80:83], v[208:211], v[196:199], v[80:83]
    v_mfma_f32_16x16x32_bf16 v[84:87], v[212:215], v[196:199], v[84:87]
    v_mfma_f32_16x16x32_bf16 v[88:91], v[216:219], v[196:199], v[88:91]
    v_mfma_f32_16x16x32_bf16 v[92:95], v[220:223], v[196:199], v[92:95]
    v_mfma_f32_16x16x32_bf16 v[96:99], v[208:211], v[200:203], v[96:99]
    v_mfma_f32_16x16x32_bf16 v[100:103], v[212:215], v[200:203], v[100:103]
    v_mfma_f32_16x16x32_bf16 v[104:107], v[216:219], v[200:203], v[104:107]
    v_mfma_f32_16x16x32_bf16 v[108:111], v[220:223], v[200:203], v[108:111]
    v_mfma_f32_16x16x32_bf16 v[112:115], v[208:211], v[204:207], v[112:115]
    v_mfma_f32_16x16x32_bf16 v[116:119], v[212:215], v[204:207], v[116:119]
    v_mfma_f32_16x16x32_bf16 v[120:123], v[216:219], v[204:207], v[120:123]
    v_mfma_f32_16x16x32_bf16 v[124:127], v[220:223], v[204:207], v[124:127]
    s_waitcnt lgkmcnt(0)
    v_mfma_f32_16x16x32_bf16 v[0:3], v[160:163], v[128:131], v[0:3]
    ds_read_b64_tr_b16 v[208:209], v234 offset:32768
    v_mfma_f32_16x16x32_bf16 v[4:7], v[164:167], v[128:131], v[4:7]
    ds_read_b64_tr_b16 v[210:211], v234 offset:33792
    v_mfma_f32_16x16x32_bf16 v[8:11], v[168:171], v[128:131], v[8:11]
    ds_read_b64_tr_b16 v[212:213], v237 offset:32768
    v_mfma_f32_16x16x32_bf16 v[12:15], v[172:175], v[128:131], v[12:15]
    ds_read_b64_tr_b16 v[214:215], v237 offset:33792
    v_mfma_f32_16x16x32_bf16 v[16:19], v[160:163], v[132:135], v[16:19]
    ds_read_b64_tr_b16 v[216:217], v234 offset:40960
    v_mfma_f32_16x16x32_bf16 v[20:23], v[164:167], v[132:135], v[20:23]
    v_mfma_f32_16x16x32_bf16 v[24:27], v[168:171], v[132:135], v[24:27]
    ds_read_b64_tr_b16 v[218:219], v234 offset:41984
    v_mfma_f32_16x16x32_bf16 v[28:31], v[172:175], v[132:135], v[28:31]
    ds_read_b64_tr_b16 v[220:221], v237 offset:40960
    v_mfma_f32_16x16x32_bf16 v[32:35], v[160:163], v[136:139], v[32:35]
    ds_read_b64_tr_b16 v[222:223], v237 offset:41984
    v_mfma_f32_16x16x32_bf16 v[36:39], v[164:167], v[136:139], v[36:39]
    ds_read_b128 v[176:179], v231 offset:32768
    v_mfma_f32_16x16x32_bf16 v[40:43], v[168:171], v[136:139], v[40:43]
    ds_read_b128 v[180:183], v231 offset:33792
    v_mfma_f32_16x16x32_bf16 v[44:47], v[172:175], v[136:139], v[44:47]
    v_mfma_f32_16x16x32_bf16 v[48:51], v[160:163], v[140:143], v[48:51]
    ds_read_b128 v[184:187], v231 offset:34816
    v_mfma_f32_16x16x32_bf16 v[52:55], v[164:167], v[140:143], v[52:55]
    ds_read_b128 v[188:191], v231 offset:35840
    v_mfma_f32_16x16x32_bf16 v[56:59], v[168:171], v[140:143], v[56:59]
    ds_read_b128 v[192:195], v231 offset:36864
    v_mfma_f32_16x16x32_bf16 v[60:63], v[172:175], v[140:143], v[60:63]
    ds_read_b128 v[196:199], v231 offset:37888
    v_mfma_f32_16x16x32_bf16 v[64:67], v[160:163], v[144:147], v[64:67]
    ds_read_b128 v[200:203], v231 offset:38912
    v_mfma_f32_16x16x32_bf16 v[68:71], v[164:167], v[144:147], v[68:71]
    v_mfma_f32_16x16x32_bf16 v[72:75], v[168:171], v[144:147], v[72:75]
    ds_read_b128 v[204:207], v231 offset:39936
    v_mfma_f32_16x16x32_bf16 v[76:79], v[172:175], v[144:147], v[76:79]
    v_mfma_f32_16x16x32_bf16 v[80:83], v[160:163], v[148:151], v[80:83]
    v_mfma_f32_16x16x32_bf16 v[84:87], v[164:167], v[148:151], v[84:87]
    v_mfma_f32_16x16x32_bf16 v[88:91], v[168:171], v[148:151], v[88:91]
    v_mfma_f32_16x16x32_bf16 v[92:95], v[172:175], v[148:151], v[92:95]
    v_mfma_f32_16x16x32_bf16 v[96:99], v[160:163], v[152:155], v[96:99]
    v_mfma_f32_16x16x32_bf16 v[100:103], v[164:167], v[152:155], v[100:103]
    v_mfma_f32_16x16x32_bf16 v[104:107], v[168:171], v[152:155], v[104:107]
    v_mfma_f32_16x16x32_bf16 v[108:111], v[172:175], v[152:155], v[108:111]
    v_mfma_f32_16x16x32_bf16 v[112:115], v[160:163], v[156:159], v[112:115]
    v_mfma_f32_16x16x32_bf16 v[116:119], v[164:167], v[156:159], v[116:119]
    v_mfma_f32_16x16x32_bf16 v[120:123], v[168:171], v[156:159], v[120:123]
    v_mfma_f32_16x16x32_bf16 v[124:127], v[172:175], v[156:159], v[124:127]
    s_waitcnt lgkmcnt(0)
    v_mfma_f32_16x16x32_bf16 v[0:3], v[208:211], v[176:179], v[0:3]
    v_mfma_f32_16x16x32_bf16 v[4:7], v[212:215], v[176:179], v[4:7]
    v_mfma_f32_16x16x32_bf16 v[8:11], v[216:219], v[176:179], v[8:11]
    v_mfma_f32_16x16x32_bf16 v[12:15], v[220:223], v[176:179], v[12:15]
    v_mfma_f32_16x16x32_bf16 v[16:19], v[208:211], v[180:183], v[16:19]
    v_mfma_f32_16x16x32_bf16 v[20:23], v[212:215], v[180:183], v[20:23]
    v_mfma_f32_16x16x32_bf16 v[24:27], v[216:219], v[180:183], v[24:27]
    v_mfma_f32_16x16x32_bf16 v[28:31], v[220:223], v[180:183], v[28:31]
    v_mfma_f32_16x16x32_bf16 v[32:35], v[208:211], v[184:187], v[32:35]
    v_mfma_f32_16x16x32_bf16 v[36:39], v[212:215], v[184:187], v[36:39]
    v_mfma_f32_16x16x32_bf16 v[40:43], v[216:219], v[184:187], v[40:43]
    v_mfma_f32_16x16x32_bf16 v[44:47], v[220:223], v[184:187], v[44:47]
    v_mfma_f32_16x16x32_bf16 v[48:51], v[208:211], v[188:191], v[48:51]
    v_mfma_f32_16x16x32_bf16 v[52:55], v[212:215], v[188:191], v[52:55]
    v_mfma_f32_16x16x32_bf16 v[56:59], v[216:219], v[188:191], v[56:59]
    v_mfma_f32_16x16x32_bf16 v[60:63], v[220:223], v[188:191], v[60:63]
    v_mfma_f32_16x16x32_bf16 v[64:67], v[208:211], v[192:195], v[64:67]
    v_mfma_f32_16x16x32_bf16 v[68:71], v[212:215], v[192:195], v[68:71]
    v_mfma_f32_16x16x32_bf16 v[72:75], v[216:219], v[192:195], v[72:75]
    v_mfma_f32_16x16x32_bf16 v[76:79], v[220:223], v[192:195], v[76:79]
    v_mfma_f32_16x16x32_bf16 v[80:83], v[208:211], v[196:199], v[80:83]
    v_mfma_f32_16x16x32_bf16 v[84:87], v[212:215], v[196:199], v[84:87]
    v_mfma_f32_16x16x32_bf16 v[88:91], v[216:219], v[196:199], v[88:91]
    v_mfma_f32_16x16x32_bf16 v[92:95], v[220:223], v[196:199], v[92:95]
    v_mfma_f32_16x16x32_bf16 v[96:99], v[208:211], v[200:203], v[96:99]
    v_mfma_f32_16x16x32_bf16 v[100:103], v[212:215], v[200:203], v[100:103]
    v_mfma_f32_16x16x32_bf16 v[104:107], v[216:219], v[200:203], v[104:107]
    v_mfma_f32_16x16x32_bf16 v[108:111], v[220:223], v[200:203], v[108:111]
    v_mfma_f32_16x16x32_bf16 v[112:115], v[208:211], v[204:207], v[112:115]
    v_mfma_f32_16x16x32_bf16 v[116:119], v[212:215], v[204:207], v[116:119]
    v_mfma_f32_16x16x32_bf16 v[120:123], v[216:219], v[204:207], v[120:123]
    v_mfma_f32_16x16x32_bf16 v[124:127], v[220:223], v[204:207], v[124:127]
    s_branch ka_epi_4
ka_pf_3:
    s_barrier
    ds_read_b64_tr_b16 v[160:161], v233 offset:0
    ds_read_b64_tr_b16 v[162:163], v233 offset:1024
    ds_read_b64_tr_b16 v[164:165], v236 offset:0
    ds_read_b64_tr_b16 v[166:167], v236 offset:1024
    ds_read_b64_tr_b16 v[168:169], v233 offset:8192
    ds_read_b64_tr_b16 v[170:171], v233 offset:9216
    ds_read_b64_tr_b16 v[172:173], v236 offset:8192
    ds_read_b64_tr_b16 v[174:175], v236 offset:9216
    ds_read_b128 v[128:131], v230 offset:0
    ds_read_b128 v[132:135], v230 offset:1024
    ds_read_b128 v[136:139], v230 offset:2048
    ds_read_b128 v[140:143], v230 offset:3072
    ds_read_b128 v[144:147], v230 offset:4096
    ds_read_b128 v[148:151], v230 offset:5120
    ds_read_b128 v[152:155], v230 offset:6144
    ds_read_b128 v[156:159], v230 offset:7168
    s_waitcnt lgkmcnt(0)
    s_barrier
    v_mfma_f32_16x16x32_bf16 v[0:3], v[160:163], v[128:131], 0
    ds_read_b64_tr_b16 v[208:209], v233 offset:32768
    v_mfma_f32_16x16x32_bf16 v[4:7], v[164:167], v[128:131], 0
    ds_read_b64_tr_b16 v[210:211], v233 offset:33792
    v_mfma_f32_16x16x32_bf16 v[8:11], v[168:171], v[128:131], 0
    ds_read_b64_tr_b16 v[212:213], v236 offset:32768
    v_mfma_f32_16x16x32_bf16 v[12:15], v[172:175], v[128:131], 0
    ds_read_b64_tr_b16 v[214:215], v236 offset:33792
    v_mfma_f32_16x16x32_bf16 v[16:19], v[160:163], v[132:135], 0
    ds_read_b64_tr_b16 v[216:217], v233 offset:40960
    v_mfma_f32_16x16x32_bf16 v[20:23], v[164:167], v[132:135], 0
    v_mfma_f32_16x16x32_bf16 v[24:27], v[168:171], v[132:135], 0
    ds_read_b64_tr_b16 v[218:219], v233 offset:41984
    v_mfma_f32_16x16x32_bf16 v[28:31], v[172:175], v[132:135], 0
    ds_read_b64_tr_b16 v[220:221], v236 offset:40960
    v_mfma_f32_16x16x32_bf16 v[32:35], v[160:163], v[136:139], 0
    ds_read_b64_tr_b16 v[222:223], v236 offset:41984
    v_mfma_f32_16x16x32_bf16 v[36:39], v[164:167], v[136:139], 0
    ds_read_b128 v[176:179], v230 offset:32768
    v_mfma_f32_16x16x32_bf16 v[40:43], v[168:171], v[136:139], 0
    ds_read_b128 v[180:183], v230 offset:33792
    v_mfma_f32_16x16x32_bf16 v[44:47], v[172:175], v[136:139], 0
    v_mfma_f32_16x16x32_bf16 v[48:51], v[160:163], v[140:143], 0
    ds_read_b128 v[184:187], v230 offset:34816
    v_mfma_f32_16x16x32_bf16 v[52:55], v[164:167], v[140:143], 0
    ds_read_b128 v[188:191], v230 offset:35840
    v_mfma_f32_16x16x32_bf16 v[56:59], v[168:171], v[140:143], 0
    ds_read_b128 v[192:195], v230 offset:36864
    v_mfma_f32_16x16x32_bf16 v[60:63], v[172:175], v[140:143], 0
    ds_read_b128 v[196:199], v230 offset:37888
    v_mfma_f32_16x16x32_bf16 v[64:67], v[160:163], v[144:147], 0
    ds_read_b128 v[200:203], v230 offset:38912
    v_mfma_f32_16x16x32_bf16 v[68:71], v[164:167], v[144:147], 0
    v_mfma_f32_16x16x32_bf16 v[72:75], v[168:171], v[144:147], 0
    ds_read_b128 v[204:207], v230 offset:39936
    v_mfma_f32_16x16x32_bf16 v[76:79], v[172:175], v[144:147], 0
    v_mfma_f32_16x16x32_bf16 v[80:83], v[160:163], v[148:151], 0
    v_mfma_f32_16x16x32_bf16 v[84:87], v[164:167], v[148:151], 0
    v_mfma_f32_16x16x32_bf16 v[88:91], v[168:171], v[148:151], 0
    v_mfma_f32_16x16x32_bf16 v[92:95], v[172:175], v[148:151], 0
    v_mfma_f32_16x16x32_bf16 v[96:99], v[160:163], v[152:155], 0
    v_mfma_f32_16x16x32_bf16 v[100:103], v[164:167], v[152:155], 0
    v_mfma_f32_16x16x32_bf16 v[104:107], v[168:171], v[152:155], 0
    v_mfma_f32_16x16x32_bf16 v[108:111], v[172:175], v[152:155], 0
    v_mfma_f32_16x16x32_bf16 v[112:115], v[160:163], v[156:159], 0
    v_mfma_f32_16x16x32_bf16 v[116:119], v[164:167], v[156:159], 0
    v_mfma_f32_16x16x32_bf16 v[120:123], v[168:171], v[156:159], 0
    v_mfma_f32_16x16x32_bf16 v[124:127], v[172:175], v[156:159], 0
    s_waitcnt vmcnt(0)
    s_waitcnt lgkmcnt(0)
    s_barrier
    s_cmp_lg_u32 s30, 4
    s_cbranch_scc1 ka_yf_26
    s_add_u32 s26, s81, 1024
    s_lshl_b32 s26, s26, 7
    v_mov_b32 v240, s50
    v_mov_b32 v241, s51
    v_mov_b32 v242, s26
    s_mov_b64 exec, 1
    global_store_dwordx2 v242, v[240:241], s[52:53] sc1
    s_mov_b64 exec, -1
ka_yf_26:
    v_mfma_f32_16x16x32_bf16 v[0:3], v[208:211], v[176:179], v[0:3]
    ds_read_b64_tr_b16 v[160:161], v234 offset:0
    v_mfma_f32_16x16x32_bf16 v[4:7], v[212:215], v[176:179], v[4:7]
    ds_read_b64_tr_b16 v[162:163], v234 offset:1024
    v_mfma_f32_16x16x32_bf16 v[8:11], v[216:219], v[176:179], v[8:11]
    ds_read_b64_tr_b16 v[164:165], v237 offset:0
    v_mfma_f32_16x16x32_bf16 v[12:15], v[220:223], v[176:179], v[12:15]
    ds_read_b64_tr_b16 v[166:167], v237 offset:1024
    v_mfma_f32_16x16x32_bf16 v[16:19], v[208:211], v[180:183], v[16:19]
    ds_read_b64_tr_b16 v[168:169], v234 offset:8192
    v_mfma_f32_16x16x32_bf16 v[20:23], v[212:215], v[180:183], v[20:23]
    v_mfma_f32_16x16x32_bf16 v[24:27], v[216:219], v[180:183], v[24:27]
    ds_read_b64_tr_b16 v[170:171], v234 offset:9216
    v_mfma_f32_16x16x32_bf16 v[28:31], v[220:223], v[180:183], v[28:31]
    ds_read_b64_tr_b16 v[172:173], v237 offset:8192
    v_mfma_f32_16x16x32_bf16 v[32:35], v[208:211], v[184:187], v[32:35]
    ds_read_b64_tr_b16 v[174:175], v237 offset:9216
    v_mfma_f32_16x16x32_bf16 v[36:39], v[212:215], v[184:187], v[36:39]
    ds_read_b128 v[128:131], v231 offset:0
    v_mfma_f32_16x16x32_bf16 v[40:43], v[216:219], v[184:187], v[40:43]
    ds_read_b128 v[132:135], v231 offset:1024
    v_mfma_f32_16x16x32_bf16 v[44:47], v[220:223], v[184:187], v[44:47]
    v_mfma_f32_16x16x32_bf16 v[48:51], v[208:211], v[188:191], v[48:51]
    ds_read_b128 v[136:139], v231 offset:2048
    v_mfma_f32_16x16x32_bf16 v[52:55], v[212:215], v[188:191], v[52:55]
    ds_read_b128 v[140:143], v231 offset:3072
    v_mfma_f32_16x16x32_bf16 v[56:59], v[216:219], v[188:191], v[56:59]
    ds_read_b128 v[144:147], v231 offset:4096
    v_mfma_f32_16x16x32_bf16 v[60:63], v[220:223], v[188:191], v[60:63]
    ds_read_b128 v[148:151], v231 offset:5120
    v_mfma_f32_16x16x32_bf16 v[64:67], v[208:211], v[192:195], v[64:67]
    ds_read_b128 v[152:155], v231 offset:6144
    v_mfma_f32_16x16x32_bf16 v[68:71], v[212:215], v[192:195], v[68:71]
    v_mfma_f32_16x16x32_bf16 v[72:75], v[216:219], v[192:195], v[72:75]
    ds_read_b128 v[156:159], v231 offset:7168
    v_mfma_f32_16x16x32_bf16 v[76:79], v[220:223], v[192:195], v[76:79]
    v_mfma_f32_16x16x32_bf16 v[80:83], v[208:211], v[196:199], v[80:83]
    v_mfma_f32_16x16x32_bf16 v[84:87], v[212:215], v[196:199], v[84:87]
    v_mfma_f32_16x16x32_bf16 v[88:91], v[216:219], v[196:199], v[88:91]
    v_mfma_f32_16x16x32_bf16 v[92:95], v[220:223], v[196:199], v[92:95]
    v_mfma_f32_16x16x32_bf16 v[96:99], v[208:211], v[200:203], v[96:99]
    v_mfma_f32_16x16x32_bf16 v[100:103], v[212:215], v[200:203], v[100:103]
    v_mfma_f32_16x16x32_bf16 v[104:107], v[216:219], v[200:203], v[104:107]
    v_mfma_f32_16x16x32_bf16 v[108:111], v[220:223], v[200:203], v[108:111]
    v_mfma_f32_16x16x32_bf16 v[112:115], v[208:211], v[204:207], v[112:115]
    v_mfma_f32_16x16x32_bf16 v[116:119], v[212:215], v[204:207], v[116:119]
    v_mfma_f32_16x16x32_bf16 v[120:123], v[216:219], v[204:207], v[120:123]
    v_mfma_f32_16x16x32_bf16 v[124:127], v[220:223], v[204:207], v[124:127]
    s_waitcnt lgkmcnt(0)
    s_barrier
    v_mfma_f32_16x16x32_bf16 v[0:3], v[160:163], v[128:131], v[0:3]
    ds_read_b64_tr_b16 v[208:209], v234 offset:32768
    v_mfma_f32_16x16x32_bf16 v[4:7], v[164:167], v[128:131], v[4:7]
    ds_read_b64_tr_b16 v[210:211], v234 offset:33792
    v_mfma_f32_16x16x32_bf16 v[8:11], v[168:171], v[128:131], v[8:11]
    ds_read_b64_tr_b16 v[212:213], v237 offset:32768
    v_mfma_f32_16x16x32_bf16 v[12:15], v[172:175], v[128:131], v[12:15]
    ds_read_b64_tr_b16 v[214:215], v237 offset:33792
    v_mfma_f32_16x16x32_bf16 v[16:19], v[160:163], v[132:135], v[16:19]
    ds_read_b64_tr_b16 v[216:217], v234 offset:40960
    v_mfma_f32_16x16x32_bf16 v[20:23], v[164:167], v[132:135], v[20:23]
    v_mfma_f32_16x16x32_bf16 v[24:27], v[168:171], v[132:135], v[24:27]
    ds_read_b64_tr_b16 v[218:219], v234 offset:41984
    v_mfma_f32_16x16x32_bf16 v[28:31], v[172:175], v[132:135], v[28:31]
    ds_read_b64_tr_b16 v[220:221], v237 offset:40960
    v_mfma_f32_16x16x32_bf16 v[32:35], v[160:163], v[136:139], v[32:35]
    ds_read_b64_tr_b16 v[222:223], v237 offset:41984
    v_mfma_f32_16x16x32_bf16 v[36:39], v[164:167], v[136:139], v[36:39]
    ds_read_b128 v[176:179], v231 offset:32768
    v_mfma_f32_16x16x32_bf16 v[40:43], v[168:171], v[136:139], v[40:43]
    ds_read_b128 v[180:183], v231 offset:33792
    v_mfma_f32_16x16x32_bf16 v[44:47], v[172:175], v[136:139], v[44:47]
    v_mfma_f32_16x16x32_bf16 v[48:51], v[160:163], v[140:143], v[48:51]
    ds_read_b128 v[184:187], v231 offset:34816
    v_mfma_f32_16x16x32_bf16 v[52:55], v[164:167], v[140:143], v[52:55]
    ds_read_b128 v[188:191], v231 offset:35840
    v_mfma_f32_16x16x32_bf16 v[56:59], v[168:171], v[140:143], v[56:59]
    ds_read_b128 v[192:195], v231 offset:36864
    v_mfma_f32_16x16x32_bf16 v[60:63], v[172:175], v[140:143], v[60:63]
    ds_read_b128 v[196:199], v231 offset:37888
    v_mfma_f32_16x16x32_bf16 v[64:67], v[160:163], v[144:147], v[64:67]
    ds_read_b128 v[200:203], v231 offset:38912
    v_mfma_f32_16x16x32_bf16 v[68:71], v[164:167], v[144:147], v[68:71]
    v_mfma_f32_16x16x32_bf16 v[72:75], v[168:171], v[144:147], v[72:75]
    ds_read_b128 v[204:207], v231 offset:39936
    v_mfma_f32_16x16x32_bf16 v[76:79], v[172:175], v[144:147], v[76:79]
    v_mfma_f32_16x16x32_bf16 v[80:83], v[160:163], v[148:151], v[80:83]
    v_mfma_f32_16x16x32_bf16 v[84:87], v[164:167], v[148:151], v[84:87]
    v_mfma_f32_16x16x32_bf16 v[88:91], v[168:171], v[148:151], v[88:91]
    v_mfma_f32_16x16x32_bf16 v[92:95], v[172:175], v[148:151], v[92:95]
    v_mfma_f32_16x16x32_bf16 v[96:99], v[160:163], v[152:155], v[96:99]
    v_mfma_f32_16x16x32_bf16 v[100:103], v[164:167], v[152:155], v[100:103]
    v_mfma_f32_16x16x32_bf16 v[104:107], v[168:171], v[152:155], v[104:107]
    v_mfma_f32_16x16x32_bf16 v[108:111], v[172:175], v[152:155], v[108:111]
    v_mfma_f32_16x16x32_bf16 v[112:115], v[160:163], v[156:159], v[112:115]
    v_mfma_f32_16x16x32_bf16 v[116:119], v[164:167], v[156:159], v[116:119]
    v_mfma_f32_16x16x32_bf16 v[120:123], v[168:171], v[156:159], v[120:123]
    v_mfma_f32_16x16x32_bf16 v[124:127], v[172:175], v[156:159], v[124:127]
    s_waitcnt lgkmcnt(0)
    s_barrier
    v_mfma_f32_16x16x32_bf16 v[0:3], v[208:211], v[176:179], v[0:3]
    ds_read_b64_tr_b16 v[160:161], v233 offset:0
    v_mfma_f32_16x16x32_bf16 v[4:7], v[212:215], v[176:179], v[4:7]
    ds_read_b64_tr_b16 v[162:163], v233 offset:1024
    v_mfma_f32_16x16x32_bf16 v[8:11], v[216:219], v[176:179], v[8:11]
    ds_read_b64_tr_b16 v[164:165], v236 offset:0
    v_mfma_f32_16x16x32_bf16 v[12:15], v[220:223], v[176:179], v[12:15]
    ds_read_b64_tr_b16 v[166:167], v236 offset:1024
    v_mfma_f32_16x16x32_bf16 v[16:19], v[208:211], v[180:183], v[16:19]
    ds_read_b64_tr_b16 v[168:169], v233 offset:8192
    v_mfma_f32_16x16x32_bf16 v[20:23], v[212:215], v[180:183], v[20:23]
    v_mfma_f32_16x16x32_bf16 v[24:27], v[216:219], v[180:183], v[24:27]
    ds_read_b64_tr_b16 v[170:171], v233 offset:9216
    v_mfma_f32_16x16x32_bf16 v[28:31], v[220:223], v[180:183], v[28:31]
    ds_read_b64_tr_b16 v[172:173], v236 offset:8192
    v_mfma_f32_16x16x32_bf16 v[32:35], v[208:211], v[184:187], v[32:35]
    ds_read_b64_tr_b16 v[174:175], v236 offset:9216
    v_mfma_f32_16x16x32_bf16 v[36:39], v[212:215], v[184:187], v[36:39]
    ds_read_b128 v[128:131], v230 offset:0
    v_mfma_f32_16x16x32_bf16 v[40:43], v[216:219], v[184:187], v[40:43]
    ds_read_b128 v[132:135], v230 offset:1024
    v_mfma_f32_16x16x32_bf16 v[44:47], v[220:223], v[184:187], v[44:47]
    v_mfma_f32_16x16x32_bf16 v[48:51], v[208:211], v[188:191], v[48:51]
    ds_read_b128 v[136:139], v230 offset:2048
    v_mfma_f32_16x16x32_bf16 v[52:55], v[212:215], v[188:191], v[52:55]
    ds_read_b128 v[140:143], v230 offset:3072
    v_mfma_f32_16x16x32_bf16 v[56:59], v[216:219], v[188:191], v[56:59]
    ds_read_b128 v[144:147], v230 offset:4096
    v_mfma_f32_16x16x32_bf16 v[60:63], v[220:223], v[188:191], v[60:63]
    ds_read_b128 v[148:151], v230 offset:5120
    v_mfma_f32_16x16x32_bf16 v[64:67], v[208:211], v[192:195], v[64:67]
    ds_read_b128 v[152:155], v230 offset:6144
    v_mfma_f32_16x16x32_bf16 v[68:71], v[212:215], v[192:195], v[68:71]
    v_mfma_f32_16x16x32_bf16 v[72:75], v[216:219], v[192:195], v[72:75]
    ds_read_b128 v[156:159], v230 offset:7168
    v_mfma_f32_16x16x32_bf16 v[76:79], v[220:223], v[192:195], v[76:79]
    v_mfma_f32_16x16x32_bf16 v[80:83], v[208:211], v[196:199], v[80:83]
    v_mfma_f32_16x16x32_bf16 v[84:87], v[212:215], v[196:199], v[84:87]
    v_mfma_f32_16x16x32_bf16 v[88:91], v[216:219], v[196:199], v[88:91]
    v_mfma_f32_16x16x32_bf16 v[92:95], v[220:223], v[196:199], v[92:95]
    v_mfma_f32_16x16x32_bf16 v[96:99], v[208:211], v[200:203], v[96:99]
    v_mfma_f32_16x16x32_bf16 v[100:103], v[212:215], v[200:203], v[100:103]
    v_mfma_f32_16x16x32_bf16 v[104:107], v[216:219], v[200:203], v[104:107]
    v_mfma_f32_16x16x32_bf16 v[108:111], v[220:223], v[200:203], v[108:111]
    v_mfma_f32_16x16x32_bf16 v[112:115], v[208:211], v[204:207], v[112:115]
    v_mfma_f32_16x16x32_bf16 v[116:119], v[212:215], v[204:207], v[116:119]
    v_mfma_f32_16x16x32_bf16 v[120:123], v[216:219], v[204:207], v[120:123]
    v_mfma_f32_16x16x32_bf16 v[124:127], v[220:223], v[204:207], v[124:127]
    s_waitcnt lgkmcnt(0)
    s_barrier
    v_mfma_f32_16x16x32_bf16 v[0:3], v[160:163], v[128:131], v[0:3]
    ds_read_b64_tr_b16 v[208:209], v233 offset:32768
    v_mfma_f32_16x16x32_bf16 v[4:7], v[164:167], v[128:131], v[4:7]
    ds_read_b64_tr_b16 v[210:211], v233 offset:33792
    v_mfma_f32_16x16x32_bf16 v[8:11], v[168:171], v[128:131], v[8:11]
    ds_read_b64_tr_b16 v[212:213], v236 offset:32768
    v_mfma_f32_16x16x32_bf16 v[12:15], v[172:175], v[128:131], v[12:15]
    ds_read_b64_tr_b16 v[214:215], v236 offset:33792
    v_mfma_f32_16x16x32_bf16 v[16:19], v[160:163], v[132:135], v[16:19]
    ds_read_b64_tr_b16 v[216:217], v233 offset:40960
    v_mfma_f32_16x16x32_bf16 v[20:23], v[164:167], v[132:135], v[20:23]
    v_mfma_f32_16x16x32_bf16 v[24:27], v[168:171], v[132:135], v[24:27]
    ds_read_b64_tr_b16 v[218:219], v233 offset:41984
    v_mfma_f32_16x16x32_bf16 v[28:31], v[172:175], v[132:135], v[28:31]
    ds_read_b64_tr_b16 v[220:221], v236 offset:40960
    v_mfma_f32_16x16x32_bf16 v[32:35], v[160:163], v[136:139], v[32:35]
    ds_read_b64_tr_b16 v[222:223], v236 offset:41984
    v_mfma_f32_16x16x32_bf16 v[36:39], v[164:167], v[136:139], v[36:39]
    ds_read_b128 v[176:179], v230 offset:32768
    v_mfma_f32_16x16x32_bf16 v[40:43], v[168:171], v[136:139], v[40:43]
    ds_read_b128 v[180:183], v230 offset:33792
    v_mfma_f32_16x16x32_bf16 v[44:47], v[172:175], v[136:139], v[44:47]
    v_mfma_f32_16x16x32_bf16 v[48:51], v[160:163], v[140:143], v[48:51]
    ds_read_b128 v[184:187], v230 offset:34816
    v_mfma_f32_16x16x32_bf16 v[52:55], v[164:167], v[140:143], v[52:55]
    ds_read_b128 v[188:191], v230 offset:35840
    v_mfma_f32_16x16x32_bf16 v[56:59], v[168:171], v[140:143], v[56:59]
    ds_read_b128 v[192:195], v230 offset:36864
    v_mfma_f32_16x16x32_bf16 v[60:63], v[172:175], v[140:143], v[60:63]
    ds_read_b128 v[196:199], v230 offset:37888
    v_mfma_f32_16x16x32_bf16 v[64:67], v[160:163], v[144:147], v[64:67]
    ds_read_b128 v[200:203], v230 offset:38912
    v_mfma_f32_16x16x32_bf16 v[68:71], v[164:167], v[144:147], v[68:71]
    v_mfma_f32_16x16x32_bf16 v[72:75], v[168:171], v[144:147], v[72:75]
    ds_read_b128 v[204:207], v230 offset:39936
    v_mfma_f32_16x16x32_bf16 v[76:79], v[172:175], v[144:147], v[76:79]
    v_mfma_f32_16x16x32_bf16 v[80:83], v[160:163], v[148:151], v[80:83]
    v_mfma_f32_16x16x32_bf16 v[84:87], v[164:167], v[148:151], v[84:87]
    v_mfma_f32_16x16x32_bf16 v[88:91], v[168:171], v[148:151], v[88:91]
    v_mfma_f32_16x16x32_bf16 v[92:95], v[172:175], v[148:151], v[92:95]
    v_mfma_f32_16x16x32_bf16 v[96:99], v[160:163], v[152:155], v[96:99]
    v_mfma_f32_16x16x32_bf16 v[100:103], v[164:167], v[152:155], v[100:103]
    v_mfma_f32_16x16x32_bf16 v[104:107], v[168:171], v[152:155], v[104:107]
    v_mfma_f32_16x16x32_bf16 v[108:111], v[172:175], v[152:155], v[108:111]
    v_mfma_f32_16x16x32_bf16 v[112:115], v[160:163], v[156:159], v[112:115]
    v_mfma_f32_16x16x32_bf16 v[116:119], v[164:167], v[156:159], v[116:119]
    v_mfma_f32_16x16x32_bf16 v[120:123], v[168:171], v[156:159], v[120:123]
    v_mfma_f32_16x16x32_bf16 v[124:127], v[172:175], v[156:159], v[124:127]
    s_mov_b32 s39, 5
loop_27:
    s_waitcnt lgkmcnt(0)
    s_barrier
    v_mfma_f32_16x16x32_bf16 v[0:3], v[208:211], v[176:179], v[0:3]
    ds_read_b64_tr_b16 v[160:161], v234 offset:0
    v_mfma_f32_16x16x32_bf16 v[4:7], v[212:215], v[176:179], v[4:7]
    ds_read_b64_tr_b16 v[162:163], v234 offset:1024
    v_mfma_f32_16x16x32_bf16 v[8:11], v[216:219], v[176:179], v[8:11]
    ds_read_b64_tr_b16 v[164:165], v237 offset:0
    v_mfma_f32_16x16x32_bf16 v[12:15], v[220:223], v[176:179], v[12:15]
    ds_read_b64_tr_b16 v[166:167], v237 offset:1024
    v_mfma_f32_16x16x32_bf16 v[16:19], v[208:211], v[180:183], v[16:19]
    ds_read_b64_tr_b16 v[168:169], v234 offset:8192
    v_mfma_f32_16x16x32_bf16 v[20:23], v[212:215], v[180:183], v[20:23]
    v_mfma_f32_16x16x32_bf16 v[24:27], v[216:219], v[180:183], v[24:27]
    ds_read_b64_tr_b16 v[170:171], v234 offset:9216
    v_mfma_f32_16x16x32_bf16 v[28:31], v[220:223], v[180:183], v[28:31]
    ds_read_b64_tr_b16 v[172:173], v237 offset:8192
    v_mfma_f32_16x16x32_bf16 v[32:35], v[208:211], v[184:187], v[32:35]
    ds_read_b64_tr_b16 v[174:175], v237 offset:9216
    v_mfma_f32_16x16x32_bf16 v[36:39], v[212:215], v[184:187], v[36:39]
    ds_read_b128 v[128:131], v231 offset:0
    v_mfma_f32_16x16x32_bf16 v[40:43], v[216:219], v[184:187], v[40:43]
    ds_read_b128 v[132:135], v231 offset:1024
    v_mfma_f32_16x16x32_bf16 v[44:47], v[220:223], v[184:187], v[44:47]
    v_mfma_f32_16x16x32_bf16 v[48:51], v[208:211], v[188:191], v[48:51]
    ds_read_b128 v[136:139], v231 offset:2048
    v_mfma_f32_16x16x32_bf16 v[52:55], v[212:215], v[188:191], v[52:55]
    ds_read_b128 v[140:143], v231 offset:3072
    v_mfma_f32_16x16x32_bf16 v[56:59], v[216:219], v[188:191], v[56:59]
    ds_read_b128 v[144:147], v231 offset:4096
    v_mfma_f32_16x16x32_bf16 v[60:63], v[220:223], v[188:191], v[60:63]
    ds_read_b128 v[148:151], v231 offset:5120
    v_mfma_f32_16x16x32_bf16 v[64:67], v[208:211], v[192:195], v[64:67]
    ds_read_b128 v[152:155], v231 offset:6144
    v_mfma_f32_16x16x32_bf16 v[68:71], v[212:215], v[192:195], v[68:71]
    v_mfma_f32_16x16x32_bf16 v[72:75], v[216:219], v[192:195], v[72:75]
    ds_read_b128 v[156:159], v231 offset:7168
    v_mfma_f32_16x16x32_bf16 v[76:79], v[220:223], v[192:195], v[76:79]
    v_mfma_f32_16x16x32_bf16 v[80:83], v[208:211], v[196:199], v[80:83]
    v_mfma_f32_16x16x32_bf16 v[84:87], v[212:215], v[196:199], v[84:87]
    v_mfma_f32_16x16x32_bf16 v[88:91], v[216:219], v[196:199], v[88:91]
    v_mfma_f32_16x16x32_bf16 v[92:95], v[220:223], v[196:199], v[92:95]
    v_mfma_f32_16x16x32_bf16 v[96:99], v[208:211], v[200:203], v[96:99]
    v_mfma_f32_16x16x32_bf16 v[100:103], v[212:215], v[200:203], v[100:103]
    v_mfma_f32_16x16x32_bf16 v[104:107], v[216:219], v[200:203], v[104:107]
    v_mfma_f32_16x16x32_bf16 v[108:111], v[220:223], v[200:203], v[108:111]
    v_mfma_f32_16x16x32_bf16 v[112:115], v[208:211], v[204:207], v[112:115]
    v_mfma_f32_16x16x32_bf16 v[116:119], v[212:215], v[204:207], v[116:119]
    v_mfma_f32_16x16x32_bf16 v[120:123], v[216:219], v[204:207], v[120:123]
    v_mfma_f32_16x16x32_bf16 v[124:127], v[220:223], v[204:207], v[124:127]
    s_waitcnt lgkmcnt(0)
    s_barrier
    v_mfma_f32_16x16x32_bf16 v[0:3], v[160:163], v[128:131], v[0:3]
    ds_read_b64_tr_b16 v[208:209], v234 offset:32768
    v_mfma_f32_16x16x32_bf16 v[4:7], v[164:167], v[128:131], v[4:7]
    ds_read_b64_tr_b16 v[210:211], v234 offset:33792
    v_mfma_f32_16x16x32_bf16 v[8:11], v[168:171], v[128:131], v[8:11]
    ds_read_b64_tr_b16 v[212:213], v237 offset:32768
    v_mfma_f32_16x16x32_bf16 v[12:15], v[172:175], v[128:131], v[12:15]
    ds_read_b64_tr_b16 v[214:215], v237 offset:33792
    v_mfma_f32_16x16x32_bf16 v[16:19], v[160:163], v[132:135], v[16:19]
    ds_read_b64_tr_b16 v[216:217], v234 offset:40960
    v_mfma_f32_16x16x32_bf16 v[20:23], v[164:167], v[132:135], v[20:23]
    v_mfma_f32_16x16x32_bf16 v[24:27], v[168:171], v[132:135], v[24:27]
    ds_read_b64_tr_b16 v[218:219], v234 offset:41984
    v_mfma_f32_16x16x32_bf16 v[28:31], v[172:175], v[132:135], v[28:31]
    ds_read_b64_tr_b16 v[220:221], v237 offset:40960
    v_mfma_f32_16x16x32_bf16 v[32:35], v[160:163], v[136:139], v[32:35]
    ds_read_b64_tr_b16 v[222:223], v237 offset:41984
    v_mfma_f32_16x16x32_bf16 v[36:39], v[164:167], v[136:139], v[36:39]
    ds_read_b128 v[176:179], v231 offset:32768
    v_mfma_f32_16x16x32_bf16 v[40:43], v[168:171], v[136:139], v[40:43]
    ds_read_b128 v[180:183], v231 offset:33792
    v_mfma_f32_16x16x32_bf16 v[44:47], v[172:175], v[136:139], v[44:47]
    v_mfma_f32_16x16x32_bf16 v[48:51], v[160:163], v[140:143], v[48:51]
    ds_read_b128 v[184:187], v231 offset:34816
    v_mfma_f32_16x16x32_bf16 v[52:55], v[164:167], v[140:143], v[52:55]
    ds_read_b128 v[188:191], v231 offset:35840
    v_mfma_f32_16x16x32_bf16 v[56:59], v[168:171], v[140:143], v[56:59]
    ds_read_b128 v[192:195], v231 offset:36864
    v_mfma_f32_16x16x32_bf16 v[60:63], v[172:175], v[140:143], v[60:63]
    ds_read_b128 v[196:199], v231 offset:37888
    v_mfma_f32_16x16x32_bf16 v[64:67], v[160:163], v[144:147], v[64:67]
    ds_read_b128 v[200:203], v231 offset:38912
    v_mfma_f32_16x16x32_bf16 v[68:71], v[164:167], v[144:147], v[68:71]
    v_mfma_f32_16x16x32_bf16 v[72:75], v[168:171], v[144:147], v[72:75]
    ds_read_b128 v[204:207], v231 offset:39936
    v_mfma_f32_16x16x32_bf16 v[76:79], v[172:175], v[144:147], v[76:79]
    v_mfma_f32_16x16x32_bf16 v[80:83], v[160:163], v[148:151], v[80:83]
    v_mfma_f32_16x16x32_bf16 v[84:87], v[164:167], v[148:151], v[84:87]
    v_mfma_f32_16x16x32_bf16 v[88:91], v[168:171], v[148:151], v[88:91]
    v_mfma_f32_16x16x32_bf16 v[92:95], v[172:175], v[148:151], v[92:95]
    v_mfma_f32_16x16x32_bf16 v[96:99], v[160:163], v[152:155], v[96:99]
    v_mfma_f32_16x16x32_bf16 v[100:103], v[164:167], v[152:155], v[100:103]
    v_mfma_f32_16x16x32_bf16 v[104:107], v[168:171], v[152:155], v[104:107]
    v_mfma_f32_16x16x32_bf16 v[108:111], v[172:175], v[152:155], v[108:111]
    v_mfma_f32_16x16x32_bf16 v[112:115], v[160:163], v[156:159], v[112:115]
    v_mfma_f32_16x16x32_bf16 v[116:119], v[164:167], v[156:159], v[116:119]
    v_mfma_f32_16x16x32_bf16 v[120:123], v[168:171], v[156:159], v[120:123]
    v_mfma_f32_16x16x32_bf16 v[124:127], v[172:175], v[156:159], v[124:127]
    s_waitcnt lgkmcnt(0)
    s_barrier
    v_mfma_f32_16x16x32_bf16 v[0:3], v[208:211], v[176:179], v[0:3]
    ds_read_b64_tr_b16 v[160:161], v233 offset:0
    v_mfma_f32_16x16x32_bf16 v[4:7], v[212:215], v[176:179], v[4:7]
    ds_read_b64_tr_b16 v[162:163], v233 offset:1024
    v_mfma_f32_16x16x32_bf16 v[8:11], v[216:219], v[176:179], v[8:11]
    ds_read_b64_tr_b16 v[164:165], v236 offset:0
    v_mfma_f32_16x16x32_bf16 v[12:15], v[220:223], v[176:179], v[12:15]
    ds_read_b64_tr_b16 v[166:167], v236 offset:1024
    v_mfma_f32_16x16x32_bf16 v[16:19], v[208:211], v[180:183], v[16:19]
    ds_read_b64_tr_b16 v[168:169], v233 offset:8192
    v_mfma_f32_16x16x32_bf16 v[20:23], v[212:215], v[180:183], v[20:23]
    v_mfma_f32_16x16x32_bf16 v[24:27], v[216:219], v[180:183], v[24:27]
    ds_read_b64_tr_b16 v[170:171], v233 offset:9216
    v_mfma_f32_16x16x32_bf16 v[28:31], v[220:223], v[180:183], v[28:31]
    ds_read_b64_tr_b16 v[172:173], v236 offset:8192
    v_mfma_f32_16x16x32_bf16 v[32:35], v[208:211], v[184:187], v[32:35]
    ds_read_b64_tr_b16 v[174:175], v236 offset:9216
    v_mfma_f32_16x16x32_bf16 v[36:39], v[212:215], v[184:187], v[36:39]
    ds_read_b128 v[128:131], v230 offset:0
    v_mfma_f32_16x16x32_bf16 v[40:43], v[216:219], v[184:187], v[40:43]
    ds_read_b128 v[132:135], v230 offset:1024
    v_mfma_f32_16x16x32_bf16 v[44:47], v[220:223], v[184:187], v[44:47]
    v_mfma_f32_16x16x32_bf16 v[48:51], v[208:211], v[188:191], v[48:51]
    ds_read_b128 v[136:139], v230 offset:2048
    v_mfma_f32_16x16x32_bf16 v[52:55], v[212:215], v[188:191], v[52:55]
    ds_read_b128 v[140:143], v230 offset:3072
    v_mfma_f32_16x16x32_bf16 v[56:59], v[216:219], v[188:191], v[56:59]
    ds_read_b128 v[144:147], v230 offset:4096
    v_mfma_f32_16x16x32_bf16 v[60:63], v[220:223], v[188:191], v[60:63]
    ds_read_b128 v[148:151], v230 offset:5120
    v_mfma_f32_16x16x32_bf16 v[64:67], v[208:211], v[192:195], v[64:67]
    ds_read_b128 v[152:155], v230 offset:6144
    v_mfma_f32_16x16x32_bf16 v[68:71], v[212:215], v[192:195], v[68:71]
    v_mfma_f32_16x16x32_bf16 v[72:75], v[216:219], v[192:195], v[72:75]
    ds_read_b128 v[156:159], v230 offset:7168
    v_mfma_f32_16x16x32_bf16 v[76:79], v[220:223], v[192:195], v[76:79]
    v_mfma_f32_16x16x32_bf16 v[80:83], v[208:211], v[196:199], v[80:83]
    v_mfma_f32_16x16x32_bf16 v[84:87], v[212:215], v[196:199], v[84:87]
    v_mfma_f32_16x16x32_bf16 v[88:91], v[216:219], v[196:199], v[88:91]
    v_mfma_f32_16x16x32_bf16 v[92:95], v[220:223], v[196:199], v[92:95]
    v_mfma_f32_16x16x32_bf16 v[96:99], v[208:211], v[200:203], v[96:99]
    v_mfma_f32_16x16x32_bf16 v[100:103], v[212:215], v[200:203], v[100:103]
    v_mfma_f32_16x16x32_bf16 v[104:107], v[216:219], v[200:203], v[104:107]
    v_mfma_f32_16x16x32_bf16 v[108:111], v[220:223], v[200:203], v[108:111]
    v_mfma_f32_16x16x32_bf16 v[112:115], v[208:211], v[204:207], v[112:115]
    v_mfma_f32_16x16x32_bf16 v[116:119], v[212:215], v[204:207], v[116:119]
    v_mfma_f32_16x16x32_bf16 v[120:123], v[216:219], v[204:207], v[120:123]
    v_mfma_f32_16x16x32_bf16 v[124:127], v[220:223], v[204:207], v[124:127]
    s_waitcnt lgkmcnt(0)
    s_barrier
    v_mfma_f32_16x16x32_bf16 v[0:3], v[160:163], v[128:131], v[0:3]
    ds_read_b64_tr_b16 v[208:209], v233 offset:32768
    v_mfma_f32_16x16x32_bf16 v[4:7], v[164:167], v[128:131], v[4:7]
    ds_read_b64_tr_b16 v[210:211], v233 offset:33792
    v_mfma_f32_16x16x32_bf16 v[8:11], v[168:171], v[128:131], v[8:11]
    ds_read_b64_tr_b16 v[212:213], v236 offset:32768
    v_mfma_f32_16x16x32_bf16 v[12:15], v[172:175], v[128:131], v[12:15]
    ds_read_b64_tr_b16 v[214:215], v236 offset:33792
    v_mfma_f32_16x16x32_bf16 v[16:19], v[160:163], v[132:135], v[16:19]
    ds_read_b64_tr_b16 v[216:217], v233 offset:40960
    v_mfma_f32_16x16x32_bf16 v[20:23], v[164:167], v[132:135], v[20:23]
    v_mfma_f32_16x16x32_bf16 v[24:27], v[168:171], v[132:135], v[24:27]
    ds_read_b64_tr_b16 v[218:219], v233 offset:41984
    v_mfma_f32_16x16x32_bf16 v[28:31], v[172:175], v[132:135], v[28:31]
    ds_read_b64_tr_b16 v[220:221], v236 offset:40960
    v_mfma_f32_16x16x32_bf16 v[32:35], v[160:163], v[136:139], v[32:35]
    ds_read_b64_tr_b16 v[222:223], v236 offset:41984
    v_mfma_f32_16x16x32_bf16 v[36:39], v[164:167], v[136:139], v[36:39]
    ds_read_b128 v[176:179], v230 offset:32768
    v_mfma_f32_16x16x32_bf16 v[40:43], v[168:171], v[136:139], v[40:43]
    ds_read_b128 v[180:183], v230 offset:33792
    v_mfma_f32_16x16x32_bf16 v[44:47], v[172:175], v[136:139], v[44:47]
    v_mfma_f32_16x16x32_bf16 v[48:51], v[160:163], v[140:143], v[48:51]
    ds_read_b128 v[184:187], v230 offset:34816
    v_mfma_f32_16x16x32_bf16 v[52:55], v[164:167], v[140:143], v[52:55]
    ds_read_b128 v[188:191], v230 offset:35840
    v_mfma_f32_16x16x32_bf16 v[56:59], v[168:171], v[140:143], v[56:59]
    ds_read_b128 v[192:195], v230 offset:36864
    v_mfma_f32_16x16x32_bf16 v[60:63], v[172:175], v[140:143], v[60:63]
    ds_read_b128 v[196:199], v230 offset:37888
    v_mfma_f32_16x16x32_bf16 v[64:67], v[160:163], v[144:147], v[64:67]
    ds_read_b128 v[200:203], v230 offset:38912
    v_mfma_f32_16x16x32_bf16 v[68:71], v[164:167], v[144:147], v[68:71]
    v_mfma_f32_16x16x32_bf16 v[72:75], v[168:171], v[144:147], v[72:75]
    ds_read_b128 v[204:207], v230 offset:39936
    v_mfma_f32_16x16x32_bf16 v[76:79], v[172:175], v[144:147], v[76:79]
    v_mfma_f32_16x16x32_bf16 v[80:83], v[160:163], v[148:151], v[80:83]
    v_mfma_f32_16x16x32_bf16 v[84:87], v[164:167], v[148:151], v[84:87]
    v_mfma_f32_16x16x32_bf16 v[88:91], v[168:171], v[148:151], v[88:91]
    v_mfma_f32_16x16x32_bf16 v[92:95], v[172:175], v[148:151], v[92:95]
    v_mfma_f32_16x16x32_bf16 v[96:99], v[160:163], v[152:155], v[96:99]
    v_mfma_f32_16x16x32_bf16 v[100:103], v[164:167], v[152:155], v[100:103]
    v_mfma_f32_16x16x32_bf16 v[104:107], v[168:171], v[152:155], v[104:107]
    v_mfma_f32_16x16x32_bf16 v[108:111], v[172:175], v[152:155], v[108:111]
    v_mfma_f32_16x16x32_bf16 v[112:115], v[160:163], v[156:159], v[112:115]
    v_mfma_f32_16x16x32_bf16 v[116:119], v[164:167], v[156:159], v[116:119]
    v_mfma_f32_16x16x32_bf16 v[120:123], v[168:171], v[156:159], v[120:123]
    v_mfma_f32_16x16x32_bf16 v[124:127], v[172:175], v[156:159], v[124:127]
    s_sub_u32 s39, s39, 1
    s_cmp_lg_u32 s39, 0
    s_cbranch_scc1 loop_27
    s_waitcnt lgkmcnt(0)
    s_barrier
    v_mfma_f32_16x16x32_bf16 v[0:3], v[208:211], v[176:179], v[0:3]
    ds_read_b64_tr_b16 v[160:161], v234 offset:0
    v_mfma_f32_16x16x32_bf16 v[4:7], v[212:215], v[176:179], v[4:7]
    ds_read_b64_tr_b16 v[162:163], v234 offset:1024
    v_mfma_f32_16x16x32_bf16 v[8:11], v[216:219], v[176:179], v[8:11]
    ds_read_b64_tr_b16 v[164:165], v237 offset:0
    v_mfma_f32_16x16x32_bf16 v[12:15], v[220:223], v[176:179], v[12:15]
    ds_read_b64_tr_b16 v[166:167], v237 offset:1024
    v_mfma_f32_16x16x32_bf16 v[16:19], v[208:211], v[180:183], v[16:19]
    ds_read_b64_tr_b16 v[168:169], v234 offset:8192
    v_mfma_f32_16x16x32_bf16 v[20:23], v[212:215], v[180:183], v[20:23]
    v_mfma_f32_16x16x32_bf16 v[24:27], v[216:219], v[180:183], v[24:27]
    ds_read_b64_tr_b16 v[170:171], v234 offset:9216
    v_mfma_f32_16x16x32_bf16 v[28:31], v[220:223], v[180:183], v[28:31]
    ds_read_b64_tr_b16 v[172:173], v237 offset:8192
    v_mfma_f32_16x16x32_bf16 v[32:35], v[208:211], v[184:187], v[32:35]
    ds_read_b64_tr_b16 v[174:175], v237 offset:9216
    v_mfma_f32_16x16x32_bf16 v[36:39], v[212:215], v[184:187], v[36:39]
    ds_read_b128 v[128:131], v231 offset:0
    v_mfma_f32_16x16x32_bf16 v[40:43], v[216:219], v[184:187], v[40:43]
    ds_read_b128 v[132:135], v231 offset:1024
    v_mfma_f32_16x16x32_bf16 v[44:47], v[220:223], v[184:187], v[44:47]
    v_mfma_f32_16x16x32_bf16 v[48:51], v[208:211], v[188:191], v[48:51]
    ds_read_b128 v[136:139], v231 offset:2048
    v_mfma_f32_16x16x32_bf16 v[52:55], v[212:215], v[188:191], v[52:55]
    ds_read_b128 v[140:143], v231 offset:3072
    v_mfma_f32_16x16x32_bf16 v[56:59], v[216:219], v[188:191], v[56:59]
    ds_read_b128 v[144:147], v231 offset:4096
    v_mfma_f32_16x16x32_bf16 v[60:63], v[220:223], v[188:191], v[60:63]
    ds_read_b128 v[148:151], v231 offset:5120
    v_mfma_f32_16x16x32_bf16 v[64:67], v[208:211], v[192:195], v[64:67]
    ds_read_b128 v[152:155], v231 offset:6144
    v_mfma_f32_16x16x32_bf16 v[68:71], v[212:215], v[192:195], v[68:71]
    v_mfma_f32_16x16x32_bf16 v[72:75], v[216:219], v[192:195], v[72:75]
    ds_read_b128 v[156:159], v231 offset:7168
    v_mfma_f32_16x16x32_bf16 v[76:79], v[220:223], v[192:195], v[76:79]
    v_mfma_f32_16x16x32_bf16 v[80:83], v[208:211], v[196:199], v[80:83]
    v_mfma_f32_16x16x32_bf16 v[84:87], v[212:215], v[196:199], v[84:87]
    v_mfma_f32_16x16x32_bf16 v[88:91], v[216:219], v[196:199], v[88:91]
    v_mfma_f32_16x16x32_bf16 v[92:95], v[220:223], v[196:199], v[92:95]
    v_mfma_f32_16x16x32_bf16 v[96:99], v[208:211], v[200:203], v[96:99]
    v_mfma_f32_16x16x32_bf16 v[100:103], v[212:215], v[200:203], v[100:103]
    v_mfma_f32_16x16x32_bf16 v[104:107], v[216:219], v[200:203], v[104:107]
    v_mfma_f32_16x16x32_bf16 v[108:111], v[220:223], v[200:203], v[108:111]
    v_mfma_f32_16x16x32_bf16 v[112:115], v[208:211], v[204:207], v[112:115]
    v_mfma_f32_16x16x32_bf16 v[116:119], v[212:215], v[204:207], v[116:119]
    v_mfma_f32_16x16x32_bf16 v[120:123], v[216:219], v[204:207], v[120:123]
    v_mfma_f32_16x16x32_bf16 v[124:127], v[220:223], v[204:207], v[124:127]
    s_waitcnt lgkmcnt(0)
    s_barrier
    v_mfma_f32_16x16x32_bf16 v[0:3], v[160:163], v[128:131], v[0:3]
    ds_read_b64_tr_b16 v[208:209], v234 offset:32768
    v_mfma_f32_16x16x32_bf16 v[4:7], v[164:167], v[128:131], v[4:7]
    ds_read_b64_tr_b16 v[210:211], v234 offset:33792
    v_mfma_f32_16x16x32_bf16 v[8:11], v[168:171], v[128:131], v[8:11]
    ds_read_b64_tr_b16 v[212:213], v237 offset:32768
    v_mfma_f32_16x16x32_bf16 v[12:15], v[172:175], v[128:131], v[12:15]
    ds_read_b64_tr_b16 v[214:215], v237 offset:33792
    v_mfma_f32_16x16x32_bf16 v[16:19], v[160:163], v[132:135], v[16:19]
    ds_read_b64_tr_b16 v[216:217], v234 offset:40960
    v_mfma_f32_16x16x32_bf16 v[20:23], v[164:167], v[132:135], v[20:23]
    v_mfma_f32_16x16x32_bf16 v[24:27], v[168:171], v[132:135], v[24:27]
    ds_read_b64_tr_b16 v[218:219], v234 offset:41984
    v_mfma_f32_16x16x32_bf16 v[28:31], v[172:175], v[132:135], v[28:31]
    ds_read_b64_tr_b16 v[220:221], v237 offset:40960
    v_mfma_f32_16x16x32_bf16 v[32:35], v[160:163], v[136:139], v[32:35]
    ds_read_b64_tr_b16 v[222:223], v237 offset:41984
    v_mfma_f32_16x16x32_bf16 v[36:39], v[164:167], v[136:139], v[36:39]
    ds_read_b128 v[176:179], v231 offset:32768
    v_mfma_f32_16x16x32_bf16 v[40:43], v[168:171], v[136:139], v[40:43]
    ds_read_b128 v[180:183], v231 offset:33792
    v_mfma_f32_16x16x32_bf16 v[44:47], v[172:175], v[136:139], v[44:47]
    v_mfma_f32_16x16x32_bf16 v[48:51], v[160:163], v[140:143], v[48:51]
    ds_read_b128 v[184:187], v231 offset:34816
    v_mfma_f32_16x16x32_bf16 v[52:55], v[164:167], v[140:143], v[52:55]
    ds_read_b128 v[188:191], v231 offset:35840
    v_mfma_f32_16x16x32_bf16 v[56:59], v[168:171], v[140:143], v[56:59]
    ds_read_b128 v[192:195], v231 offset:36864
    v_mfma_f32_16x16x32_bf16 v[60:63], v[172:175], v[140:143], v[60:63]
    ds_read_b128 v[196:199], v231 offset:37888
    v_mfma_f32_16x16x32_bf16 v[64:67], v[160:163], v[144:147], v[64:67]
    ds_read_b128 v[200:203], v231 offset:38912
    v_mfma_f32_16x16x32_bf16 v[68:71], v[164:167], v[144:147], v[68:71]
    v_mfma_f32_16x16x32_bf16 v[72:75], v[168:171], v[144:147], v[72:75]
    ds_read_b128 v[204:207], v231 offset:39936
    v_mfma_f32_16x16x32_bf16 v[76:79], v[172:175], v[144:147], v[76:79]
    v_mfma_f32_16x16x32_bf16 v[80:83], v[160:163], v[148:151], v[80:83]
    v_mfma_f32_16x16x32_bf16 v[84:87], v[164:167], v[148:151], v[84:87]
    v_mfma_f32_16x16x32_bf16 v[88:91], v[168:171], v[148:151], v[88:91]
    v_mfma_f32_16x16x32_bf16 v[92:95], v[172:175], v[148:151], v[92:95]
    v_mfma_f32_16x16x32_bf16 v[96:99], v[160:163], v[152:155], v[96:99]
    v_mfma_f32_16x16x32_bf16 v[100:103], v[164:167], v[152:155], v[100:103]
    v_mfma_f32_16x16x32_bf16 v[104:107], v[168:171], v[152:155], v[104:107]
    v_mfma_f32_16x16x32_bf16 v[108:111], v[172:175], v[152:155], v[108:111]
    v_mfma_f32_16x16x32_bf16 v[112:115], v[160:163], v[156:159], v[112:115]
    v_mfma_f32_16x16x32_bf16 v[116:119], v[164:167], v[156:159], v[116:119]
    v_mfma_f32_16x16x32_bf16 v[120:123], v[168:171], v[156:159], v[120:123]
    v_mfma_f32_16x16x32_bf16 v[124:127], v[172:175], v[156:159], v[124:127]
    s_waitcnt lgkmcnt(0)
    s_barrier
    v_mfma_f32_16x16x32_bf16 v[0:3], v[208:211], v[176:179], v[0:3]
    ds_read_b64_tr_b16 v[160:161], v233 offset:0
    v_mfma_f32_16x16x32_bf16 v[4:7], v[212:215], v[176:179], v[4:7]
    ds_read_b64_tr_b16 v[162:163], v233 offset:1024
    v_mfma_f32_16x16x32_bf16 v[8:11], v[216:219], v[176:179], v[8:11]
    ds_read_b64_tr_b16 v[164:165], v236 offset:0
    v_mfma_f32_16x16x32_bf16 v[12:15], v[220:223], v[176:179], v[12:15]
    ds_read_b64_tr_b16 v[166:167], v236 offset:1024
    v_mfma_f32_16x16x32_bf16 v[16:19], v[208:211], v[180:183], v[16:19]
    ds_read_b64_tr_b16 v[168:169], v233 offset:8192
    v_mfma_f32_16x16x32_bf16 v[20:23], v[212:215], v[180:183], v[20:23]
    v_mfma_f32_16x16x32_bf16 v[24:27], v[216:219], v[180:183], v[24:27]
    ds_read_b64_tr_b16 v[170:171], v233 offset:9216
    v_mfma_f32_16x16x32_bf16 v[28:31], v[220:223], v[180:183], v[28:31]
    ds_read_b64_tr_b16 v[172:173], v236 offset:8192
    v_mfma_f32_16x16x32_bf16 v[32:35], v[208:211], v[184:187], v[32:35]
    ds_read_b64_tr_b16 v[174:175], v236 offset:9216
    v_mfma_f32_16x16x32_bf16 v[36:39], v[212:215], v[184:187], v[36:39]
    ds_read_b128 v[128:131], v230 offset:0
    v_mfma_f32_16x16x32_bf16 v[40:43], v[216:219], v[184:187], v[40:43]
    ds_read_b128 v[132:135], v230 offset:1024
    v_mfma_f32_16x16x32_bf16 v[44:47], v[220:223], v[184:187], v[44:47]
    v_mfma_f32_16x16x32_bf16 v[48:51], v[208:211], v[188:191], v[48:51]
    ds_read_b128 v[136:139], v230 offset:2048
    v_mfma_f32_16x16x32_bf16 v[52:55], v[212:215], v[188:191], v[52:55]
    ds_read_b128 v[140:143], v230 offset:3072
    v_mfma_f32_16x16x32_bf16 v[56:59], v[216:219], v[188:191], v[56:59]
    ds_read_b128 v[144:147], v230 offset:4096
    v_mfma_f32_16x16x32_bf16 v[60:63], v[220:223], v[188:191], v[60:63]
    ds_read_b128 v[148:151], v230 offset:5120
    v_mfma_f32_16x16x32_bf16 v[64:67], v[208:211], v[192:195], v[64:67]
    ds_read_b128 v[152:155], v230 offset:6144
    v_mfma_f32_16x16x32_bf16 v[68:71], v[212:215], v[192:195], v[68:71]
    v_mfma_f32_16x16x32_bf16 v[72:75], v[216:219], v[192:195], v[72:75]
    ds_read_b128 v[156:159], v230 offset:7168
    v_mfma_f32_16x16x32_bf16 v[76:79], v[220:223], v[192:195], v[76:79]
    v_mfma_f32_16x16x32_bf16 v[80:83], v[208:211], v[196:199], v[80:83]
    v_mfma_f32_16x16x32_bf16 v[84:87], v[212:215], v[196:199], v[84:87]
    v_mfma_f32_16x16x32_bf16 v[88:91], v[216:219], v[196:199], v[88:91]
    v_mfma_f32_16x16x32_bf16 v[92:95], v[220:223], v[196:199], v[92:95]
    v_mfma_f32_16x16x32_bf16 v[96:99], v[208:211], v[200:203], v[96:99]
    v_mfma_f32_16x16x32_bf16 v[100:103], v[212:215], v[200:203], v[100:103]
    v_mfma_f32_16x16x32_bf16 v[104:107], v[216:219], v[200:203], v[104:107]
    v_mfma_f32_16x16x32_bf16 v[108:111], v[220:223], v[200:203], v[108:111]
    v_mfma_f32_16x16x32_bf16 v[112:115], v[208:211], v[204:207], v[112:115]
    v_mfma_f32_16x16x32_bf16 v[116:119], v[212:215], v[204:207], v[116:119]
    v_mfma_f32_16x16x32_bf16 v[120:123], v[216:219], v[204:207], v[120:123]
    v_mfma_f32_16x16x32_bf16 v[124:127], v[220:223], v[204:207], v[124:127]
    s_waitcnt lgkmcnt(0)
    s_barrier
    v_mfma_f32_16x16x32_bf16 v[0:3], v[160:163], v[128:131], v[0:3]
    ds_read_b64_tr_b16 v[208:209], v233 offset:32768
    v_mfma_f32_16x16x32_bf16 v[4:7], v[164:167], v[128:131], v[4:7]
    ds_read_b64_tr_b16 v[210:211], v233 offset:33792
    v_mfma_f32_16x16x32_bf16 v[8:11], v[168:171], v[128:131], v[8:11]
    ds_read_b64_tr_b16 v[212:213], v236 offset:32768
    v_mfma_f32_16x16x32_bf16 v[12:15], v[172:175], v[128:131], v[12:15]
    ds_read_b64_tr_b16 v[214:215], v236 offset:33792
    v_mfma_f32_16x16x32_bf16 v[16:19], v[160:163], v[132:135], v[16:19]
    ds_read_b64_tr_b16 v[216:217], v233 offset:40960
    v_mfma_f32_16x16x32_bf16 v[20:23], v[164:167], v[132:135], v[20:23]
    v_mfma_f32_16x16x32_bf16 v[24:27], v[168:171], v[132:135], v[24:27]
    ds_read_b64_tr_b16 v[218:219], v233 offset:41984
    v_mfma_f32_16x16x32_bf16 v[28:31], v[172:175], v[132:135], v[28:31]
    ds_read_b64_tr_b16 v[220:221], v236 offset:40960
    v_mfma_f32_16x16x32_bf16 v[32:35], v[160:163], v[136:139], v[32:35]
    ds_read_b64_tr_b16 v[222:223], v236 offset:41984
    v_mfma_f32_16x16x32_bf16 v[36:39], v[164:167], v[136:139], v[36:39]
    ds_read_b128 v[176:179], v230 offset:32768
    v_mfma_f32_16x16x32_bf16 v[40:43], v[168:171], v[136:139], v[40:43]
    ds_read_b128 v[180:183], v230 offset:33792
    v_mfma_f32_16x16x32_bf16 v[44:47], v[172:175], v[136:139], v[44:47]
    v_mfma_f32_16x16x32_bf16 v[48:51], v[160:163], v[140:143], v[48:51]
    ds_read_b128 v[184:187], v230 offset:34816
    v_mfma_f32_16x16x32_bf16 v[52:55], v[164:167], v[140:143], v[52:55]
    ds_read_b128 v[188:191], v230 offset:35840
    v_mfma_f32_16x16x32_bf16 v[56:59], v[168:171], v[140:143], v[56:59]
    ds_read_b128 v[192:195], v230 offset:36864
    v_mfma_f32_16x16x32_bf16 v[60:63], v[172:175], v[140:143], v[60:63]
    ds_read_b128 v[196:199], v230 offset:37888
    v_mfma_f32_16x16x32_bf16 v[64:67], v[160:163], v[144:147], v[64:67]
    ds_read_b128 v[200:203], v230 offset:38912
    v_mfma_f32_16x16x32_bf16 v[68:71], v[164:167], v[144:147], v[68:71]
    v_mfma_f32_16x16x32_bf16 v[72:75], v[168:171], v[144:147], v[72:75]
    ds_read_b128 v[204:207], v230 offset:39936
    v_mfma_f32_16x16x32_bf16 v[76:79], v[172:175], v[144:147], v[76:79]
    v_mfma_f32_16x16x32_bf16 v[80:83], v[160:163], v[148:151], v[80:83]
    v_mfma_f32_16x16x32_bf16 v[84:87], v[164:167], v[148:151], v[84:87]
    v_mfma_f32_16x16x32_bf16 v[88:91], v[168:171], v[148:151], v[88:91]
    v_mfma_f32_16x16x32_bf16 v[92:95], v[172:175], v[148:151], v[92:95]
    v_mfma_f32_16x16x32_bf16 v[96:99], v[160:163], v[152:155], v[96:99]
    v_mfma_f32_16x16x32_bf16 v[100:103], v[164:167], v[152:155], v[100:103]
    v_mfma_f32_16x16x32_bf16 v[104:107], v[168:171], v[152:155], v[104:107]
    v_mfma_f32_16x16x32_bf16 v[108:111], v[172:175], v[152:155], v[108:111]
    v_mfma_f32_16x16x32_bf16 v[112:115], v[160:163], v[156:159], v[112:115]
    v_mfma_f32_16x16x32_bf16 v[116:119], v[164:167], v[156:159], v[116:119]
    v_mfma_f32_16x16x32_bf16 v[120:123], v[168:171], v[156:159], v[120:123]
    v_mfma_f32_16x16x32_bf16 v[124:127], v[172:175], v[156:159], v[124:127]
    s_waitcnt lgkmcnt(0)
    s_barrier
    v_mfma_f32_16x16x32_bf16 v[0:3], v[208:211], v[176:179], v[0:3]
    ds_read_b64_tr_b16 v[160:161], v234 offset:0
    v_mfma_f32_16x16x32_bf16 v[4:7], v[212:215], v[176:179], v[4:7]
    ds_read_b64_tr_b16 v[162:163], v234 offset:1024
    v_mfma_f32_16x16x32_bf16 v[8:11], v[216:219], v[176:179], v[8:11]
    ds_read_b64_tr_b16 v[164:165], v237 offset:0
    v_mfma_f32_16x16x32_bf16 v[12:15], v[220:223], v[176:179], v[12:15]
    ds_read_b64_tr_b16 v[166:167], v237 offset:1024
    v_mfma_f32_16x16x32_bf16 v[16:19], v[208:211], v[180:183], v[16:19]
    ds_read_b64_tr_b16 v[168:169], v234 offset:8192
    v_mfma_f32_16x16x32_bf16 v[20:23], v[212:215], v[180:183], v[20:23]
    v_mfma_f32_16x16x32_bf16 v[24:27], v[216:219], v[180:183], v[24:27]
    ds_read_b64_tr_b16 v[170:171], v234 offset:9216
    v_mfma_f32_16x16x32_bf16 v[28:31], v[220:223], v[180:183], v[28:31]
    ds_read_b64_tr_b16 v[172:173], v237 offset:8192
    v_mfma_f32_16x16x32_bf16 v[32:35], v[208:211], v[184:187], v[32:35]
    ds_read_b64_tr_b16 v[174:175], v237 offset:9216
    v_mfma_f32_16x16x32_bf16 v[36:39], v[212:215], v[184:187], v[36:39]
    ds_read_b128 v[128:131], v231 offset:0
    v_mfma_f32_16x16x32_bf16 v[40:43], v[216:219], v[184:187], v[40:43]
    ds_read_b128 v[132:135], v231 offset:1024
    v_mfma_f32_16x16x32_bf16 v[44:47], v[220:223], v[184:187], v[44:47]
    v_mfma_f32_16x16x32_bf16 v[48:51], v[208:211], v[188:191], v[48:51]
    ds_read_b128 v[136:139], v231 offset:2048
    v_mfma_f32_16x16x32_bf16 v[52:55], v[212:215], v[188:191], v[52:55]
    ds_read_b128 v[140:143], v231 offset:3072
    v_mfma_f32_16x16x32_bf16 v[56:59], v[216:219], v[188:191], v[56:59]
    ds_read_b128 v[144:147], v231 offset:4096
    v_mfma_f32_16x16x32_bf16 v[60:63], v[220:223], v[188:191], v[60:63]
    ds_read_b128 v[148:151], v231 offset:5120
    v_mfma_f32_16x16x32_bf16 v[64:67], v[208:211], v[192:195], v[64:67]
    ds_read_b128 v[152:155], v231 offset:6144
    v_mfma_f32_16x16x32_bf16 v[68:71], v[212:215], v[192:195], v[68:71]
    v_mfma_f32_16x16x32_bf16 v[72:75], v[216:219], v[192:195], v[72:75]
    ds_read_b128 v[156:159], v231 offset:7168
    v_mfma_f32_16x16x32_bf16 v[76:79], v[220:223], v[192:195], v[76:79]
    v_mfma_f32_16x16x32_bf16 v[80:83], v[208:211], v[196:199], v[80:83]
    v_mfma_f32_16x16x32_bf16 v[84:87], v[212:215], v[196:199], v[84:87]
    v_mfma_f32_16x16x32_bf16 v[88:91], v[216:219], v[196:199], v[88:91]
    v_mfma_f32_16x16x32_bf16 v[92:95], v[220:223], v[196:199], v[92:95]
    v_mfma_f32_16x16x32_bf16 v[96:99], v[208:211], v[200:203], v[96:99]
    v_mfma_f32_16x16x32_bf16 v[100:103], v[212:215], v[200:203], v[100:103]
    v_mfma_f32_16x16x32_bf16 v[104:107], v[216:219], v[200:203], v[104:107]
    v_mfma_f32_16x16x32_bf16 v[108:111], v[220:223], v[200:203], v[108:111]
    v_mfma_f32_16x16x32_bf16 v[112:115], v[208:211], v[204:207], v[112:115]
    v_mfma_f32_16x16x32_bf16 v[116:119], v[212:215], v[204:207], v[116:119]
    v_mfma_f32_16x16x32_bf16 v[120:123], v[216:219], v[204:207], v[120:123]
    v_mfma_f32_16x16x32_bf16 v[124:127], v[220:223], v[204:207], v[124:127]
    s_waitcnt lgkmcnt(0)
    v_mfma_f32_16x16x32_bf16 v[0:3], v[160:163], v[128:131], v[0:3]
    ds_read_b64_tr_b16 v[208:209], v234 offset:32768
    v_mfma_f32_16x16x32_bf16 v[4:7], v[164:167], v[128:131], v[4:7]
    ds_read_b64_tr_b16 v[210:211], v234 offset:33792
    v_mfma_f32_16x16x32_bf16 v[8:11], v[168:171], v[128:131], v[8:11]
    ds_read_b64_tr_b16 v[212:213], v237 offset:32768
    v_mfma_f32_16x16x32_bf16 v[12:15], v[172:175], v[128:131], v[12:15]
    ds_read_b64_tr_b16 v[214:215], v237 offset:33792
    v_mfma_f32_16x16x32_bf16 v[16:19], v[160:163], v[132:135], v[16:19]
    ds_read_b64_tr_b16 v[216:217], v234 offset:40960
    v_mfma_f32_16x16x32_bf16 v[20:23], v[164:167], v[132:135], v[20:23]
    v_mfma_f32_16x16x32_bf16 v[24:27], v[168:171], v[132:135], v[24:27]
    ds_read_b64_tr_b16 v[218:219], v234 offset:41984
    v_mfma_f32_16x16x32_bf16 v[28:31], v[172:175], v[132:135], v[28:31]
    ds_read_b64_tr_b16 v[220:221], v237 offset:40960
    v_mfma_f32_16x16x32_bf16 v[32:35], v[160:163], v[136:139], v[32:35]
    ds_read_b64_tr_b16 v[222:223], v237 offset:41984
    v_mfma_f32_16x16x32_bf16 v[36:39], v[164:167], v[136:139], v[36:39]
    ds_read_b128 v[176:179], v231 offset:32768
    v_mfma_f32_16x16x32_bf16 v[40:43], v[168:171], v[136:139], v[40:43]
    ds_read_b128 v[180:183], v231 offset:33792
    v_mfma_f32_16x16x32_bf16 v[44:47], v[172:175], v[136:139], v[44:47]
    v_mfma_f32_16x16x32_bf16 v[48:51], v[160:163], v[140:143], v[48:51]
    ds_read_b128 v[184:187], v231 offset:34816
    v_mfma_f32_16x16x32_bf16 v[52:55], v[164:167], v[140:143], v[52:55]
    ds_read_b128 v[188:191], v231 offset:35840
    v_mfma_f32_16x16x32_bf16 v[56:59], v[168:171], v[140:143], v[56:59]
    ds_read_b128 v[192:195], v231 offset:36864
    v_mfma_f32_16x16x32_bf16 v[60:63], v[172:175], v[140:143], v[60:63]
    ds_read_b128 v[196:199], v231 offset:37888
    v_mfma_f32_16x16x32_bf16 v[64:67], v[160:163], v[144:147], v[64:67]
    ds_read_b128 v[200:203], v231 offset:38912
    v_mfma_f32_16x16x32_bf16 v[68:71], v[164:167], v[144:147], v[68:71]
    v_mfma_f32_16x16x32_bf16 v[72:75], v[168:171], v[144:147], v[72:75]
    ds_read_b128 v[204:207], v231 offset:39936
    v_mfma_f32_16x16x32_bf16 v[76:79], v[172:175], v[144:147], v[76:79]
    v_mfma_f32_16x16x32_bf16 v[80:83], v[160:163], v[148:151], v[80:83]
    v_mfma_f32_16x16x32_bf16 v[84:87], v[164:167], v[148:151], v[84:87]
    v_mfma_f32_16x16x32_bf16 v[88:91], v[168:171], v[148:151], v[88:91]
    v_mfma_f32_16x16x32_bf16 v[92:95], v[172:175], v[148:151], v[92:95]
    v_mfma_f32_16x16x32_bf16 v[96:99], v[160:163], v[152:155], v[96:99]
    v_mfma_f32_16x16x32_bf16 v[100:103], v[164:167], v[152:155], v[100:103]
    v_mfma_f32_16x16x32_bf16 v[104:107], v[168:171], v[152:155], v[104:107]
    v_mfma_f32_16x16x32_bf16 v[108:111], v[172:175], v[152:155], v[108:111]
    v_mfma_f32_16x16x32_bf16 v[112:115], v[160:163], v[156:159], v[112:115]
    v_mfma_f32_16x16x32_bf16 v[116:119], v[164:167], v[156:159], v[116:119]
    v_mfma_f32_16x16x32_bf16 v[120:123], v[168:171], v[156:159], v[120:123]
    v_mfma_f32_16x16x32_bf16 v[124:127], v[172:175], v[156:159], v[124:127]
    s_waitcnt lgkmcnt(0)
    v_mfma_f32_16x16x32_bf16 v[0:3], v[208:211], v[176:179], v[0:3]
    v_mfma_f32_16x16x32_bf16 v[4:7], v[212:215], v[176:179], v[4:7]
    v_mfma_f32_16x16x32_bf16 v[8:11], v[216:219], v[176:179], v[8:11]
    v_mfma_f32_16x16x32_bf16 v[12:15], v[220:223], v[176:179], v[12:15]
    v_mfma_f32_16x16x32_bf16 v[16:19], v[208:211], v[180:183], v[16:19]
    v_mfma_f32_16x16x32_bf16 v[20:23], v[212:215], v[180:183], v[20:23]
    v_mfma_f32_16x16x32_bf16 v[24:27], v[216:219], v[180:183], v[24:27]
    v_mfma_f32_16x16x32_bf16 v[28:31], v[220:223], v[180:183], v[28:31]
    v_mfma_f32_16x16x32_bf16 v[32:35], v[208:211], v[184:187], v[32:35]
    v_mfma_f32_16x16x32_bf16 v[36:39], v[212:215], v[184:187], v[36:39]
    v_mfma_f32_16x16x32_bf16 v[40:43], v[216:219], v[184:187], v[40:43]
    v_mfma_f32_16x16x32_bf16 v[44:47], v[220:223], v[184:187], v[44:47]
    v_mfma_f32_16x16x32_bf16 v[48:51], v[208:211], v[188:191], v[48:51]
    v_mfma_f32_16x16x32_bf16 v[52:55], v[212:215], v[188:191], v[52:55]
    v_mfma_f32_16x16x32_bf16 v[56:59], v[216:219], v[188:191], v[56:59]
    v_mfma_f32_16x16x32_bf16 v[60:63], v[220:223], v[188:191], v[60:63]
    v_mfma_f32_16x16x32_bf16 v[64:67], v[208:211], v[192:195], v[64:67]
    v_mfma_f32_16x16x32_bf16 v[68:71], v[212:215], v[192:195], v[68:71]
    v_mfma_f32_16x16x32_bf16 v[72:75], v[216:219], v[192:195], v[72:75]
    v_mfma_f32_16x16x32_bf16 v[76:79], v[220:223], v[192:195], v[76:79]
    v_mfma_f32_16x16x32_bf16 v[80:83], v[208:211], v[196:199], v[80:83]
    v_mfma_f32_16x16x32_bf16 v[84:87], v[212:215], v[196:199], v[84:87]
    v_mfma_f32_16x16x32_bf16 v[88:91], v[216:219], v[196:199], v[88:91]
    v_mfma_f32_16x16x32_bf16 v[92:95], v[220:223], v[196:199], v[92:95]
    v_mfma_f32_16x16x32_bf16 v[96:99], v[208:211], v[200:203], v[96:99]
    v_mfma_f32_16x16x32_bf16 v[100:103], v[212:215], v[200:203], v[100:103]
    v_mfma_f32_16x16x32_bf16 v[104:107], v[216:219], v[200:203], v[104:107]
    v_mfma_f32_16x16x32_bf16 v[108:111], v[220:223], v[200:203], v[108:111]
    v_mfma_f32_16x16x32_bf16 v[112:115], v[208:211], v[204:207], v[112:115]
    v_mfma_f32_16x16x32_bf16 v[116:119], v[212:215], v[204:207], v[116:119]
    v_mfma_f32_16x16x32_bf16 v[120:123], v[216:219], v[204:207], v[120:123]
    v_mfma_f32_16x16x32_bf16 v[124:127], v[220:223], v[204:207], v[124:127]
ka_epi_4:
    s_nop 7
    s_lshl_b32 s83, s37, 1
    s_add_u32 s83, s83, s31
    s_mul_i32 s83, s83, 112
    s_lshl_b32 s26, s38, 2
    s_add_u32 s83, s83, s26
    s_add_u32 s83, s83, s32
    s_mul_i32 s83, s37, 28
    s_add_u32 s83, s83, s38
    s_add_u32 s83, s83, 2048
    s_lshl_b32 s83, s83, 7
    s_mov_b64 s[94:95], s[50:51]
    s_mov_b64 s[96:97], s[52:53]
    s_nop 4
    s_load_dwordx4 s[4:7], s[0:1], 48
    s_load_dwordx2 s[92:93], s[0:1], 0
    v_mov_b32 v192, v229
    s_and_b32 s26, s2, 7
    s_lshr_b32 s27, s2, 3
    s_and_b32 s33, s26, 1
    s_lshr_b32 s31, s26, 1
    s_lshl_b32 s31, s31, 2
    s_and_b32 s28, s27, 3
    s_add_u32 s31, s31, s28
    s_lshr_b32 s32, s27, 2
    s_lshr_b32 s38, s30, 2
    s_and_b32 s39, s30, 3
    s_mul_i32 s36, s33, 3670016
    s_mul_i32 s35, s33, 458752
    s_add_u32 s37, s35, 8192
    v_lshlrev_b32 v204, 4, v192
    v_lshrrev_b32 v200, 4, v192
    v_lshlrev_b32 v201, 1, v200
    v_and_b32 v202, 15, v192
    v_xor_b32 v202, v202, v201
    v_lshlrev_b32 v202, 4, v202
    s_lshl_b32 s26, s30, 4
    v_add_u32 v200, s26, v200
    v_lshlrev_b32 v200, 11, v200
    s_lshl_b32 s26, s32, 8
    v_add3_u32 v196, v200, v202, s26
    v_xor_b32 v201, 128, v196
    v_add_u32 v197, 7168, v196
    v_add_u32 v198, 14336, v201
    v_add_u32 v199, 21504, v201
    s_lshl_b32 s34, s30, 12
    s_mul_i32 s26, s31, 917504
    s_lshl_b32 s27, s39, 10
    s_add_u32 s26, s26, s27
    s_lshl_b32 s27, s33, 12
    s_add_u32 s26, s26, s27
    s_lshl_b32 s27, s38, 14
    s_add_u32 s26, s26, s27
    v_add_u32 v223, s26, v204
    v_xor_b32 v224, 0x1000, v223
    v_min_u32 v200, 31, v192
    v_lshlrev_b32 v200, 7, v200
    v_add_u32 v195, 491520, v200
    s_add_u32 s84, s24, 0x4000000
    s_addc_u32 s85, s25, 0
    s_and_b32 s85, s85, 0xffff
    s_mov_b32 s86, 0x400000
    s_mov_b32 s87, 0x20000
    s_mov_b32 s82, 1
    s_cmp_ge_u32 s30, 1
    s_cbranch_scc1 kf_z0_28
    global_load_dwordx2 v[200:201], v195, s[96:97] sc1
    s_mov_b32 s82, 0
kf_z0_28:
    v_pk_mul_f32 v[128:129], v[0:1], v[0:1]
    v_pk_mul_f32 v[130:131], v[2:3], v[2:3]
    v_pk_mul_f32 v[132:133], v[4:5], v[4:5]
    v_pk_mul_f32 v[134:135], v[6:7], v[6:7]
    v_pk_fma_f32 v[128:129], v[128:129], v[246:247], v[244:245]
    v_pk_fma_f32 v[130:131], v[130:131], v[246:247], v[244:245]
    v_pk_fma_f32 v[132:133], v[132:133], v[246:247], v[244:245]
    v_pk_fma_f32 v[134:135], v[134:135], v[246:247], v[244:245]
    v_pk_mul_f32 v[128:129], v[128:129], v[0:1]
    v_pk_mul_f32 v[130:131], v[130:131], v[2:3]
    v_pk_mul_f32 v[132:133], v[132:133], v[4:5]
    v_pk_mul_f32 v[134:135], v[134:135], v[6:7]
    v_exp_f32 v128, v128
    v_exp_f32 v129, v129
    v_exp_f32 v130, v130
    v_exp_f32 v131, v131
    v_exp_f32 v132, v132
    v_exp_f32 v133, v133
    v_exp_f32 v134, v134
    v_exp_f32 v135, v135
    v_pk_mul_f32 v[8:9], v[8:9], v[0:1]
    v_pk_mul_f32 v[10:11], v[10:11], v[2:3]
    v_pk_mul_f32 v[12:13], v[12:13], v[4:5]
    v_pk_mul_f32 v[14:15], v[14:15], v[6:7]
    v_pk_add_f32 v[128:129], v[128:129], v[248:249]
    v_pk_add_f32 v[130:131], v[130:131], v[248:249]
    v_pk_add_f32 v[132:133], v[132:133], v[248:249]
    v_pk_add_f32 v[134:135], v[134:135], v[248:249]
    v_rcp_f32 v128, v128
    v_rcp_f32 v129, v129
    v_rcp_f32 v130, v130
    v_rcp_f32 v131, v131
    v_rcp_f32 v132, v132
    v_rcp_f32 v133, v133
    v_rcp_f32 v134, v134
    v_rcp_f32 v135, v135
    s_mov_b32 s41, 0
    v_pk_mul_f32 v[128:129], v[128:129], v[8:9]
    v_pk_mul_f32 v[130:131], v[130:131], v[10:11]
    v_pk_mul_f32 v[132:133], v[132:133], v[12:13]
    v_pk_mul_f32 v[134:135], v[134:135], v[14:15]
    v_cvt_pk_bf16_f32 v136, v128, v129
    v_cvt_pk_bf16_f32 v137, v130, v131
    v_cvt_pk_bf16_f32 v138, v132, v133
    v_cvt_pk_bf16_f32 v139, v134, v135
    s_nop 1
    v_permlane16_swap_b32 v136, v138
    v_permlane16_swap_b32 v137, v139
    buffer_store_dwordx4 v[136:139], v243, s[20:23], s41 offen sc1
    v_pk_mul_f32 v[144:145], v[16:17], v[16:17]
    v_pk_mul_f32 v[146:147], v[18:19], v[18:19]
    v_pk_mul_f32 v[148:149], v[20:21], v[20:21]
    v_pk_mul_f32 v[150:151], v[22:23], v[22:23]
    v_pk_fma_f32 v[144:145], v[144:145], v[246:247], v[244:245]
    v_pk_fma_f32 v[146:147], v[146:147], v[246:247], v[244:245]
    v_pk_fma_f32 v[148:149], v[148:149], v[246:247], v[244:245]
    v_pk_fma_f32 v[150:151], v[150:151], v[246:247], v[244:245]
    v_pk_mul_f32 v[144:145], v[144:145], v[16:17]
    v_pk_mul_f32 v[146:147], v[146:147], v[18:19]
    v_pk_mul_f32 v[148:149], v[148:149], v[20:21]
    v_pk_mul_f32 v[150:151], v[150:151], v[22:23]
    v_exp_f32 v144, v144
    v_exp_f32 v145, v145
    v_exp_f32 v146, v146
    v_exp_f32 v147, v147
    v_exp_f32 v148, v148
    v_exp_f32 v149, v149
    v_exp_f32 v150, v150
    v_exp_f32 v151, v151
    v_pk_mul_f32 v[24:25], v[24:25], v[16:17]
    v_pk_mul_f32 v[26:27], v[26:27], v[18:19]
    v_pk_mul_f32 v[28:29], v[28:29], v[20:21]
    v_pk_mul_f32 v[30:31], v[30:31], v[22:23]
    v_pk_add_f32 v[144:145], v[144:145], v[248:249]
    v_pk_add_f32 v[146:147], v[146:147], v[248:249]
    v_pk_add_f32 v[148:149], v[148:149], v[248:249]
    v_pk_add_f32 v[150:151], v[150:151], v[248:249]
    v_rcp_f32 v144, v144
    v_rcp_f32 v145, v145
    v_rcp_f32 v146, v146
    v_rcp_f32 v147, v147
    v_rcp_f32 v148, v148
    v_rcp_f32 v149, v149
    v_rcp_f32 v150, v150
    v_rcp_f32 v151, v151
    s_mov_b32 s41, 1024
    v_pk_mul_f32 v[144:145], v[144:145], v[24:25]
    v_pk_mul_f32 v[146:147], v[146:147], v[26:27]
    v_pk_mul_f32 v[148:149], v[148:149], v[28:29]
    v_pk_mul_f32 v[150:151], v[150:151], v[30:31]
    v_cvt_pk_bf16_f32 v152, v144, v145
    v_cvt_pk_bf16_f32 v153, v146, v147
    v_cvt_pk_bf16_f32 v154, v148, v149
    v_cvt_pk_bf16_f32 v155, v150, v151
    s_nop 1
    v_permlane16_swap_b32 v152, v154
    v_permlane16_swap_b32 v153, v155
    buffer_store_dwordx4 v[152:155], v243, s[20:23], s41 offen sc1
    v_pk_mul_f32 v[128:129], v[32:33], v[32:33]
    v_pk_mul_f32 v[130:131], v[34:35], v[34:35]
    v_pk_mul_f32 v[132:133], v[36:37], v[36:37]
    v_pk_mul_f32 v[134:135], v[38:39], v[38:39]
    v_pk_fma_f32 v[128:129], v[128:129], v[246:247], v[244:245]
    v_pk_fma_f32 v[130:131], v[130:131], v[246:247], v[244:245]
    v_pk_fma_f32 v[132:133], v[132:133], v[246:247], v[244:245]
    v_pk_fma_f32 v[134:135], v[134:135], v[246:247], v[244:245]
    v_pk_mul_f32 v[128:129], v[128:129], v[32:33]
    v_pk_mul_f32 v[130:131], v[130:131], v[34:35]
    v_pk_mul_f32 v[132:133], v[132:133], v[36:37]
    v_pk_mul_f32 v[134:135], v[134:135], v[38:39]
    v_exp_f32 v128, v128
    v_exp_f32 v129, v129
    v_exp_f32 v130, v130
    v_exp_f32 v131, v131
    v_exp_f32 v132, v132
    v_exp_f32 v133, v133
    v_exp_f32 v134, v134
    v_exp_f32 v135, v135
    v_pk_mul_f32 v[40:41], v[40:41], v[32:33]
    v_pk_mul_f32 v[42:43], v[42:43], v[34:35]
    v_pk_mul_f32 v[44:45], v[44:45], v[36:37]
    v_pk_mul_f32 v[46:47], v[46:47], v[38:39]
    v_pk_add_f32 v[128:129], v[128:129], v[248:249]
    v_pk_add_f32 v[130:131], v[130:131], v[248:249]
    v_pk_add_f32 v[132:133], v[132:133], v[248:249]
    v_pk_add_f32 v[134:135], v[134:135], v[248:249]
    v_rcp_f32 v128, v128
    v_rcp_f32 v129, v129
    v_rcp_f32 v130, v130
    v_rcp_f32 v131, v131
    v_rcp_f32 v132, v132
    v_rcp_f32 v133, v133
    v_rcp_f32 v134, v134
    v_rcp_f32 v135, v135
    s_mov_b32 s41, 2048
    v_pk_mul_f32 v[128:129], v[128:129], v[40:41]
    v_pk_mul_f32 v[130:131], v[130:131], v[42:43]
    v_pk_mul_f32 v[132:133], v[132:133], v[44:45]
    v_pk_mul_f32 v[134:135], v[134:135], v[46:47]
    v_cvt_pk_bf16_f32 v136, v128, v129
    v_cvt_pk_bf16_f32 v137, v130, v131
    v_cvt_pk_bf16_f32 v138, v132, v133
    v_cvt_pk_bf16_f32 v139, v134, v135
    s_nop 1
    v_permlane16_swap_b32 v136, v138
    v_permlane16_swap_b32 v137, v139
    buffer_store_dwordx4 v[136:139], v243, s[20:23], s41 offen sc1
    v_pk_mul_f32 v[144:145], v[48:49], v[48:49]
    v_pk_mul_f32 v[146:147], v[50:51], v[50:51]
    v_pk_mul_f32 v[148:149], v[52:53], v[52:53]
    v_pk_mul_f32 v[150:151], v[54:55], v[54:55]
    v_pk_fma_f32 v[144:145], v[144:145], v[246:247], v[244:245]
    v_pk_fma_f32 v[146:147], v[146:147], v[246:247], v[244:245]
    v_pk_fma_f32 v[148:149], v[148:149], v[246:247], v[244:245]
    v_pk_fma_f32 v[150:151], v[150:151], v[246:247], v[244:245]
    v_pk_mul_f32 v[144:145], v[144:145], v[48:49]
    v_pk_mul_f32 v[146:147], v[146:147], v[50:51]
    v_pk_mul_f32 v[148:149], v[148:149], v[52:53]
    v_pk_mul_f32 v[150:151], v[150:151], v[54:55]
    v_exp_f32 v144, v144
    v_exp_f32 v145, v145
    v_exp_f32 v146, v146
    v_exp_f32 v147, v147
    v_exp_f32 v148, v148
    v_exp_f32 v149, v149
    v_exp_f32 v150, v150
    v_exp_f32 v151, v151
    v_pk_mul_f32 v[56:57], v[56:57], v[48:49]
    v_pk_mul_f32 v[58:59], v[58:59], v[50:51]
    v_pk_mul_f32 v[60:61], v[60:61], v[52:53]
    v_pk_mul_f32 v[62:63], v[62:63], v[54:55]
    v_pk_add_f32 v[144:145], v[144:145], v[248:249]
    v_pk_add_f32 v[146:147], v[146:147], v[248:249]
    v_pk_add_f32 v[148:149], v[148:149], v[248:249]
    v_pk_add_f32 v[150:151], v[150:151], v[248:249]
    v_rcp_f32 v144, v144
    v_rcp_f32 v145, v145
    v_rcp_f32 v146, v146
    v_rcp_f32 v147, v147
    v_rcp_f32 v148, v148
    v_rcp_f32 v149, v149
    v_rcp_f32 v150, v150
    v_rcp_f32 v151, v151
    s_mov_b32 s41, 3072
    v_pk_mul_f32 v[144:145], v[144:145], v[56:57]
    v_pk_mul_f32 v[146:147], v[146:147], v[58:59]
    v_pk_mul_f32 v[148:149], v[148:149], v[60:61]
    v_pk_mul_f32 v[150:151], v[150:151], v[62:63]
    v_cvt_pk_bf16_f32 v152, v144, v145
    v_cvt_pk_bf16_f32 v153, v146, v147
    v_cvt_pk_bf16_f32 v154, v148, v149
    v_cvt_pk_bf16_f32 v155, v150, v151
    s_nop 1
    v_permlane16_swap_b32 v152, v154
    v_permlane16_swap_b32 v153, v155
    buffer_store_dwordx4 v[152:155], v243, s[20:23], s41 offen sc1
    s_cmp_eq_u32 s82, 1
    s_cbranch_scc1 kf_nz_29
    s_waitcnt vmcnt(4)
    v_cmp_eq_u64 vcc, s[94:95], v[200:201]
    s_nop 1
    s_cmp_eq_u64 vcc, -1
    s_cbranch_scc0 kf_nz_29
    s_mul_i32 s26, s30, 16384
    s_lshl_b32 s27, s2, 14
    s_add_u32 s27, s26, s27
    s_add_u32 m0, s26, 131072
    s_add_u32 s28, s27, 0
    buffer_load_dwordx4 v204, s[84:87], s28 offen offset:0 sc1 lds
    buffer_load_dwordx4 v204, s[84:87], s28 offen offset:1024 sc1 lds
    buffer_load_dwordx4 v204, s[84:87], s28 offen offset:2048 sc1 lds
    buffer_load_dwordx4 v204, s[84:87], s28 offen offset:3072 sc1 lds
    s_add_u32 m0, s26, 135168
    s_add_u32 s28, s27, 4096
    buffer_load_dwordx4 v204, s[84:87], s28 offen offset:0 sc1 lds
    buffer_load_dwordx4 v204, s[84:87], s28 offen offset:1024 sc1 lds
    buffer_load_dwordx4 v204, s[84:87], s28 offen offset:2048 sc1 lds
    buffer_load_dwordx4 v204, s[84:87], s28 offen offset:3072 sc1 lds
    s_add_u32 m0, s26, 139264
    s_add_u32 s28, s27, 8192
    buffer_load_dwordx4 v204, s[84:87], s28 offen offset:0 sc1 lds
    buffer_load_dwordx4 v204, s[84:87], s28 offen offset:1024 sc1 lds
    buffer_load_dwordx4 v204, s[84:87], s28 offen offset:2048 sc1 lds
    buffer_load_dwordx4 v204, s[84:87], s28 offen offset:3072 sc1 lds
    s_add_u32 m0, s26, 143360
    s_add_u32 s28, s27, 12288
    buffer_load_dwordx4 v204, s[84:87], s28 offen offset:0 sc1 lds
    buffer_load_dwordx4 v204, s[84:87], s28 offen offset:1024 sc1 lds
    buffer_load_dwordx4 v204, s[84:87], s28 offen offset:2048 sc1 lds
    buffer_load_dwordx4 v204, s[84:87], s28 offen offset:3072 sc1 lds
    s_mov_b32 s82, 1
kf_nz_29:
    s_waitcnt lgkmcnt(0)
    s_mov_b32 s12, s4
    s_mov_b32 s13, s5
    s_and_b32 s13, s13, 0xffff
    s_mov_b32 s14, 0x700000
    s_mov_b32 s15, 0x20000
    s_barrier
    s_add_u32 m0, s34, 0
    s_nop 0
    buffer_load_dwordx4 v196, s[12:15], s36 offen offset:0  lds
    buffer_load_dwordx4 v197, s[12:15], s36 offen offset:1024  lds
    buffer_load_dwordx4 v198, s[12:15], s36 offen offset:2048  lds
    buffer_load_dwordx4 v199, s[12:15], s36 offen offset:3072  lds
    s_add_u32 s36, s36, 262144
    v_pk_mul_f32 v[128:129], v[64:65], v[64:65]
    v_pk_mul_f32 v[130:131], v[66:67], v[66:67]
    v_pk_mul_f32 v[132:133], v[68:69], v[68:69]
    v_pk_mul_f32 v[134:135], v[70:71], v[70:71]
    v_pk_fma_f32 v[128:129], v[128:129], v[246:247], v[244:245]
    v_pk_fma_f32 v[130:131], v[130:131], v[246:247], v[244:245]
    v_pk_fma_f32 v[132:133], v[132:133], v[246:247], v[244:245]
    v_pk_fma_f32 v[134:135], v[134:135], v[246:247], v[244:245]
    v_pk_mul_f32 v[128:129], v[128:129], v[64:65]
    v_pk_mul_f32 v[130:131], v[130:131], v[66:67]
    v_pk_mul_f32 v[132:133], v[132:133], v[68:69]
    v_pk_mul_f32 v[134:135], v[134:135], v[70:71]
    v_exp_f32 v128, v128
    v_exp_f32 v129, v129
    v_exp_f32 v130, v130
    v_exp_f32 v131, v131
    v_exp_f32 v132, v132
    v_exp_f32 v133, v133
    v_exp_f32 v134, v134
    v_exp_f32 v135, v135
    v_pk_mul_f32 v[72:73], v[72:73], v[64:65]
    v_pk_mul_f32 v[74:75], v[74:75], v[66:67]
    v_pk_mul_f32 v[76:77], v[76:77], v[68:69]
    v_pk_mul_f32 v[78:79], v[78:79], v[70:71]
    v_pk_add_f32 v[128:129], v[128:129], v[248:249]
    v_pk_add_f32 v[130:131], v[130:131], v[248:249]
    v_pk_add_f32 v[132:133], v[132:133], v[248:249]
    v_pk_add_f32 v[134:135], v[134:135], v[248:249]
    v_rcp_f32 v128, v128
    v_rcp_f32 v129, v129
    v_rcp_f32 v130, v130
    v_rcp_f32 v131, v131
    v_rcp_f32 v132, v132
    v_rcp_f32 v133, v133
    v_rcp_f32 v134, v134
    v_rcp_f32 v135, v135
    s_mov_b32 s41, 4096
    v_pk_mul_f32 v[128:129], v[128:129], v[72:73]
    v_pk_mul_f32 v[130:131], v[130:131], v[74:75]
    v_pk_mul_f32 v[132:133], v[132:133], v[76:77]
    v_pk_mul_f32 v[134:135], v[134:135], v[78:79]
    v_cvt_pk_bf16_f32 v136, v128, v129
    v_cvt_pk_bf16_f32 v137, v130, v131
    v_cvt_pk_bf16_f32 v138, v132, v133
    v_cvt_pk_bf16_f32 v139, v134, v135
    s_nop 1
    v_permlane16_swap_b32 v136, v138
    v_permlane16_swap_b32 v137, v139
    buffer_store_dwordx4 v[136:139], v243, s[20:23], s41 offen sc1
    v_pk_mul_f32 v[144:145], v[80:81], v[80:81]
    v_pk_mul_f32 v[146:147], v[82:83], v[82:83]
    v_pk_mul_f32 v[148:149], v[84:85], v[84:85]
    v_pk_mul_f32 v[150:151], v[86:87], v[86:87]
    v_pk_fma_f32 v[144:145], v[144:145], v[246:247], v[244:245]
    v_pk_fma_f32 v[146:147], v[146:147], v[246:247], v[244:245]
    v_pk_fma_f32 v[148:149], v[148:149], v[246:247], v[244:245]
    v_pk_fma_f32 v[150:151], v[150:151], v[246:247], v[244:245]
    v_pk_mul_f32 v[144:145], v[144:145], v[80:81]
    v_pk_mul_f32 v[146:147], v[146:147], v[82:83]
    v_pk_mul_f32 v[148:149], v[148:149], v[84:85]
    v_pk_mul_f32 v[150:151], v[150:151], v[86:87]
    v_exp_f32 v144, v144
    v_exp_f32 v145, v145
    v_exp_f32 v146, v146
    v_exp_f32 v147, v147
    v_exp_f32 v148, v148
    v_exp_f32 v149, v149
    v_exp_f32 v150, v150
    v_exp_f32 v151, v151
    v_pk_mul_f32 v[88:89], v[88:89], v[80:81]
    v_pk_mul_f32 v[90:91], v[90:91], v[82:83]
    v_pk_mul_f32 v[92:93], v[92:93], v[84:85]
    v_pk_mul_f32 v[94:95], v[94:95], v[86:87]
    v_pk_add_f32 v[144:145], v[144:145], v[248:249]
    v_pk_add_f32 v[146:147], v[146:147], v[248:249]
    v_pk_add_f32 v[148:149], v[148:149], v[248:249]
    v_pk_add_f32 v[150:151], v[150:151], v[248:249]
    v_rcp_f32 v144, v144
    v_rcp_f32 v145, v145
    v_rcp_f32 v146, v146
    v_rcp_f32 v147, v147
    v_rcp_f32 v148, v148
    v_rcp_f32 v149, v149
    v_rcp_f32 v150, v150
    v_rcp_f32 v151, v151
    s_mov_b32 s41, 5120
    v_pk_mul_f32 v[144:145], v[144:145], v[88:89]
    v_pk_mul_f32 v[146:147], v[146:147], v[90:91]
    v_pk_mul_f32 v[148:149], v[148:149], v[92:93]
    v_pk_mul_f32 v[150:151], v[150:151], v[94:95]
    v_cvt_pk_bf16_f32 v152, v144, v145
    v_cvt_pk_bf16_f32 v153, v146, v147
    v_cvt_pk_bf16_f32 v154, v148, v149
    v_cvt_pk_bf16_f32 v155, v150, v151
    s_nop 1
    v_permlane16_swap_b32 v152, v154
    v_permlane16_swap_b32 v153, v155
    buffer_store_dwordx4 v[152:155], v243, s[20:23], s41 offen sc1
    v_pk_mul_f32 v[128:129], v[96:97], v[96:97]
    v_pk_mul_f32 v[130:131], v[98:99], v[98:99]
    v_pk_mul_f32 v[132:133], v[100:101], v[100:101]
    v_pk_mul_f32 v[134:135], v[102:103], v[102:103]
    v_pk_fma_f32 v[128:129], v[128:129], v[246:247], v[244:245]
    v_pk_fma_f32 v[130:131], v[130:131], v[246:247], v[244:245]
    v_pk_fma_f32 v[132:133], v[132:133], v[246:247], v[244:245]
    v_pk_fma_f32 v[134:135], v[134:135], v[246:247], v[244:245]
    v_pk_mul_f32 v[128:129], v[128:129], v[96:97]
    v_pk_mul_f32 v[130:131], v[130:131], v[98:99]
    v_pk_mul_f32 v[132:133], v[132:133], v[100:101]
    v_pk_mul_f32 v[134:135], v[134:135], v[102:103]
    v_exp_f32 v128, v128
    v_exp_f32 v129, v129
    v_exp_f32 v130, v130
    v_exp_f32 v131, v131
    v_exp_f32 v132, v132
    v_exp_f32 v133, v133
    v_exp_f32 v134, v134
    v_exp_f32 v135, v135
    v_pk_mul_f32 v[104:105], v[104:105], v[96:97]
    v_pk_mul_f32 v[106:107], v[106:107], v[98:99]
    v_pk_mul_f32 v[108:109], v[108:109], v[100:101]
    v_pk_mul_f32 v[110:111], v[110:111], v[102:103]
    v_pk_add_f32 v[128:129], v[128:129], v[248:249]
    v_pk_add_f32 v[130:131], v[130:131], v[248:249]
    v_pk_add_f32 v[132:133], v[132:133], v[248:249]
    v_pk_add_f32 v[134:135], v[134:135], v[248:249]
    v_rcp_f32 v128, v128
    v_rcp_f32 v129, v129
    v_rcp_f32 v130, v130
    v_rcp_f32 v131, v131
    v_rcp_f32 v132, v132
    v_rcp_f32 v133, v133
    v_rcp_f32 v134, v134
    v_rcp_f32 v135, v135
    s_mov_b32 s41, 6144
    v_pk_mul_f32 v[128:129], v[128:129], v[104:105]
    v_pk_mul_f32 v[130:131], v[130:131], v[106:107]
    v_pk_mul_f32 v[132:133], v[132:133], v[108:109]
    v_pk_mul_f32 v[134:135], v[134:135], v[110:111]
    v_cvt_pk_bf16_f32 v136, v128, v129
    v_cvt_pk_bf16_f32 v137, v130, v131
    v_cvt_pk_bf16_f32 v138, v132, v133
    v_cvt_pk_bf16_f32 v139, v134, v135
    s_nop 1
    v_permlane16_swap_b32 v136, v138
    v_permlane16_swap_b32 v137, v139
    buffer_store_dwordx4 v[136:139], v243, s[20:23], s41 offen sc1
    v_pk_mul_f32 v[144:145], v[112:113], v[112:113]
    v_pk_mul_f32 v[146:147], v[114:115], v[114:115]
    v_pk_mul_f32 v[148:149], v[116:117], v[116:117]
    v_pk_mul_f32 v[150:151], v[118:119], v[118:119]
    v_pk_fma_f32 v[144:145], v[144:145], v[246:247], v[244:245]
    v_pk_fma_f32 v[146:147], v[146:147], v[246:247], v[244:245]
    v_pk_fma_f32 v[148:149], v[148:149], v[246:247], v[244:245]
    v_pk_fma_f32 v[150:151], v[150:151], v[246:247], v[244:245]
    v_pk_mul_f32 v[144:145], v[144:145], v[112:113]
    v_pk_mul_f32 v[146:147], v[146:147], v[114:115]
    v_pk_mul_f32 v[148:149], v[148:149], v[116:117]
    v_pk_mul_f32 v[150:151], v[150:151], v[118:119]
    v_exp_f32 v144, v144
    v_exp_f32 v145, v145
    v_exp_f32 v146, v146
    v_exp_f32 v147, v147
    v_exp_f32 v148, v148
    v_exp_f32 v149, v149
    v_exp_f32 v150, v150
    v_exp_f32 v151, v151
    v_pk_mul_f32 v[120:121], v[120:121], v[112:113]
    v_pk_mul_f32 v[122:123], v[122:123], v[114:115]
    v_pk_mul_f32 v[124:125], v[124:125], v[116:117]
    v_pk_mul_f32 v[126:127], v[126:127], v[118:119]
    v_pk_add_f32 v[144:145], v[144:145], v[248:249]
    v_pk_add_f32 v[146:147], v[146:147], v[248:249]
    v_pk_add_f32 v[148:149], v[148:149], v[248:249]
    v_pk_add_f32 v[150:151], v[150:151], v[248:249]
    v_rcp_f32 v144, v144
    v_rcp_f32 v145, v145
    v_rcp_f32 v146, v146
    v_rcp_f32 v147, v147
    v_rcp_f32 v148, v148
    v_rcp_f32 v149, v149
    v_rcp_f32 v150, v150
    v_rcp_f32 v151, v151
    s_mov_b32 s41, 7168
    v_pk_mul_f32 v[144:145], v[144:145], v[120:121]
    v_pk_mul_f32 v[146:147], v[146:147], v[122:123]
    v_pk_mul_f32 v[148:149], v[148:149], v[124:125]
    v_pk_mul_f32 v[150:151], v[150:151], v[126:127]
    v_cvt_pk_bf16_f32 v152, v144, v145
    v_cvt_pk_bf16_f32 v153, v146, v147
    v_cvt_pk_bf16_f32 v154, v148, v149
    v_cvt_pk_bf16_f32 v155, v150, v151
    s_nop 1
    v_permlane16_swap_b32 v152, v154
    v_permlane16_swap_b32 v153, v155
    buffer_store_dwordx4 v[152:155], v243, s[20:23], s41 offen sc1
ka_p2_30:
    s_cmp_eq_u32 s82, 1
    s_cbranch_scc1 kf_zok_31
pollf_32:
    s_sleep 4
    global_load_dwordx2 v[0:1], v195, s[96:97] offset:0 sc1
    s_waitcnt vmcnt(0)
    v_cmp_eq_u64 vcc, s[94:95], v[0:1]
    s_nop 1
    s_cmp_eq_u64 vcc, -1
    s_cbranch_scc0 pollf_32
    s_mul_i32 s26, s30, 16384
    s_lshl_b32 s27, s2, 14
    s_add_u32 s27, s26, s27
    s_add_u32 m0, s26, 131072
    s_add_u32 s28, s27, 0
    buffer_load_dwordx4 v204, s[84:87], s28 offen offset:0 sc1 lds
    buffer_load_dwordx4 v204, s[84:87], s28 offen offset:1024 sc1 lds
    buffer_load_dwordx4 v204, s[84:87], s28 offen offset:2048 sc1 lds
    buffer_load_dwordx4 v204, s[84:87], s28 offen offset:3072 sc1 lds
    s_add_u32 m0, s26, 135168
    s_add_u32 s28, s27, 4096
    buffer_load_dwordx4 v204, s[84:87], s28 offen offset:0 sc1 lds
    buffer_load_dwordx4 v204, s[84:87], s28 offen offset:1024 sc1 lds
    buffer_load_dwordx4 v204, s[84:87], s28 offen offset:2048 sc1 lds
    buffer_load_dwordx4 v204, s[84:87], s28 offen offset:3072 sc1 lds
    s_add_u32 m0, s26, 139264
    s_add_u32 s28, s27, 8192
    buffer_load_dwordx4 v204, s[84:87], s28 offen offset:0 sc1 lds
    buffer_load_dwordx4 v204, s[84:87], s28 offen offset:1024 sc1 lds
    buffer_load_dwordx4 v204, s[84:87], s28 offen offset:2048 sc1 lds
    buffer_load_dwordx4 v204, s[84:87], s28 offen offset:3072 sc1 lds
    s_add_u32 m0, s26, 143360
    s_add_u32 s28, s27, 12288
    buffer_load_dwordx4 v204, s[84:87], s28 offen offset:0 sc1 lds
    buffer_load_dwordx4 v204, s[84:87], s28 offen offset:1024 sc1 lds
    buffer_load_dwordx4 v204, s[84:87], s28 offen offset:2048 sc1 lds
    buffer_load_dwordx4 v204, s[84:87], s28 offen offset:3072 sc1 lds
    s_waitcnt vmcnt(0)
kf_zok_31:
    s_add_u32 s8, s24, 0x800000
    s_addc_u32 s9, s25, 0
    s_and_b32 s9, s9, 0xffff
    s_mov_b32 s10, 0xe00000
    s_mov_b32 s11, 0x20000
    v_bfe_u32 v201, v192, 2, 1
    v_lshlrev_b32 v201, 4, v201
    v_bfe_u32 v202, v192, 3, 2
    v_lshl_add_u32 v201, v202, 2, v201
    v_and_b32 v202, 3, v192
    v_add_u32 v4, v201, v202
    v_add_u32 v7, 147456, v204
    s_cmp_ge_u32 s30, 5
    s_cbranch_scc1 kb_jend_33
    v_mov_b32 v5, v4
    s_add_u32 s26, s30, 1
    s_lshr_b32 s26, s26, 1
    s_cmp_lg_u32 s26, 1
    s_cbranch_scc1 kb_jn_36
    v_and_b32 v5, 31, v192
kb_jn_36:
    s_cmp_eq_u32 s26, 2
    s_cselect_b32 s27, 1023, 31
    s_mov_b32 s28, 0x3d000000
    s_cselect_b32 s28, 0x3a800000, s28
    s_add_u32 s29, s30, 1
    s_and_b32 s29, s29, 1
    s_cmp_eq_u32 s30, 0
    s_cselect_b32 s29, 0, s29
    s_lshl_b32 s40, s29, 4
    v_lshrrev_b32 v6, 5, v192
    v_lshl_add_u32 v6, v6, 2, s40
    v_mul_u32_u24 v6, v6, v5
    v_mad_u32_u24 v64, 0, v5, v6
    v_mad_u32_u24 v65, 1, v5, v6
    v_mad_u32_u24 v66, 2, v5, v6
    v_mad_u32_u24 v67, 3, v5, v6
    v_mad_u32_u24 v68, 8, v5, v6
    v_mad_u32_u24 v69, 9, v5, v6
    v_mad_u32_u24 v70, 10, v5, v6
    v_mad_u32_u24 v71, 11, v5, v6
    v_and_b32 v64, s27, v64
    v_and_b32 v65, s27, v65
    v_and_b32 v66, s27, v66
    v_and_b32 v67, s27, v67
    v_and_b32 v68, s27, v68
    v_and_b32 v69, s27, v69
    v_and_b32 v70, s27, v70
    v_and_b32 v71, s27, v71
    v_cvt_f32_u32 v64, v64
    v_cvt_f32_u32 v65, v65
    v_cvt_f32_u32 v66, v66
    v_cvt_f32_u32 v67, v67
    v_cvt_f32_u32 v68, v68
    v_cvt_f32_u32 v69, v69
    v_cvt_f32_u32 v70, v70
    v_cvt_f32_u32 v71, v71
    v_mul_f32 v64, s28, v64
    v_mul_f32 v65, s28, v65
    v_mul_f32 v66, s28, v66
    v_mul_f32 v67, s28, v67
    v_mul_f32 v68, s28, v68
    v_mul_f32 v69, s28, v69
    v_mul_f32 v70, s28, v70
    v_mul_f32 v71, s28, v71
    v_cos_f32 v72, v64
    v_cos_f32 v73, v65
    v_cos_f32 v74, v66
    v_cos_f32 v75, v67
    v_cos_f32 v76, v68
    v_cos_f32 v77, v69
    v_cos_f32 v78, v70
    v_cos_f32 v79, v71
    v_sin_f32 v80, v64
    v_sin_f32 v81, v65
    v_sin_f32 v82, v66
    v_sin_f32 v83, v67
    v_sin_f32 v84, v68
    v_sin_f32 v85, v69
    v_sin_f32 v86, v70
    v_sin_f32 v87, v71
    s_cmp_eq_u32 s26, 2
    s_cbranch_scc1 kb_jtw_34
    v_cvt_pk_bf16_f32 v88, v72, v73
    v_cvt_pk_bf16_f32 v89, v74, v75
    v_cvt_pk_bf16_f32 v90, v76, v77
    v_cvt_pk_bf16_f32 v91, v78, v79
    v_cvt_pk_bf16_f32 v92, -v80, -v81
    v_cvt_pk_bf16_f32 v93, -v82, -v83
    v_cvt_pk_bf16_f32 v94, -v84, -v85
    v_cvt_pk_bf16_f32 v95, -v86, -v87
    s_cmp_eq_u32 s26, 0
    s_cbranch_scc1 kb_jb1_35
    s_lshl_b32 s29, s29, 10
    v_add_u32 v6, s29, v7
    ds_write_b128 v6, v[88:91] offset:4096
    ds_write_b128 v6, v[92:95] offset:6144
    s_branch kb_jend_33
kb_jb1_35:
    v_cvt_pk_bf16_f32 v96, v80, v81
    v_cvt_pk_bf16_f32 v97, v82, v83
    v_cvt_pk_bf16_f32 v98, v84, v85
    v_cvt_pk_bf16_f32 v99, v86, v87
    ds_write_b128 v7, v[88:91]
    ds_write_b128 v7, v[92:95] offset:1024
    ds_write_b128 v7, v[96:99] offset:2048
    ds_write_b128 v7, v[88:91] offset:3072
    s_branch kb_jend_33
kb_jtw_34:
    s_lshl_b32 s29, s29, 11
    v_add_u32 v6, s29, v7
    ds_write_b128 v6, v[72:75] offset:8192
    ds_write_b128 v6, v[80:83] offset:12288
    ds_write_b128 v6, v[76:79] offset:9216
    ds_write_b128 v6, v[84:87] offset:13312
kb_jend_33:
    s_mov_b32 s16, s6
    s_mov_b32 s17, s7
    s_and_b32 s17, s17, 0xffff
    s_mov_b32 s18, 0x400000
    s_mov_b32 s19, 0x20000
    s_mov_b32 s88, s92
    s_mov_b32 s89, s93
    s_and_b32 s89, s89, 0xffff
    s_mov_b32 s90, 0x400000
    s_mov_b32 s91, 0x20000
    s_add_u32 s20, s24, 0x2800000
    s_addc_u32 s21, s25, 0
    s_and_b32 s21, s21, 0xffff
    s_mov_b32 s22, 0x400000
    s_mov_b32 s23, 0x20000
    s_add_u32 s44, s24, 0x3000000
    s_addc_u32 s45, s25, 0
    s_and_b32 s45, s45, 0xffff
    s_mov_b32 s46, 0xc00000
    s_mov_b32 s47, 0x20000
    v_lshrrev_b32 v200, 4, v192
    v_bfe_u32 v201, v192, 2, 2
    v_lshlrev_b32 v202, 11, v200
    v_lshlrev_b32 v203, 8, v201
    s_lshl_b32 s26, s38, 14
    v_add3_u32 v202, v202, v203, s26
    v_and_b32 v200, 1, v200
    v_lshl_or_b32 v201, v200, 2, v201
    v_lshlrev_b32 v201, 5, v201
    v_and_b32 v203, 3, v192
    v_lshlrev_b32 v203, 3, v203
    v_add3_u32 v207, v202, v201, v203
    v_xor_b32 v208, 32, v207
    v_xor_b32 v209, 64, v207
    v_xor_b32 v210, 96, v207
    v_xor_b32 v211, 128, v207
    v_xor_b32 v212, 160, v207
    v_xor_b32 v213, 192, v207
    v_xor_b32 v214, 224, v207
    v_add_u32 v215, 0x10000, v207
    v_add_u32 v216, 0x10000, v208
    v_add_u32 v217, 0x10000, v209
    v_add_u32 v218, 0x10000, v210
    v_add_u32 v219, 0x10000, v211
    v_add_u32 v220, 0x10000, v212
    v_add_u32 v221, 0x10000, v213
    v_add_u32 v222, 0x10000, v214
    v_and_b32 v200, 3, v192
    v_bfe_u32 v201, v192, 2, 2
    v_lshl_add_u32 v200, v200, 6, v201
    s_lshl_b32 s27, s39, 2
    s_lshl_b32 s28, s33, 4
    s_add_u32 s27, s27, s28
    s_lshr_b32 s26, s31, 1
    s_and_b32 s28, s31, 1
    s_lshl_b32 s52, s28, 1
    s_lshr_b32 s29, s26, 2
    s_add_u32 s52, s52, s29
    s_lshl_b32 s52, s52, 1
    s_and_b32 s29, s26, 1
    s_add_u32 s52, s52, s29
    s_lshl_b32 s52, s52, 5
    s_add_u32 s52, s52, s27
    s_add_u32 s52, s52, 3904
    s_lshl_b32 s52, s52, 7
    s_lshl_b32 s26, s26, 8
    s_lshl_b32 s28, s28, 5
    s_add_u32 s26, s26, s28
    s_add_u32 s26, s26, s27
    v_add_u32 v200, s26, v200
    v_lshlrev_b32 v200, 11, v200
    v_lshrrev_b32 v201, 5, v192
    v_lshlrev_b32 v201, 4, v201
    v_and_b32 v202, 16, v192
    v_lshlrev_b32 v202, 1, v202
    v_add3_u32 v200, v200, v201, v202
    s_lshl_b32 s26, s32, 8
    v_add_u32 v193, s26, v200
    s_lshl_b32 s26, s31, 3
    s_add_u32 s26, s26, s32
    s_lshl_b32 s26, s26, 1
    s_add_u32 s26, s26, s33
    s_xor_b32 s27, s26, 1
    s_mul_i32 s28, s39, 12288
    s_mul_i32 s48, s26, 49152
    s_add_u32 s48, s48, s28
    s_mul_i32 s49, s27, 49152
    s_add_u32 s49, s49, s28
    s_lshl_b32 s28, s39, 7
    s_add_u32 s28, s28, 532480
    s_lshl_b32 s50, s26, 9
    s_add_u32 s50, s50, s28
    s_lshl_b32 s51, s27, 9
    s_add_u32 s51, s51, s28
    v_add_u32 v205, 4096, v204
    s_lshl_b32 s26, s30, 13
    v_add_u32 v206, s26, v204
    s_and_b32 s53, s2, 31
    s_lshr_b32 s26, s2, 7
    s_lshl_b32 s26, s26, 5
    s_add_u32 s53, s53, s26
    s_bfe_u32 s26, s2, 0x10006
    s_lshl_b32 s26, s26, 10
    s_add_u32 s53, s53, s26
    s_bfe_u32 s26, s2, 0x10005
    s_lshl_b32 s26, s26, 8
    s_add_u32 s53, s53, s26
    s_lshl_b32 s26, s38, 9
    s_add_u32 s53, s53, s26
    s_lshl_b32 s26, s39, 6
    s_add_u32 s53, s53, s26
    s_lshl_b32 s53, s53, 11
    v_lshrrev_b32 v200, 5, v192
    v_and_b32 v201, 31, v192
    v_lshlrev_b32 v8, 11, v200
    v_lshl_add_u32 v8, v201, 4, v8
    s_lshl_b32 s26, s30, 1
    s_add_u32 s26, s26, 131072
    v_add_u32 v8, s26, v8
    v_mov_b32 v9, s26
    s_lshr_b32 s26, s31, 1
    s_mul_i32 s26, s26, 28
    s_mul_i32 s27, s33, 14
    s_add_u32 s26, s26, s27
    s_add_u32 s26, s26, 2048
    v_min_u32 v200, 13, v192
    v_add_u32 v200, s26, v200
    v_lshlrev_b32 v195, 7, v200
    s_waitcnt vmcnt(0) lgkmcnt(0)
    s_barrier
    s_cmp_lg_u32 s30, 6
    s_cbranch_scc1 kf_hw_37
    s_waitcnt vmcnt(0)
    s_cmp_eq_u32 s83, -1
    s_cbranch_scc1 kf_nh_38
    v_mov_b32 v0, s94
    v_mov_b32 v1, s95
    v_mov_b32 v2, s83
    s_mov_b64 exec, 1
    global_store_dwordx2 v2, v[0:1], s[96:97] sc1
    s_mov_b64 exec, -1
    s_mov_b32 s83, -1
kf_nh_38:
kf_hw_37:
    s_add_u32 m0, s34, 32768
    s_nop 0
    buffer_load_dwordx4 v196, s[12:15], s36 offen offset:0  lds
    buffer_load_dwordx4 v197, s[12:15], s36 offen offset:1024  lds
    buffer_load_dwordx4 v198, s[12:15], s36 offen offset:2048  lds
    buffer_load_dwordx4 v199, s[12:15], s36 offen offset:3072  lds
    s_add_u32 s36, s36, 262144
    s_add_u32 m0, s34, 65536
    s_nop 0
    buffer_load_dwordx4 v196, s[12:15], s36 offen offset:0  lds
    buffer_load_dwordx4 v197, s[12:15], s36 offen offset:1024  lds
    buffer_load_dwordx4 v198, s[12:15], s36 offen offset:2048  lds
    buffer_load_dwordx4 v199, s[12:15], s36 offen offset:3072  lds
    s_add_u32 s36, s36, 262144
    ds_read_u16 v32, v8 offset:0
    ds_read_u16 v33, v8 offset:512
    ds_read_u16 v34, v8 offset:1024
    ds_read_u16 v35, v8 offset:1536
    ds_read_u16 v36, v8 offset:4096
    ds_read_u16 v37, v8 offset:4608
    ds_read_u16 v38, v8 offset:5120
    ds_read_u16 v39, v8 offset:5632
    ds_read_u16 v40, v8 offset:8192
    ds_read_u16 v41, v8 offset:8704
    ds_read_u16 v42, v8 offset:9216
    ds_read_u16 v43, v8 offset:9728
    ds_read_u16 v44, v8 offset:12288
    ds_read_u16 v45, v8 offset:12800
    ds_read_u16 v46, v8 offset:13312
    ds_read_u16 v47, v8 offset:13824
    ds_read_b128 v[64:67], v7 offset:0
    ds_read_b128 v[68:71], v7 offset:1024
    ds_read_b128 v[72:75], v7 offset:2048
    ds_read_b128 v[76:79], v7 offset:3072
    ds_read_b128 v[80:83], v7 offset:4096
    ds_read_b128 v[84:87], v7 offset:5120
    ds_read_b128 v[88:91], v7 offset:6144
    ds_read_b128 v[92:95], v7 offset:7168
    ds_read_b128 v[96:99], v7 offset:8192
    ds_read_b128 v[100:103], v7 offset:9216
    ds_read_b128 v[104:107], v7 offset:10240
    ds_read_b128 v[108:111], v7 offset:11264
    ds_read_b128 v[112:115], v7 offset:12288
    ds_read_b128 v[116:119], v7 offset:13312
    ds_read_b128 v[120:123], v7 offset:14336
    ds_read_b128 v[124:127], v7 offset:15360
    s_waitcnt lgkmcnt(12)
    v_lshl_or_b32 v12, v33, 16, v32
    v_lshl_or_b32 v13, v35, 16, v34
    v_lshl_or_b32 v14, v37, 16, v36
    v_lshl_or_b32 v15, v39, 16, v38
    v_lshl_or_b32 v16, v41, 16, v40
    v_lshl_or_b32 v17, v43, 16, v42
    v_lshl_or_b32 v18, v45, 16, v44
    v_lshl_or_b32 v19, v47, 16, v46
    s_nop 1
    v_mfma_f32_32x32x16_bf16 v[32:47], v[12:15], v[64:67], 0
    v_mfma_f32_32x32x16_bf16 v[48:63], v[12:15], v[72:75], 0
    v_mfma_f32_32x32x16_bf16 v[32:47], v[16:19], v[68:71], v[32:47]
    v_mfma_f32_32x32x16_bf16 v[48:63], v[16:19], v[76:79], v[48:63]
    s_nop 5
    s_waitcnt lgkmcnt(0)
    s_nop 7
    v_pk_mul_f32 v[64:65], v[32:33], v[96:97]
    v_pk_mul_f32 v[66:67], v[34:35], v[98:99]
    v_pk_mul_f32 v[68:69], v[36:37], v[100:101]
    v_pk_mul_f32 v[70:71], v[38:39], v[102:103]
    v_pk_mul_f32 v[72:73], v[40:41], v[104:105]
    v_pk_mul_f32 v[74:75], v[42:43], v[106:107]
    v_pk_mul_f32 v[76:77], v[44:45], v[108:109]
    v_pk_mul_f32 v[78:79], v[46:47], v[110:111]
    v_pk_mul_f32 v[32:33], v[32:33], v[112:113]
    v_pk_mul_f32 v[34:35], v[34:35], v[114:115]
    v_pk_mul_f32 v[36:37], v[36:37], v[116:117]
    v_pk_mul_f32 v[38:39], v[38:39], v[118:119]
    v_pk_mul_f32 v[40:41], v[40:41], v[120:121]
    v_pk_mul_f32 v[42:43], v[42:43], v[122:123]
    v_pk_mul_f32 v[44:45], v[44:45], v[124:125]
    v_pk_mul_f32 v[46:47], v[46:47], v[126:127]
    v_pk_fma_f32 v[64:65], v[48:49], v[112:113], v[64:65] neg_lo:[1,0,0] neg_hi:[1,0,0]
    v_pk_fma_f32 v[66:67], v[50:51], v[114:115], v[66:67] neg_lo:[1,0,0] neg_hi:[1,0,0]
    v_pk_fma_f32 v[68:69], v[52:53], v[116:117], v[68:69] neg_lo:[1,0,0] neg_hi:[1,0,0]
    v_pk_fma_f32 v[70:71], v[54:55], v[118:119], v[70:71] neg_lo:[1,0,0] neg_hi:[1,0,0]
    v_pk_fma_f32 v[72:73], v[56:57], v[120:121], v[72:73] neg_lo:[1,0,0] neg_hi:[1,0,0]
    v_pk_fma_f32 v[74:75], v[58:59], v[122:123], v[74:75] neg_lo:[1,0,0] neg_hi:[1,0,0]
    v_pk_fma_f32 v[76:77], v[60:61], v[124:125], v[76:77] neg_lo:[1,0,0] neg_hi:[1,0,0]
    v_pk_fma_f32 v[78:79], v[62:63], v[126:127], v[78:79] neg_lo:[1,0,0] neg_hi:[1,0,0]
    v_cvt_pk_bf16_f32 v12, v64, v65
    v_cvt_pk_bf16_f32 v13, v66, v67
    v_cvt_pk_bf16_f32 v14, v68, v69
    v_cvt_pk_bf16_f32 v15, v70, v71
    v_cvt_pk_bf16_f32 v16, v72, v73
    v_cvt_pk_bf16_f32 v17, v74, v75
    v_cvt_pk_bf16_f32 v18, v76, v77
    v_cvt_pk_bf16_f32 v19, v78, v79
    v_pk_fma_f32 v[32:33], v[48:49], v[96:97], v[32:33]
    v_pk_fma_f32 v[34:35], v[50:51], v[98:99], v[34:35]
    v_pk_fma_f32 v[36:37], v[52:53], v[100:101], v[36:37]
    v_pk_fma_f32 v[38:39], v[54:55], v[102:103], v[38:39]
    v_pk_fma_f32 v[40:41], v[56:57], v[104:105], v[40:41]
    v_pk_fma_f32 v[42:43], v[58:59], v[106:107], v[42:43]
    v_pk_fma_f32 v[44:45], v[60:61], v[108:109], v[44:45]
    v_pk_fma_f32 v[46:47], v[62:63], v[110:111], v[46:47]
    v_mfma_f32_32x32x16_bf16 v[64:79], v[12:15], v[80:83], 0
    v_mfma_f32_32x32x16_bf16 v[64:79], v[16:19], v[84:87], v[64:79]
    v_cvt_pk_bf16_f32 v24, v32, v33
    v_cvt_pk_bf16_f32 v25, v34, v35
    v_cvt_pk_bf16_f32 v26, v36, v37
    v_cvt_pk_bf16_f32 v27, v38, v39
    v_cvt_pk_bf16_f32 v28, v40, v41
    v_cvt_pk_bf16_f32 v29, v42, v43
    v_cvt_pk_bf16_f32 v30, v44, v45
    v_cvt_pk_bf16_f32 v31, v46, v47
    s_nop 1
    v_mfma_f32_32x32x16_bf16 v[64:79], v[24:27], v[88:91], v[64:79]
    v_mfma_f32_32x32x16_bf16 v[64:79], v[28:31], v[92:95], v[64:79]
    s_nop 11
    v_cvt_pk_bf16_f32 v32, v64, v65
    v_cvt_pk_bf16_f32 v33, v66, v67
    v_cvt_pk_bf16_f32 v34, v68, v69
    v_cvt_pk_bf16_f32 v35, v70, v71
    v_cvt_pk_bf16_f32 v36, v72, v73
    v_cvt_pk_bf16_f32 v37, v74, v75
    v_cvt_pk_bf16_f32 v38, v76, v77
    v_cvt_pk_bf16_f32 v39, v78, v79
    buffer_store_dwordx4 v[32:35], v204, s[20:23], s53 offen sc1
    buffer_store_dwordx4 v[36:39], v204, s[20:23], s53 offen offset:1024 sc1
    s_add_u32 m0, s34, 98304
    s_nop 0
    buffer_load_dwordx4 v196, s[12:15], s36 offen offset:0  lds
    buffer_load_dwordx4 v197, s[12:15], s36 offen offset:1024  lds
    buffer_load_dwordx4 v198, s[12:15], s36 offen offset:2048  lds
    buffer_load_dwordx4 v199, s[12:15], s36 offen offset:3072  lds
    s_add_u32 s36, s36, 262144
    s_cmp_lg_u32 s30, 0
    s_cbranch_scc1 kf_hp_39
pollf_40:
    s_sleep 4
    global_load_dwordx2 v[2:3], v195, s[96:97] offset:0 sc1
    s_waitcnt vmcnt(0)
    v_cmp_eq_u64 vcc, s[94:95], v[2:3]
    s_nop 1
    s_cmp_eq_u64 vcc, -1
    s_cbranch_scc0 pollf_40
kf_hp_39:
    s_waitcnt vmcnt(0)
    s_barrier
    buffer_load_dwordx4 v[128:131], v223, s[8:11], s35 offen sc1
    buffer_load_dwordx4 v[132:135], v224, s[8:11], s35 offen sc1
    s_add_u32 s35, s35, 32768
    buffer_load_dwordx4 v[136:139], v223, s[8:11], s37 offen sc1
    buffer_load_dwordx4 v[140:143], v224, s[8:11], s37 offen sc1
    s_add_u32 s37, s37, 32768
    buffer_load_dwordx4 v[144:147], v223, s[8:11], s35 offen sc1
    buffer_load_dwordx4 v[148:151], v224, s[8:11], s35 offen sc1
    s_add_u32 s35, s35, 32768
    buffer_load_dwordx4 v[152:155], v223, s[8:11], s37 offen sc1
    buffer_load_dwordx4 v[156:159], v224, s[8:11], s37 offen sc1
    s_add_u32 s37, s37, 32768
    s_cmp_lg_u32 s30, 7
    s_cbranch_scc1 kb_nf_41
    s_add_u32 s26, s2, 3904
    s_lshl_b32 s26, s26, 7
    v_mov_b32 v200, s94
    v_mov_b32 v201, s95
    v_mov_b32 v202, s26
    s_mov_b64 exec, 1
    global_store_dwordx2 v202, v[200:201], s[96:97] sc1
    s_mov_b64 exec, -1
kb_nf_41:
    ds_read_b64_tr_b16 v[64:65], v207 offset:0
    ds_read_b64_tr_b16 v[66:67], v207 offset:1024
    ds_read_b64_tr_b16 v[68:69], v208 offset:0
    ds_read_b64_tr_b16 v[70:71], v208 offset:1024
    ds_read_b64_tr_b16 v[72:73], v209 offset:0
    ds_read_b64_tr_b16 v[74:75], v209 offset:1024
    ds_read_b64_tr_b16 v[76:77], v210 offset:0
    ds_read_b64_tr_b16 v[78:79], v210 offset:1024
    ds_read_b64_tr_b16 v[80:81], v211 offset:0
    ds_read_b64_tr_b16 v[82:83], v211 offset:1024
    ds_read_b64_tr_b16 v[84:85], v212 offset:0
    ds_read_b64_tr_b16 v[86:87], v212 offset:1024
    ds_read_b64_tr_b16 v[88:89], v213 offset:0
    ds_read_b64_tr_b16 v[90:91], v213 offset:1024
    ds_read_b64_tr_b16 v[92:93], v214 offset:0
    ds_read_b64_tr_b16 v[94:95], v214 offset:1024
    s_waitcnt vmcnt(6) lgkmcnt(0)
    v_mfma_f32_16x16x32_bf16 v[0:3], v[64:67], v[128:131], 0
    ds_read_b64_tr_b16 v[96:97], v207 offset:8192
    ds_read_b64_tr_b16 v[98:99], v207 offset:9216
    v_mfma_f32_16x16x32_bf16 v[4:7], v[68:71], v[128:131], 0
    ds_read_b64_tr_b16 v[100:101], v208 offset:8192
    buffer_load_dwordx4 v[160:163], v223, s[8:11], s35 offen sc1
    v_mfma_f32_16x16x32_bf16 v[8:11], v[72:75], v[128:131], 0
    ds_read_b64_tr_b16 v[102:103], v208 offset:9216
    ds_read_b64_tr_b16 v[104:105], v209 offset:8192
    buffer_load_dwordx4 v[164:167], v224, s[8:11], s35 offen sc1
    v_mfma_f32_16x16x32_bf16 v[12:15], v[76:79], v[128:131], 0
    ds_read_b64_tr_b16 v[106:107], v209 offset:9216
    s_add_u32 s35, s35, 32768
    v_mfma_f32_16x16x32_bf16 v[16:19], v[80:83], v[128:131], 0
    ds_read_b64_tr_b16 v[108:109], v210 offset:8192
    ds_read_b64_tr_b16 v[110:111], v210 offset:9216
    buffer_load_dwordx4 v[168:171], v223, s[8:11], s37 offen sc1
    v_mfma_f32_16x16x32_bf16 v[20:23], v[84:87], v[128:131], 0
    ds_read_b64_tr_b16 v[112:113], v211 offset:8192
    buffer_load_dwordx4 v[172:175], v224, s[8:11], s37 offen sc1
    v_mfma_f32_16x16x32_bf16 v[24:27], v[88:91], v[128:131], 0
    ds_read_b64_tr_b16 v[114:115], v211 offset:9216
    s_add_u32 s37, s37, 32768
    v_mfma_f32_16x16x32_bf16 v[28:31], v[92:95], v[128:131], 0
    ds_read_b64_tr_b16 v[116:117], v212 offset:8192
    ds_read_b64_tr_b16 v[118:119], v212 offset:9216
    v_mfma_f32_16x16x32_bf16 v[32:35], v[64:67], v[132:135], 0
    ds_read_b64_tr_b16 v[120:121], v213 offset:8192
    buffer_load_dwordx4 v[176:179], v223, s[8:11], s35 offen sc1
    v_mfma_f32_16x16x32_bf16 v[36:39], v[68:71], v[132:135], 0
    ds_read_b64_tr_b16 v[122:123], v213 offset:9216
    ds_read_b64_tr_b16 v[124:125], v214 offset:8192
    buffer_load_dwordx4 v[180:183], v224, s[8:11], s35 offen sc1
    v_mfma_f32_16x16x32_bf16 v[40:43], v[72:75], v[132:135], 0
    ds_read_b64_tr_b16 v[126:127], v214 offset:9216
    s_add_u32 s35, s35, 32768
    v_mfma_f32_16x16x32_bf16 v[44:47], v[76:79], v[132:135], 0
    buffer_load_dwordx4 v[184:187], v223, s[8:11], s37 offen sc1
    v_mfma_f32_16x16x32_bf16 v[48:51], v[80:83], v[132:135], 0
    buffer_load_dwordx4 v[188:191], v224, s[8:11], s37 offen sc1
    v_mfma_f32_16x16x32_bf16 v[52:55], v[84:87], v[132:135], 0
    s_add_u32 s37, s37, 32768
    v_mfma_f32_16x16x32_bf16 v[56:59], v[88:91], v[132:135], 0
    v_mfma_f32_16x16x32_bf16 v[60:63], v[92:95], v[132:135], 0
    s_waitcnt vmcnt(12) lgkmcnt(0)
    s_barrier
    v_mfma_f32_16x16x32_bf16 v[0:3], v[96:99], v[136:139], v[0:3]
    ds_read_b64_tr_b16 v[64:65], v207 offset:32768
    ds_read_b64_tr_b16 v[66:67], v207 offset:33792
    v_mfma_f32_16x16x32_bf16 v[4:7], v[100:103], v[136:139], v[4:7]
    ds_read_b64_tr_b16 v[68:69], v208 offset:32768
    buffer_load_dwordx4 v[128:131], v223, s[8:11], s35 offen sc1
    v_mfma_f32_16x16x32_bf16 v[8:11], v[104:107], v[136:139], v[8:11]
    ds_read_b64_tr_b16 v[70:71], v208 offset:33792
    ds_read_b64_tr_b16 v[72:73], v209 offset:32768
    buffer_load_dwordx4 v[132:135], v224, s[8:11], s35 offen sc1
    v_mfma_f32_16x16x32_bf16 v[12:15], v[108:111], v[136:139], v[12:15]
    ds_read_b64_tr_b16 v[74:75], v209 offset:33792
    s_add_u32 s35, s35, 32768
    v_mfma_f32_16x16x32_bf16 v[16:19], v[112:115], v[136:139], v[16:19]
    ds_read_b64_tr_b16 v[76:77], v210 offset:32768
    ds_read_b64_tr_b16 v[78:79], v210 offset:33792
    v_mfma_f32_16x16x32_bf16 v[20:23], v[116:119], v[136:139], v[20:23]
    ds_read_b64_tr_b16 v[80:81], v211 offset:32768
    s_add_u32 m0, s34, 0
    v_mfma_f32_16x16x32_bf16 v[24:27], v[120:123], v[136:139], v[24:27]
    ds_read_b64_tr_b16 v[82:83], v211 offset:33792
    s_nop 0
    v_mfma_f32_16x16x32_bf16 v[28:31], v[124:127], v[136:139], v[28:31]
    ds_read_b64_tr_b16 v[84:85], v212 offset:32768
    ds_read_b64_tr_b16 v[86:87], v212 offset:33792
    v_mfma_f32_16x16x32_bf16 v[32:35], v[96:99], v[140:143], v[32:35]
    ds_read_b64_tr_b16 v[88:89], v213 offset:32768
    buffer_load_dwordx4 v196, s[12:15], s36 offen offset:0  lds
    v_mfma_f32_16x16x32_bf16 v[36:39], v[100:103], v[140:143], v[36:39]
    ds_read_b64_tr_b16 v[90:91], v213 offset:33792
    ds_read_b64_tr_b16 v[92:93], v214 offset:32768
    buffer_load_dwordx4 v197, s[12:15], s36 offen offset:1024  lds
    v_mfma_f32_16x16x32_bf16 v[40:43], v[104:107], v[140:143], v[40:43]
    ds_read_b64_tr_b16 v[94:95], v214 offset:33792
    buffer_load_dwordx4 v198, s[12:15], s36 offen offset:2048  lds
    v_mfma_f32_16x16x32_bf16 v[44:47], v[108:111], v[140:143], v[44:47]
    v_mfma_f32_16x16x32_bf16 v[48:51], v[112:115], v[140:143], v[48:51]
    buffer_load_dwordx4 v199, s[12:15], s36 offen offset:3072  lds
    v_mfma_f32_16x16x32_bf16 v[52:55], v[116:119], v[140:143], v[52:55]
    s_add_u32 s36, s36, 262144
    v_mfma_f32_16x16x32_bf16 v[56:59], v[120:123], v[140:143], v[56:59]
    v_mfma_f32_16x16x32_bf16 v[60:63], v[124:127], v[140:143], v[60:63]
    s_waitcnt vmcnt(16) lgkmcnt(0)
    v_mfma_f32_16x16x32_bf16 v[0:3], v[64:67], v[144:147], v[0:3]
    ds_read_b64_tr_b16 v[96:97], v207 offset:40960
    ds_read_b64_tr_b16 v[98:99], v207 offset:41984
    v_mfma_f32_16x16x32_bf16 v[4:7], v[68:71], v[144:147], v[4:7]
    ds_read_b64_tr_b16 v[100:101], v208 offset:40960
    buffer_load_dwordx4 v[136:139], v223, s[8:11], s37 offen sc1
    v_mfma_f32_16x16x32_bf16 v[8:11], v[72:75], v[144:147], v[8:11]
    ds_read_b64_tr_b16 v[102:103], v208 offset:41984
    ds_read_b64_tr_b16 v[104:105], v209 offset:40960
    v_mfma_f32_16x16x32_bf16 v[12:15], v[76:79], v[144:147], v[12:15]
    ds_read_b64_tr_b16 v[106:107], v209 offset:41984
    v_mfma_f32_16x16x32_bf16 v[16:19], v[80:83], v[144:147], v[16:19]
    ds_read_b64_tr_b16 v[108:109], v210 offset:40960
    ds_read_b64_tr_b16 v[110:111], v210 offset:41984
    v_mfma_f32_16x16x32_bf16 v[20:23], v[84:87], v[144:147], v[20:23]
    ds_read_b64_tr_b16 v[112:113], v211 offset:40960
    buffer_load_dwordx4 v[140:143], v224, s[8:11], s37 offen sc1
    v_mfma_f32_16x16x32_bf16 v[24:27], v[88:91], v[144:147], v[24:27]
    ds_read_b64_tr_b16 v[114:115], v211 offset:41984
    v_mfma_f32_16x16x32_bf16 v[28:31], v[92:95], v[144:147], v[28:31]
    ds_read_b64_tr_b16 v[116:117], v212 offset:40960
    ds_read_b64_tr_b16 v[118:119], v212 offset:41984
    v_mfma_f32_16x16x32_bf16 v[32:35], v[64:67], v[148:151], v[32:35]
    ds_read_b64_tr_b16 v[120:121], v213 offset:40960
    v_mfma_f32_16x16x32_bf16 v[36:39], v[68:71], v[148:151], v[36:39]
    ds_read_b64_tr_b16 v[122:123], v213 offset:41984
    ds_read_b64_tr_b16 v[124:125], v214 offset:40960
    v_mfma_f32_16x16x32_bf16 v[40:43], v[72:75], v[148:151], v[40:43]
    ds_read_b64_tr_b16 v[126:127], v214 offset:41984
    s_add_u32 s37, s37, 32768
    v_mfma_f32_16x16x32_bf16 v[44:47], v[76:79], v[148:151], v[44:47]
    v_mfma_f32_16x16x32_bf16 v[48:51], v[80:83], v[148:151], v[48:51]
    v_mfma_f32_16x16x32_bf16 v[52:55], v[84:87], v[148:151], v[52:55]
    v_mfma_f32_16x16x32_bf16 v[56:59], v[88:91], v[148:151], v[56:59]
    v_mfma_f32_16x16x32_bf16 v[60:63], v[92:95], v[148:151], v[60:63]
    s_waitcnt vmcnt(16) lgkmcnt(0)
    s_barrier
    v_mfma_f32_16x16x32_bf16 v[0:3], v[96:99], v[152:155], v[0:3]
    ds_read_b64_tr_b16 v[64:65], v215 offset:0
    ds_read_b64_tr_b16 v[66:67], v215 offset:1024
    v_mfma_f32_16x16x32_bf16 v[4:7], v[100:103], v[152:155], v[4:7]
    ds_read_b64_tr_b16 v[68:69], v216 offset:0
    buffer_load_dwordx4 v[144:147], v223, s[8:11], s35 offen sc1
    v_mfma_f32_16x16x32_bf16 v[8:11], v[104:107], v[152:155], v[8:11]
    ds_read_b64_tr_b16 v[70:71], v216 offset:1024
    ds_read_b64_tr_b16 v[72:73], v217 offset:0
    buffer_load_dwordx4 v[148:151], v224, s[8:11], s35 offen sc1
    v_mfma_f32_16x16x32_bf16 v[12:15], v[108:111], v[152:155], v[12:15]
    ds_read_b64_tr_b16 v[74:75], v217 offset:1024
    s_add_u32 s35, s35, 32768
    v_mfma_f32_16x16x32_bf16 v[16:19], v[112:115], v[152:155], v[16:19]
    ds_read_b64_tr_b16 v[76:77], v218 offset:0
    ds_read_b64_tr_b16 v[78:79], v218 offset:1024
    v_mfma_f32_16x16x32_bf16 v[20:23], v[116:119], v[152:155], v[20:23]
    ds_read_b64_tr_b16 v[80:81], v219 offset:0
    s_add_u32 m0, s34, 32768
    v_mfma_f32_16x16x32_bf16 v[24:27], v[120:123], v[152:155], v[24:27]
    ds_read_b64_tr_b16 v[82:83], v219 offset:1024
    s_nop 0
    v_mfma_f32_16x16x32_bf16 v[28:31], v[124:127], v[152:155], v[28:31]
    ds_read_b64_tr_b16 v[84:85], v220 offset:0
    ds_read_b64_tr_b16 v[86:87], v220 offset:1024
    v_mfma_f32_16x16x32_bf16 v[32:35], v[96:99], v[156:159], v[32:35]
    ds_read_b64_tr_b16 v[88:89], v221 offset:0
    buffer_load_dwordx4 v196, s[12:15], s36 offen offset:0  lds
    v_mfma_f32_16x16x32_bf16 v[36:39], v[100:103], v[156:159], v[36:39]
    ds_read_b64_tr_b16 v[90:91], v221 offset:1024
    ds_read_b64_tr_b16 v[92:93], v222 offset:0
    buffer_load_dwordx4 v197, s[12:15], s36 offen offset:1024  lds
    v_mfma_f32_16x16x32_bf16 v[40:43], v[104:107], v[156:159], v[40:43]
    ds_read_b64_tr_b16 v[94:95], v222 offset:1024
    buffer_load_dwordx4 v198, s[12:15], s36 offen offset:2048  lds
    v_mfma_f32_16x16x32_bf16 v[44:47], v[108:111], v[156:159], v[44:47]
    v_mfma_f32_16x16x32_bf16 v[48:51], v[112:115], v[156:159], v[48:51]
    buffer_load_dwordx4 v199, s[12:15], s36 offen offset:3072  lds
    v_mfma_f32_16x16x32_bf16 v[52:55], v[116:119], v[156:159], v[52:55]
    s_add_u32 s36, s36, 262144
    v_mfma_f32_16x16x32_bf16 v[56:59], v[120:123], v[156:159], v[56:59]
    v_mfma_f32_16x16x32_bf16 v[60:63], v[124:127], v[156:159], v[60:63]
    s_waitcnt vmcnt(20) lgkmcnt(0)
    v_mfma_f32_16x16x32_bf16 v[0:3], v[64:67], v[160:163], v[0:3]
    ds_read_b64_tr_b16 v[96:97], v215 offset:8192
    ds_read_b64_tr_b16 v[98:99], v215 offset:9216
    v_mfma_f32_16x16x32_bf16 v[4:7], v[68:71], v[160:163], v[4:7]
    ds_read_b64_tr_b16 v[100:101], v216 offset:8192
    buffer_load_dwordx4 v[152:155], v223, s[8:11], s37 offen sc1
    v_mfma_f32_16x16x32_bf16 v[8:11], v[72:75], v[160:163], v[8:11]
    ds_read_b64_tr_b16 v[102:103], v216 offset:9216
    ds_read_b64_tr_b16 v[104:105], v217 offset:8192
    v_mfma_f32_16x16x32_bf16 v[12:15], v[76:79], v[160:163], v[12:15]
    ds_read_b64_tr_b16 v[106:107], v217 offset:9216
    v_mfma_f32_16x16x32_bf16 v[16:19], v[80:83], v[160:163], v[16:19]
    ds_read_b64_tr_b16 v[108:109], v218 offset:8192
    ds_read_b64_tr_b16 v[110:111], v218 offset:9216
    v_mfma_f32_16x16x32_bf16 v[20:23], v[84:87], v[160:163], v[20:23]
    ds_read_b64_tr_b16 v[112:113], v219 offset:8192
    buffer_load_dwordx4 v[156:159], v224, s[8:11], s37 offen sc1
    v_mfma_f32_16x16x32_bf16 v[24:27], v[88:91], v[160:163], v[24:27]
    ds_read_b64_tr_b16 v[114:115], v219 offset:9216
    v_mfma_f32_16x16x32_bf16 v[28:31], v[92:95], v[160:163], v[28:31]
    ds_read_b64_tr_b16 v[116:117], v220 offset:8192
    ds_read_b64_tr_b16 v[118:119], v220 offset:9216
    v_mfma_f32_16x16x32_bf16 v[32:35], v[64:67], v[164:167], v[32:35]
    ds_read_b64_tr_b16 v[120:121], v221 offset:8192
    v_mfma_f32_16x16x32_bf16 v[36:39], v[68:71], v[164:167], v[36:39]
    ds_read_b64_tr_b16 v[122:123], v221 offset:9216
    ds_read_b64_tr_b16 v[124:125], v222 offset:8192
    v_mfma_f32_16x16x32_bf16 v[40:43], v[72:75], v[164:167], v[40:43]
    ds_read_b64_tr_b16 v[126:127], v222 offset:9216
    s_add_u32 s37, s37, 32768
    v_mfma_f32_16x16x32_bf16 v[44:47], v[76:79], v[164:167], v[44:47]
    v_mfma_f32_16x16x32_bf16 v[48:51], v[80:83], v[164:167], v[48:51]
    v_mfma_f32_16x16x32_bf16 v[52:55], v[84:87], v[164:167], v[52:55]
    v_mfma_f32_16x16x32_bf16 v[56:59], v[88:91], v[164:167], v[56:59]
    v_mfma_f32_16x16x32_bf16 v[60:63], v[92:95], v[164:167], v[60:63]
    s_waitcnt vmcnt(20) lgkmcnt(0)
    s_barrier
    v_mfma_f32_16x16x32_bf16 v[0:3], v[96:99], v[168:171], v[0:3]
    ds_read_b64_tr_b16 v[64:65], v215 offset:32768
    ds_read_b64_tr_b16 v[66:67], v215 offset:33792
    v_mfma_f32_16x16x32_bf16 v[4:7], v[100:103], v[168:171], v[4:7]
    ds_read_b64_tr_b16 v[68:69], v216 offset:32768
    buffer_load_dwordx4 v[160:163], v223, s[8:11], s35 offen sc1
    v_mfma_f32_16x16x32_bf16 v[8:11], v[104:107], v[168:171], v[8:11]
    ds_read_b64_tr_b16 v[70:71], v216 offset:33792
    ds_read_b64_tr_b16 v[72:73], v217 offset:32768
    buffer_load_dwordx4 v[164:167], v224, s[8:11], s35 offen sc1
    v_mfma_f32_16x16x32_bf16 v[12:15], v[108:111], v[168:171], v[12:15]
    ds_read_b64_tr_b16 v[74:75], v217 offset:33792
    s_add_u32 s35, s35, 32768
    v_mfma_f32_16x16x32_bf16 v[16:19], v[112:115], v[168:171], v[16:19]
    ds_read_b64_tr_b16 v[76:77], v218 offset:32768
    ds_read_b64_tr_b16 v[78:79], v218 offset:33792
    v_mfma_f32_16x16x32_bf16 v[20:23], v[116:119], v[168:171], v[20:23]
    ds_read_b64_tr_b16 v[80:81], v219 offset:32768
    s_add_u32 m0, s34, 65536
    v_mfma_f32_16x16x32_bf16 v[24:27], v[120:123], v[168:171], v[24:27]
    ds_read_b64_tr_b16 v[82:83], v219 offset:33792
    s_nop 0
    v_mfma_f32_16x16x32_bf16 v[28:31], v[124:127], v[168:171], v[28:31]
    ds_read_b64_tr_b16 v[84:85], v220 offset:32768
    ds_read_b64_tr_b16 v[86:87], v220 offset:33792
    v_mfma_f32_16x16x32_bf16 v[32:35], v[96:99], v[172:175], v[32:35]
    ds_read_b64_tr_b16 v[88:89], v221 offset:32768
    buffer_load_dwordx4 v196, s[12:15], s36 offen offset:0  lds
    v_mfma_f32_16x16x32_bf16 v[36:39], v[100:103], v[172:175], v[36:39]
    ds_read_b64_tr_b16 v[90:91], v221 offset:33792
    ds_read_b64_tr_b16 v[92:93], v222 offset:32768
    buffer_load_dwordx4 v197, s[12:15], s36 offen offset:1024  lds
    v_mfma_f32_16x16x32_bf16 v[40:43], v[104:107], v[172:175], v[40:43]
    ds_read_b64_tr_b16 v[94:95], v222 offset:33792
    buffer_load_dwordx4 v198, s[12:15], s36 offen offset:2048  lds
    v_mfma_f32_16x16x32_bf16 v[44:47], v[108:111], v[172:175], v[44:47]
    v_mfma_f32_16x16x32_bf16 v[48:51], v[112:115], v[172:175], v[48:51]
    buffer_load_dwordx4 v199, s[12:15], s36 offen offset:3072  lds
    v_mfma_f32_16x16x32_bf16 v[52:55], v[116:119], v[172:175], v[52:55]
    s_add_u32 s36, s36, 262144
    v_mfma_f32_16x16x32_bf16 v[56:59], v[120:123], v[172:175], v[56:59]
    v_mfma_f32_16x16x32_bf16 v[60:63], v[124:127], v[172:175], v[60:63]
    s_waitcnt vmcnt(24) lgkmcnt(0)
    v_mfma_f32_16x16x32_bf16 v[0:3], v[64:67], v[176:179], v[0:3]
    ds_read_b64_tr_b16 v[96:97], v215 offset:40960
    ds_read_b64_tr_b16 v[98:99], v215 offset:41984
    v_mfma_f32_16x16x32_bf16 v[4:7], v[68:71], v[176:179], v[4:7]
    ds_read_b64_tr_b16 v[100:101], v216 offset:40960
    buffer_load_dwordx4 v[168:171], v223, s[8:11], s37 offen sc1
    v_mfma_f32_16x16x32_bf16 v[8:11], v[72:75], v[176:179], v[8:11]
    ds_read_b64_tr_b16 v[102:103], v216 offset:41984
    ds_read_b64_tr_b16 v[104:105], v217 offset:40960
    v_mfma_f32_16x16x32_bf16 v[12:15], v[76:79], v[176:179], v[12:15]
    ds_read_b64_tr_b16 v[106:107], v217 offset:41984
    v_mfma_f32_16x16x32_bf16 v[16:19], v[80:83], v[176:179], v[16:19]
    ds_read_b64_tr_b16 v[108:109], v218 offset:40960
    ds_read_b64_tr_b16 v[110:111], v218 offset:41984
    v_mfma_f32_16x16x32_bf16 v[20:23], v[84:87], v[176:179], v[20:23]
    ds_read_b64_tr_b16 v[112:113], v219 offset:40960
    buffer_load_dwordx4 v[172:175], v224, s[8:11], s37 offen sc1
    v_mfma_f32_16x16x32_bf16 v[24:27], v[88:91], v[176:179], v[24:27]
    ds_read_b64_tr_b16 v[114:115], v219 offset:41984
    v_mfma_f32_16x16x32_bf16 v[28:31], v[92:95], v[176:179], v[28:31]
    ds_read_b64_tr_b16 v[116:117], v220 offset:40960
    ds_read_b64_tr_b16 v[118:119], v220 offset:41984
    v_mfma_f32_16x16x32_bf16 v[32:35], v[64:67], v[180:183], v[32:35]
    ds_read_b64_tr_b16 v[120:121], v221 offset:40960
    v_mfma_f32_16x16x32_bf16 v[36:39], v[68:71], v[180:183], v[36:39]
    ds_read_b64_tr_b16 v[122:123], v221 offset:41984
    ds_read_b64_tr_b16 v[124:125], v222 offset:40960
    v_mfma_f32_16x16x32_bf16 v[40:43], v[72:75], v[180:183], v[40:43]
    ds_read_b64_tr_b16 v[126:127], v222 offset:41984
    s_add_u32 s37, s37, 32768
    v_mfma_f32_16x16x32_bf16 v[44:47], v[76:79], v[180:183], v[44:47]
    v_mfma_f32_16x16x32_bf16 v[48:51], v[80:83], v[180:183], v[48:51]
    v_mfma_f32_16x16x32_bf16 v[52:55], v[84:87], v[180:183], v[52:55]
    v_mfma_f32_16x16x32_bf16 v[56:59], v[88:91], v[180:183], v[56:59]
    v_mfma_f32_16x16x32_bf16 v[60:63], v[92:95], v[180:183], v[60:63]
    s_waitcnt vmcnt(18) lgkmcnt(0)
    s_barrier
    v_mfma_f32_16x16x32_bf16 v[0:3], v[96:99], v[184:187], v[0:3]
    ds_read_b64_tr_b16 v[64:65], v207 offset:0
    ds_read_b64_tr_b16 v[66:67], v207 offset:1024
    v_mfma_f32_16x16x32_bf16 v[4:7], v[100:103], v[184:187], v[4:7]
    ds_read_b64_tr_b16 v[68:69], v208 offset:0
    buffer_load_dwordx4 v[176:179], v223, s[8:11], s35 offen sc1
    v_mfma_f32_16x16x32_bf16 v[8:11], v[104:107], v[184:187], v[8:11]
    ds_read_b64_tr_b16 v[70:71], v208 offset:1024
    ds_read_b64_tr_b16 v[72:73], v209 offset:0
    buffer_load_dwordx4 v[180:183], v224, s[8:11], s35 offen sc1
    v_mfma_f32_16x16x32_bf16 v[12:15], v[108:111], v[184:187], v[12:15]
    ds_read_b64_tr_b16 v[74:75], v209 offset:1024
    s_add_u32 s35, s35, 32768
    v_mfma_f32_16x16x32_bf16 v[16:19], v[112:115], v[184:187], v[16:19]
    ds_read_b64_tr_b16 v[76:77], v210 offset:0
    ds_read_b64_tr_b16 v[78:79], v210 offset:1024
    v_mfma_f32_16x16x32_bf16 v[20:23], v[116:119], v[184:187], v[20:23]
    ds_read_b64_tr_b16 v[80:81], v211 offset:0
    s_add_u32 m0, s34, 98304
    v_mfma_f32_16x16x32_bf16 v[24:27], v[120:123], v[184:187], v[24:27]
    ds_read_b64_tr_b16 v[82:83], v211 offset:1024
    s_nop 0
    v_mfma_f32_16x16x32_bf16 v[28:31], v[124:127], v[184:187], v[28:31]
    ds_read_b64_tr_b16 v[84:85], v212 offset:0
    ds_read_b64_tr_b16 v[86:87], v212 offset:1024
    v_mfma_f32_16x16x32_bf16 v[32:35], v[96:99], v[188:191], v[32:35]
    ds_read_b64_tr_b16 v[88:89], v213 offset:0
    buffer_load_dwordx4 v196, s[12:15], s36 offen offset:0  lds
    v_mfma_f32_16x16x32_bf16 v[36:39], v[100:103], v[188:191], v[36:39]
    ds_read_b64_tr_b16 v[90:91], v213 offset:1024
    ds_read_b64_tr_b16 v[92:93], v214 offset:0
    buffer_load_dwordx4 v197, s[12:15], s36 offen offset:1024  lds
    v_mfma_f32_16x16x32_bf16 v[40:43], v[104:107], v[188:191], v[40:43]
    ds_read_b64_tr_b16 v[94:95], v214 offset:1024
    buffer_load_dwordx4 v198, s[12:15], s36 offen offset:2048  lds
    v_mfma_f32_16x16x32_bf16 v[44:47], v[108:111], v[188:191], v[44:47]
    v_mfma_f32_16x16x32_bf16 v[48:51], v[112:115], v[188:191], v[48:51]
    buffer_load_dwordx4 v199, s[12:15], s36 offen offset:3072  lds
    v_mfma_f32_16x16x32_bf16 v[52:55], v[116:119], v[188:191], v[52:55]
    s_add_u32 s36, s36, 262144
    v_mfma_f32_16x16x32_bf16 v[56:59], v[120:123], v[188:191], v[56:59]
    v_mfma_f32_16x16x32_bf16 v[60:63], v[124:127], v[188:191], v[60:63]
    s_waitcnt vmcnt(28) lgkmcnt(0)
    v_mfma_f32_16x16x32_bf16 v[0:3], v[64:67], v[128:131], v[0:3]
    ds_read_b64_tr_b16 v[96:97], v207 offset:8192
    ds_read_b64_tr_b16 v[98:99], v207 offset:9216
    v_mfma_f32_16x16x32_bf16 v[4:7], v[68:71], v[128:131], v[4:7]
    ds_read_b64_tr_b16 v[100:101], v208 offset:8192
    buffer_load_dwordx4 v[184:187], v223, s[8:11], s37 offen sc1
    v_mfma_f32_16x16x32_bf16 v[8:11], v[72:75], v[128:131], v[8:11]
    ds_read_b64_tr_b16 v[102:103], v208 offset:9216
    ds_read_b64_tr_b16 v[104:105], v209 offset:8192
    v_mfma_f32_16x16x32_bf16 v[12:15], v[76:79], v[128:131], v[12:15]
    ds_read_b64_tr_b16 v[106:107], v209 offset:9216
    v_mfma_f32_16x16x32_bf16 v[16:19], v[80:83], v[128:131], v[16:19]
    ds_read_b64_tr_b16 v[108:109], v210 offset:8192
    ds_read_b64_tr_b16 v[110:111], v210 offset:9216
    v_mfma_f32_16x16x32_bf16 v[20:23], v[84:87], v[128:131], v[20:23]
    ds_read_b64_tr_b16 v[112:113], v211 offset:8192
    buffer_load_dwordx4 v[188:191], v224, s[8:11], s37 offen sc1
    v_mfma_f32_16x16x32_bf16 v[24:27], v[88:91], v[128:131], v[24:27]
    ds_read_b64_tr_b16 v[114:115], v211 offset:9216
    v_mfma_f32_16x16x32_bf16 v[28:31], v[92:95], v[128:131], v[28:31]
    ds_read_b64_tr_b16 v[116:117], v212 offset:8192
    ds_read_b64_tr_b16 v[118:119], v212 offset:9216
    v_mfma_f32_16x16x32_bf16 v[32:35], v[64:67], v[132:135], v[32:35]
    ds_read_b64_tr_b16 v[120:121], v213 offset:8192
    v_mfma_f32_16x16x32_bf16 v[36:39], v[68:71], v[132:135], v[36:39]
    ds_read_b64_tr_b16 v[122:123], v213 offset:9216
    ds_read_b64_tr_b16 v[124:125], v214 offset:8192
    v_mfma_f32_16x16x32_bf16 v[40:43], v[72:75], v[132:135], v[40:43]
    ds_read_b64_tr_b16 v[126:127], v214 offset:9216
    s_add_u32 s37, s37, 32768
    v_mfma_f32_16x16x32_bf16 v[44:47], v[76:79], v[132:135], v[44:47]
    v_mfma_f32_16x16x32_bf16 v[48:51], v[80:83], v[132:135], v[48:51]
    v_mfma_f32_16x16x32_bf16 v[52:55], v[84:87], v[132:135], v[52:55]
    v_mfma_f32_16x16x32_bf16 v[56:59], v[88:91], v[132:135], v[56:59]
    v_mfma_f32_16x16x32_bf16 v[60:63], v[92:95], v[132:135], v[60:63]
    s_waitcnt vmcnt(18) lgkmcnt(0)
    s_barrier
    v_mfma_f32_16x16x32_bf16 v[0:3], v[96:99], v[136:139], v[0:3]
    ds_read_b64_tr_b16 v[64:65], v207 offset:32768
    ds_read_b64_tr_b16 v[66:67], v207 offset:33792
    v_mfma_f32_16x16x32_bf16 v[4:7], v[100:103], v[136:139], v[4:7]
    ds_read_b64_tr_b16 v[68:69], v208 offset:32768
    buffer_load_dwordx4 v[128:131], v223, s[8:11], s35 offen sc1
    v_mfma_f32_16x16x32_bf16 v[8:11], v[104:107], v[136:139], v[8:11]
    ds_read_b64_tr_b16 v[70:71], v208 offset:33792
    ds_read_b64_tr_b16 v[72:73], v209 offset:32768
    buffer_load_dwordx4 v[132:135], v224, s[8:11], s35 offen sc1
    v_mfma_f32_16x16x32_bf16 v[12:15], v[108:111], v[136:139], v[12:15]
    ds_read_b64_tr_b16 v[74:75], v209 offset:33792
    s_add_u32 s35, s35, 32768
    v_mfma_f32_16x16x32_bf16 v[16:19], v[112:115], v[136:139], v[16:19]
    ds_read_b64_tr_b16 v[76:77], v210 offset:32768
    ds_read_b64_tr_b16 v[78:79], v210 offset:33792
    v_mfma_f32_16x16x32_bf16 v[20:23], v[116:119], v[136:139], v[20:23]
    ds_read_b64_tr_b16 v[80:81], v211 offset:32768
    s_add_u32 m0, s34, 0
    v_mfma_f32_16x16x32_bf16 v[24:27], v[120:123], v[136:139], v[24:27]
    ds_read_b64_tr_b16 v[82:83], v211 offset:33792
    s_nop 0
    v_mfma_f32_16x16x32_bf16 v[28:31], v[124:127], v[136:139], v[28:31]
    ds_read_b64_tr_b16 v[84:85], v212 offset:32768
    ds_read_b64_tr_b16 v[86:87], v212 offset:33792
    v_mfma_f32_16x16x32_bf16 v[32:35], v[96:99], v[140:143], v[32:35]
    ds_read_b64_tr_b16 v[88:89], v213 offset:32768
    buffer_load_dwordx4 v196, s[12:15], s36 offen offset:0  lds
    v_mfma_f32_16x16x32_bf16 v[36:39], v[100:103], v[140:143], v[36:39]
    ds_read_b64_tr_b16 v[90:91], v213 offset:33792
    ds_read_b64_tr_b16 v[92:93], v214 offset:32768
    buffer_load_dwordx4 v197, s[12:15], s36 offen offset:1024  lds
    v_mfma_f32_16x16x32_bf16 v[40:43], v[104:107], v[140:143], v[40:43]
    ds_read_b64_tr_b16 v[94:95], v214 offset:33792
    buffer_load_dwordx4 v198, s[12:15], s36 offen offset:2048  lds
    v_mfma_f32_16x16x32_bf16 v[44:47], v[108:111], v[140:143], v[44:47]
    v_mfma_f32_16x16x32_bf16 v[48:51], v[112:115], v[140:143], v[48:51]
    buffer_load_dwordx4 v199, s[12:15], s36 offen offset:3072  lds
    v_mfma_f32_16x16x32_bf16 v[52:55], v[116:119], v[140:143], v[52:55]
    s_add_u32 s36, s36, 262144
    v_mfma_f32_16x16x32_bf16 v[56:59], v[120:123], v[140:143], v[56:59]
    v_mfma_f32_16x16x32_bf16 v[60:63], v[124:127], v[140:143], v[60:63]
    s_waitcnt vmcnt(28) lgkmcnt(0)
    v_mfma_f32_16x16x32_bf16 v[0:3], v[64:67], v[144:147], v[0:3]
    ds_read_b64_tr_b16 v[96:97], v207 offset:40960
    ds_read_b64_tr_b16 v[98:99], v207 offset:41984
    v_mfma_f32_16x16x32_bf16 v[4:7], v[68:71], v[144:147], v[4:7]
    ds_read_b64_tr_b16 v[100:101], v208 offset:40960
    buffer_load_dwordx4 v[136:139], v223, s[8:11], s37 offen sc1
    v_mfma_f32_16x16x32_bf16 v[8:11], v[72:75], v[144:147], v[8:11]
    ds_read_b64_tr_b16 v[102:103], v208 offset:41984
    ds_read_b64_tr_b16 v[104:105], v209 offset:40960
    v_mfma_f32_16x16x32_bf16 v[12:15], v[76:79], v[144:147], v[12:15]
    ds_read_b64_tr_b16 v[106:107], v209 offset:41984
    v_mfma_f32_16x16x32_bf16 v[16:19], v[80:83], v[144:147], v[16:19]
    ds_read_b64_tr_b16 v[108:109], v210 offset:40960
    ds_read_b64_tr_b16 v[110:111], v210 offset:41984
    v_mfma_f32_16x16x32_bf16 v[20:23], v[84:87], v[144:147], v[20:23]
    ds_read_b64_tr_b16 v[112:113], v211 offset:40960
    buffer_load_dwordx4 v[140:143], v224, s[8:11], s37 offen sc1
    v_mfma_f32_16x16x32_bf16 v[24:27], v[88:91], v[144:147], v[24:27]
    ds_read_b64_tr_b16 v[114:115], v211 offset:41984
    v_mfma_f32_16x16x32_bf16 v[28:31], v[92:95], v[144:147], v[28:31]
    ds_read_b64_tr_b16 v[116:117], v212 offset:40960
    ds_read_b64_tr_b16 v[118:119], v212 offset:41984
    v_mfma_f32_16x16x32_bf16 v[32:35], v[64:67], v[148:151], v[32:35]
    ds_read_b64_tr_b16 v[120:121], v213 offset:40960
    v_mfma_f32_16x16x32_bf16 v[36:39], v[68:71], v[148:151], v[36:39]
    ds_read_b64_tr_b16 v[122:123], v213 offset:41984
    ds_read_b64_tr_b16 v[124:125], v214 offset:40960
    v_mfma_f32_16x16x32_bf16 v[40:43], v[72:75], v[148:151], v[40:43]
    ds_read_b64_tr_b16 v[126:127], v214 offset:41984
    s_add_u32 s37, s37, 32768
    v_mfma_f32_16x16x32_bf16 v[44:47], v[76:79], v[148:151], v[44:47]
    v_mfma_f32_16x16x32_bf16 v[48:51], v[80:83], v[148:151], v[48:51]
    v_mfma_f32_16x16x32_bf16 v[52:55], v[84:87], v[148:151], v[52:55]
    v_mfma_f32_16x16x32_bf16 v[56:59], v[88:91], v[148:151], v[56:59]
    v_mfma_f32_16x16x32_bf16 v[60:63], v[92:95], v[148:151], v[60:63]
    s_waitcnt vmcnt(18) lgkmcnt(0)
    s_barrier
    v_mfma_f32_16x16x32_bf16 v[0:3], v[96:99], v[152:155], v[0:3]
    ds_read_b64_tr_b16 v[64:65], v215 offset:0
    ds_read_b64_tr_b16 v[66:67], v215 offset:1024
    v_mfma_f32_16x16x32_bf16 v[4:7], v[100:103], v[152:155], v[4:7]
    ds_read_b64_tr_b16 v[68:69], v216 offset:0
    buffer_load_dwordx4 v[144:147], v223, s[8:11], s35 offen sc1
    v_mfma_f32_16x16x32_bf16 v[8:11], v[104:107], v[152:155], v[8:11]
    ds_read_b64_tr_b16 v[70:71], v216 offset:1024
    ds_read_b64_tr_b16 v[72:73], v217 offset:0
    buffer_load_dwordx4 v[148:151], v224, s[8:11], s35 offen sc1
    v_mfma_f32_16x16x32_bf16 v[12:15], v[108:111], v[152:155], v[12:15]
    ds_read_b64_tr_b16 v[74:75], v217 offset:1024
    s_add_u32 s35, s35, 32768
    v_mfma_f32_16x16x32_bf16 v[16:19], v[112:115], v[152:155], v[16:19]
    ds_read_b64_tr_b16 v[76:77], v218 offset:0
    ds_read_b64_tr_b16 v[78:79], v218 offset:1024
    v_mfma_f32_16x16x32_bf16 v[20:23], v[116:119], v[152:155], v[20:23]
    ds_read_b64_tr_b16 v[80:81], v219 offset:0
    s_add_u32 m0, s34, 32768
    v_mfma_f32_16x16x32_bf16 v[24:27], v[120:123], v[152:155], v[24:27]
    ds_read_b64_tr_b16 v[82:83], v219 offset:1024
    s_nop 0
    v_mfma_f32_16x16x32_bf16 v[28:31], v[124:127], v[152:155], v[28:31]
    ds_read_b64_tr_b16 v[84:85], v220 offset:0
    ds_read_b64_tr_b16 v[86:87], v220 offset:1024
    v_mfma_f32_16x16x32_bf16 v[32:35], v[96:99], v[156:159], v[32:35]
    ds_read_b64_tr_b16 v[88:89], v221 offset:0
    buffer_load_dwordx4 v196, s[12:15], s36 offen offset:0  lds
    v_mfma_f32_16x16x32_bf16 v[36:39], v[100:103], v[156:159], v[36:39]
    ds_read_b64_tr_b16 v[90:91], v221 offset:1024
    ds_read_b64_tr_b16 v[92:93], v222 offset:0
    buffer_load_dwordx4 v197, s[12:15], s36 offen offset:1024  lds
    v_mfma_f32_16x16x32_bf16 v[40:43], v[104:107], v[156:159], v[40:43]
    ds_read_b64_tr_b16 v[94:95], v222 offset:1024
    buffer_load_dwordx4 v198, s[12:15], s36 offen offset:2048  lds
    v_mfma_f32_16x16x32_bf16 v[44:47], v[108:111], v[156:159], v[44:47]
    v_mfma_f32_16x16x32_bf16 v[48:51], v[112:115], v[156:159], v[48:51]
    buffer_load_dwordx4 v199, s[12:15], s36 offen offset:3072  lds
    v_mfma_f32_16x16x32_bf16 v[52:55], v[116:119], v[156:159], v[52:55]
    s_add_u32 s36, s36, 262144
    v_mfma_f32_16x16x32_bf16 v[56:59], v[120:123], v[156:159], v[56:59]
    v_mfma_f32_16x16x32_bf16 v[60:63], v[124:127], v[156:159], v[60:63]
    s_waitcnt vmcnt(28) lgkmcnt(0)
    v_mfma_f32_16x16x32_bf16 v[0:3], v[64:67], v[160:163], v[0:3]
    ds_read_b64_tr_b16 v[96:97], v215 offset:8192
    ds_read_b64_tr_b16 v[98:99], v215 offset:9216
    v_mfma_f32_16x16x32_bf16 v[4:7], v[68:71], v[160:163], v[4:7]
    ds_read_b64_tr_b16 v[100:101], v216 offset:8192
    buffer_load_dwordx4 v[152:155], v223, s[8:11], s37 offen sc1
    v_mfma_f32_16x16x32_bf16 v[8:11], v[72:75], v[160:163], v[8:11]
    ds_read_b64_tr_b16 v[102:103], v216 offset:9216
    ds_read_b64_tr_b16 v[104:105], v217 offset:8192
    v_mfma_f32_16x16x32_bf16 v[12:15], v[76:79], v[160:163], v[12:15]
    ds_read_b64_tr_b16 v[106:107], v217 offset:9216
    v_mfma_f32_16x16x32_bf16 v[16:19], v[80:83], v[160:163], v[16:19]
    ds_read_b64_tr_b16 v[108:109], v218 offset:8192
    ds_read_b64_tr_b16 v[110:111], v218 offset:9216
    v_mfma_f32_16x16x32_bf16 v[20:23], v[84:87], v[160:163], v[20:23]
    ds_read_b64_tr_b16 v[112:113], v219 offset:8192
    buffer_load_dwordx4 v[156:159], v224, s[8:11], s37 offen sc1
    v_mfma_f32_16x16x32_bf16 v[24:27], v[88:91], v[160:163], v[24:27]
    ds_read_b64_tr_b16 v[114:115], v219 offset:9216
    v_mfma_f32_16x16x32_bf16 v[28:31], v[92:95], v[160:163], v[28:31]
    ds_read_b64_tr_b16 v[116:117], v220 offset:8192
    ds_read_b64_tr_b16 v[118:119], v220 offset:9216
    v_mfma_f32_16x16x32_bf16 v[32:35], v[64:67], v[164:167], v[32:35]
    ds_read_b64_tr_b16 v[120:121], v221 offset:8192
    v_mfma_f32_16x16x32_bf16 v[36:39], v[68:71], v[164:167], v[36:39]
    ds_read_b64_tr_b16 v[122:123], v221 offset:9216
    ds_read_b64_tr_b16 v[124:125], v222 offset:8192
    v_mfma_f32_16x16x32_bf16 v[40:43], v[72:75], v[164:167], v[40:43]
    ds_read_b64_tr_b16 v[126:127], v222 offset:9216
    s_add_u32 s37, s37, 32768
    v_mfma_f32_16x16x32_bf16 v[44:47], v[76:79], v[164:167], v[44:47]
    v_mfma_f32_16x16x32_bf16 v[48:51], v[80:83], v[164:167], v[48:51]
    v_mfma_f32_16x16x32_bf16 v[52:55], v[84:87], v[164:167], v[52:55]
    v_mfma_f32_16x16x32_bf16 v[56:59], v[88:91], v[164:167], v[56:59]
    v_mfma_f32_16x16x32_bf16 v[60:63], v[92:95], v[164:167], v[60:63]
    s_waitcnt vmcnt(18) lgkmcnt(0)
    s_barrier
    v_mfma_f32_16x16x32_bf16 v[0:3], v[96:99], v[168:171], v[0:3]
    ds_read_b64_tr_b16 v[64:65], v215 offset:32768
    ds_read_b64_tr_b16 v[66:67], v215 offset:33792
    v_mfma_f32_16x16x32_bf16 v[4:7], v[100:103], v[168:171], v[4:7]
    ds_read_b64_tr_b16 v[68:69], v216 offset:32768
    buffer_load_dwordx4 v[160:163], v223, s[8:11], s35 offen sc1
    v_mfma_f32_16x16x32_bf16 v[8:11], v[104:107], v[168:171], v[8:11]
    ds_read_b64_tr_b16 v[70:71], v216 offset:33792
    ds_read_b64_tr_b16 v[72:73], v217 offset:32768
    buffer_load_dwordx4 v[164:167], v224, s[8:11], s35 offen sc1
    v_mfma_f32_16x16x32_bf16 v[12:15], v[108:111], v[168:171], v[12:15]
    ds_read_b64_tr_b16 v[74:75], v217 offset:33792
    s_add_u32 s35, s35, 32768
    v_mfma_f32_16x16x32_bf16 v[16:19], v[112:115], v[168:171], v[16:19]
    ds_read_b64_tr_b16 v[76:77], v218 offset:32768
    ds_read_b64_tr_b16 v[78:79], v218 offset:33792
    v_mfma_f32_16x16x32_bf16 v[20:23], v[116:119], v[168:171], v[20:23]
    ds_read_b64_tr_b16 v[80:81], v219 offset:32768
    s_add_u32 m0, s34, 65536
    v_mfma_f32_16x16x32_bf16 v[24:27], v[120:123], v[168:171], v[24:27]
    ds_read_b64_tr_b16 v[82:83], v219 offset:33792
    s_nop 0
    v_mfma_f32_16x16x32_bf16 v[28:31], v[124:127], v[168:171], v[28:31]
    ds_read_b64_tr_b16 v[84:85], v220 offset:32768
    ds_read_b64_tr_b16 v[86:87], v220 offset:33792
    v_mfma_f32_16x16x32_bf16 v[32:35], v[96:99], v[172:175], v[32:35]
    ds_read_b64_tr_b16 v[88:89], v221 offset:32768
    buffer_load_dwordx4 v196, s[12:15], s36 offen offset:0  lds
    v_mfma_f32_16x16x32_bf16 v[36:39], v[100:103], v[172:175], v[36:39]
    ds_read_b64_tr_b16 v[90:91], v221 offset:33792
    ds_read_b64_tr_b16 v[92:93], v222 offset:32768
    buffer_load_dwordx4 v197, s[12:15], s36 offen offset:1024  lds
    v_mfma_f32_16x16x32_bf16 v[40:43], v[104:107], v[172:175], v[40:43]
    ds_read_b64_tr_b16 v[94:95], v222 offset:33792
    buffer_load_dwordx4 v198, s[12:15], s36 offen offset:2048  lds
    v_mfma_f32_16x16x32_bf16 v[44:47], v[108:111], v[172:175], v[44:47]
    v_mfma_f32_16x16x32_bf16 v[48:51], v[112:115], v[172:175], v[48:51]
    buffer_load_dwordx4 v199, s[12:15], s36 offen offset:3072  lds
    v_mfma_f32_16x16x32_bf16 v[52:55], v[116:119], v[172:175], v[52:55]
    s_add_u32 s36, s36, 262144
    v_mfma_f32_16x16x32_bf16 v[56:59], v[120:123], v[172:175], v[56:59]
    v_mfma_f32_16x16x32_bf16 v[60:63], v[124:127], v[172:175], v[60:63]
    s_waitcnt vmcnt(28) lgkmcnt(0)
    v_mfma_f32_16x16x32_bf16 v[0:3], v[64:67], v[176:179], v[0:3]
    ds_read_b64_tr_b16 v[96:97], v215 offset:40960
    ds_read_b64_tr_b16 v[98:99], v215 offset:41984
    v_mfma_f32_16x16x32_bf16 v[4:7], v[68:71], v[176:179], v[4:7]
    ds_read_b64_tr_b16 v[100:101], v216 offset:40960
    buffer_load_dwordx4 v[168:171], v223, s[8:11], s37 offen sc1
    v_mfma_f32_16x16x32_bf16 v[8:11], v[72:75], v[176:179], v[8:11]
    ds_read_b64_tr_b16 v[102:103], v216 offset:41984
    ds_read_b64_tr_b16 v[104:105], v217 offset:40960
    v_mfma_f32_16x16x32_bf16 v[12:15], v[76:79], v[176:179], v[12:15]
    ds_read_b64_tr_b16 v[106:107], v217 offset:41984
    v_mfma_f32_16x16x32_bf16 v[16:19], v[80:83], v[176:179], v[16:19]
    ds_read_b64_tr_b16 v[108:109], v218 offset:40960
    ds_read_b64_tr_b16 v[110:111], v218 offset:41984
    v_mfma_f32_16x16x32_bf16 v[20:23], v[84:87], v[176:179], v[20:23]
    ds_read_b64_tr_b16 v[112:113], v219 offset:40960
    buffer_load_dwordx4 v[172:175], v224, s[8:11], s37 offen sc1
    v_mfma_f32_16x16x32_bf16 v[24:27], v[88:91], v[176:179], v[24:27]
    ds_read_b64_tr_b16 v[114:115], v219 offset:41984
    v_mfma_f32_16x16x32_bf16 v[28:31], v[92:95], v[176:179], v[28:31]
    ds_read_b64_tr_b16 v[116:117], v220 offset:40960
    ds_read_b64_tr_b16 v[118:119], v220 offset:41984
    v_mfma_f32_16x16x32_bf16 v[32:35], v[64:67], v[180:183], v[32:35]
    ds_read_b64_tr_b16 v[120:121], v221 offset:40960
    v_mfma_f32_16x16x32_bf16 v[36:39], v[68:71], v[180:183], v[36:39]
    ds_read_b64_tr_b16 v[122:123], v221 offset:41984
    ds_read_b64_tr_b16 v[124:125], v222 offset:40960
    v_mfma_f32_16x16x32_bf16 v[40:43], v[72:75], v[180:183], v[40:43]
    ds_read_b64_tr_b16 v[126:127], v222 offset:41984
    s_add_u32 s37, s37, 32768
    v_mfma_f32_16x16x32_bf16 v[44:47], v[76:79], v[180:183], v[44:47]
    v_mfma_f32_16x16x32_bf16 v[48:51], v[80:83], v[180:183], v[48:51]
    v_mfma_f32_16x16x32_bf16 v[52:55], v[84:87], v[180:183], v[52:55]
    v_mfma_f32_16x16x32_bf16 v[56:59], v[88:91], v[180:183], v[56:59]
    v_mfma_f32_16x16x32_bf16 v[60:63], v[92:95], v[180:183], v[60:63]
    s_waitcnt vmcnt(18) lgkmcnt(0)
    s_barrier
    v_mfma_f32_16x16x32_bf16 v[0:3], v[96:99], v[184:187], v[0:3]
    ds_read_b64_tr_b16 v[64:65], v207 offset:0
    ds_read_b64_tr_b16 v[66:67], v207 offset:1024
    v_mfma_f32_16x16x32_bf16 v[4:7], v[100:103], v[184:187], v[4:7]
    ds_read_b64_tr_b16 v[68:69], v208 offset:0
    buffer_load_dwordx4 v[176:179], v223, s[8:11], s35 offen sc1
    v_mfma_f32_16x16x32_bf16 v[8:11], v[104:107], v[184:187], v[8:11]
    ds_read_b64_tr_b16 v[70:71], v208 offset:1024
    ds_read_b64_tr_b16 v[72:73], v209 offset:0
    buffer_load_dwordx4 v[180:183], v224, s[8:11], s35 offen sc1
    v_mfma_f32_16x16x32_bf16 v[12:15], v[108:111], v[184:187], v[12:15]
    ds_read_b64_tr_b16 v[74:75], v209 offset:1024
    s_add_u32 s35, s35, 32768
    v_mfma_f32_16x16x32_bf16 v[16:19], v[112:115], v[184:187], v[16:19]
    ds_read_b64_tr_b16 v[76:77], v210 offset:0
    ds_read_b64_tr_b16 v[78:79], v210 offset:1024
    v_mfma_f32_16x16x32_bf16 v[20:23], v[116:119], v[184:187], v[20:23]
    ds_read_b64_tr_b16 v[80:81], v211 offset:0
    s_add_u32 m0, s34, 98304
    v_mfma_f32_16x16x32_bf16 v[24:27], v[120:123], v[184:187], v[24:27]
    ds_read_b64_tr_b16 v[82:83], v211 offset:1024
    s_nop 0
    v_mfma_f32_16x16x32_bf16 v[28:31], v[124:127], v[184:187], v[28:31]
    ds_read_b64_tr_b16 v[84:85], v212 offset:0
    ds_read_b64_tr_b16 v[86:87], v212 offset:1024
    v_mfma_f32_16x16x32_bf16 v[32:35], v[96:99], v[188:191], v[32:35]
    ds_read_b64_tr_b16 v[88:89], v213 offset:0
    buffer_load_dwordx4 v196, s[12:15], s36 offen offset:0  lds
    v_mfma_f32_16x16x32_bf16 v[36:39], v[100:103], v[188:191], v[36:39]
    ds_read_b64_tr_b16 v[90:91], v213 offset:1024
    ds_read_b64_tr_b16 v[92:93], v214 offset:0
    buffer_load_dwordx4 v197, s[12:15], s36 offen offset:1024  lds
    v_mfma_f32_16x16x32_bf16 v[40:43], v[104:107], v[188:191], v[40:43]
    ds_read_b64_tr_b16 v[94:95], v214 offset:1024
    buffer_load_dwordx4 v198, s[12:15], s36 offen offset:2048  lds
    v_mfma_f32_16x16x32_bf16 v[44:47], v[108:111], v[188:191], v[44:47]
    v_mfma_f32_16x16x32_bf16 v[48:51], v[112:115], v[188:191], v[48:51]
    buffer_load_dwordx4 v199, s[12:15], s36 offen offset:3072  lds
    v_mfma_f32_16x16x32_bf16 v[52:55], v[116:119], v[188:191], v[52:55]
    s_add_u32 s36, s36, 262144
    v_mfma_f32_16x16x32_bf16 v[56:59], v[120:123], v[188:191], v[56:59]
    v_mfma_f32_16x16x32_bf16 v[60:63], v[124:127], v[188:191], v[60:63]
    s_waitcnt vmcnt(28) lgkmcnt(0)
    v_mfma_f32_16x16x32_bf16 v[0:3], v[64:67], v[128:131], v[0:3]
    ds_read_b64_tr_b16 v[96:97], v207 offset:8192
    ds_read_b64_tr_b16 v[98:99], v207 offset:9216
    v_mfma_f32_16x16x32_bf16 v[4:7], v[68:71], v[128:131], v[4:7]
    ds_read_b64_tr_b16 v[100:101], v208 offset:8192
    buffer_load_dwordx4 v[184:187], v223, s[8:11], s37 offen sc1
    v_mfma_f32_16x16x32_bf16 v[8:11], v[72:75], v[128:131], v[8:11]
    ds_read_b64_tr_b16 v[102:103], v208 offset:9216
    ds_read_b64_tr_b16 v[104:105], v209 offset:8192
    v_mfma_f32_16x16x32_bf16 v[12:15], v[76:79], v[128:131], v[12:15]
    ds_read_b64_tr_b16 v[106:107], v209 offset:9216
    v_mfma_f32_16x16x32_bf16 v[16:19], v[80:83], v[128:131], v[16:19]
    ds_read_b64_tr_b16 v[108:109], v210 offset:8192
    ds_read_b64_tr_b16 v[110:111], v210 offset:9216
    v_mfma_f32_16x16x32_bf16 v[20:23], v[84:87], v[128:131], v[20:23]
    ds_read_b64_tr_b16 v[112:113], v211 offset:8192
    buffer_load_dwordx4 v[188:191], v224, s[8:11], s37 offen sc1
    v_mfma_f32_16x16x32_bf16 v[24:27], v[88:91], v[128:131], v[24:27]
    ds_read_b64_tr_b16 v[114:115], v211 offset:9216
    v_mfma_f32_16x16x32_bf16 v[28:31], v[92:95], v[128:131], v[28:31]
    ds_read_b64_tr_b16 v[116:117], v212 offset:8192
    ds_read_b64_tr_b16 v[118:119], v212 offset:9216
    v_mfma_f32_16x16x32_bf16 v[32:35], v[64:67], v[132:135], v[32:35]
    ds_read_b64_tr_b16 v[120:121], v213 offset:8192
    v_mfma_f32_16x16x32_bf16 v[36:39], v[68:71], v[132:135], v[36:39]
    ds_read_b64_tr_b16 v[122:123], v213 offset:9216
    ds_read_b64_tr_b16 v[124:125], v214 offset:8192
    v_mfma_f32_16x16x32_bf16 v[40:43], v[72:75], v[132:135], v[40:43]
    ds_read_b64_tr_b16 v[126:127], v214 offset:9216
    s_add_u32 s37, s37, 32768
    v_mfma_f32_16x16x32_bf16 v[44:47], v[76:79], v[132:135], v[44:47]
    v_mfma_f32_16x16x32_bf16 v[48:51], v[80:83], v[132:135], v[48:51]
    v_mfma_f32_16x16x32_bf16 v[52:55], v[84:87], v[132:135], v[52:55]
    v_mfma_f32_16x16x32_bf16 v[56:59], v[88:91], v[132:135], v[56:59]
    v_mfma_f32_16x16x32_bf16 v[60:63], v[92:95], v[132:135], v[60:63]
    s_waitcnt vmcnt(18) lgkmcnt(0)
    s_barrier
    v_mfma_f32_16x16x32_bf16 v[0:3], v[96:99], v[136:139], v[0:3]
    ds_read_b64_tr_b16 v[64:65], v207 offset:32768
    ds_read_b64_tr_b16 v[66:67], v207 offset:33792
    v_mfma_f32_16x16x32_bf16 v[4:7], v[100:103], v[136:139], v[4:7]
    ds_read_b64_tr_b16 v[68:69], v208 offset:32768
    buffer_load_dwordx4 v[128:131], v223, s[8:11], s35 offen sc1
    v_mfma_f32_16x16x32_bf16 v[8:11], v[104:107], v[136:139], v[8:11]
    ds_read_b64_tr_b16 v[70:71], v208 offset:33792
    ds_read_b64_tr_b16 v[72:73], v209 offset:32768
    buffer_load_dwordx4 v[132:135], v224, s[8:11], s35 offen sc1
    v_mfma_f32_16x16x32_bf16 v[12:15], v[108:111], v[136:139], v[12:15]
    ds_read_b64_tr_b16 v[74:75], v209 offset:33792
    s_add_u32 s35, s35, 32768
    v_mfma_f32_16x16x32_bf16 v[16:19], v[112:115], v[136:139], v[16:19]
    ds_read_b64_tr_b16 v[76:77], v210 offset:32768
    ds_read_b64_tr_b16 v[78:79], v210 offset:33792
    v_mfma_f32_16x16x32_bf16 v[20:23], v[116:119], v[136:139], v[20:23]
    ds_read_b64_tr_b16 v[80:81], v211 offset:32768
    s_add_u32 m0, s34, 0
    v_mfma_f32_16x16x32_bf16 v[24:27], v[120:123], v[136:139], v[24:27]
    ds_read_b64_tr_b16 v[82:83], v211 offset:33792
    s_nop 0
    v_mfma_f32_16x16x32_bf16 v[28:31], v[124:127], v[136:139], v[28:31]
    ds_read_b64_tr_b16 v[84:85], v212 offset:32768
    ds_read_b64_tr_b16 v[86:87], v212 offset:33792
    v_mfma_f32_16x16x32_bf16 v[32:35], v[96:99], v[140:143], v[32:35]
    ds_read_b64_tr_b16 v[88:89], v213 offset:32768
    buffer_load_dwordx4 v196, s[12:15], s36 offen offset:0  lds
    v_mfma_f32_16x16x32_bf16 v[36:39], v[100:103], v[140:143], v[36:39]
    ds_read_b64_tr_b16 v[90:91], v213 offset:33792
    ds_read_b64_tr_b16 v[92:93], v214 offset:32768
    buffer_load_dwordx4 v197, s[12:15], s36 offen offset:1024  lds
    v_mfma_f32_16x16x32_bf16 v[40:43], v[104:107], v[140:143], v[40:43]
    ds_read_b64_tr_b16 v[94:95], v214 offset:33792
    buffer_load_dwordx4 v198, s[12:15], s36 offen offset:2048  lds
    v_mfma_f32_16x16x32_bf16 v[44:47], v[108:111], v[140:143], v[44:47]
    v_mfma_f32_16x16x32_bf16 v[48:51], v[112:115], v[140:143], v[48:51]
    buffer_load_dwordx4 v199, s[12:15], s36 offen offset:3072  lds
    v_mfma_f32_16x16x32_bf16 v[52:55], v[116:119], v[140:143], v[52:55]
    s_add_u32 s36, s36, 262144
    v_mfma_f32_16x16x32_bf16 v[56:59], v[120:123], v[140:143], v[56:59]
    v_mfma_f32_16x16x32_bf16 v[60:63], v[124:127], v[140:143], v[60:63]
    s_waitcnt vmcnt(28) lgkmcnt(0)
    v_mfma_f32_16x16x32_bf16 v[0:3], v[64:67], v[144:147], v[0:3]
    ds_read_b64_tr_b16 v[96:97], v207 offset:40960
    ds_read_b64_tr_b16 v[98:99], v207 offset:41984
    v_mfma_f32_16x16x32_bf16 v[4:7], v[68:71], v[144:147], v[4:7]
    ds_read_b64_tr_b16 v[100:101], v208 offset:40960
    buffer_load_dwordx4 v[136:139], v223, s[8:11], s37 offen sc1
    v_mfma_f32_16x16x32_bf16 v[8:11], v[72:75], v[144:147], v[8:11]
    ds_read_b64_tr_b16 v[102:103], v208 offset:41984
    ds_read_b64_tr_b16 v[104:105], v209 offset:40960
    v_mfma_f32_16x16x32_bf16 v[12:15], v[76:79], v[144:147], v[12:15]
    ds_read_b64_tr_b16 v[106:107], v209 offset:41984
    v_mfma_f32_16x16x32_bf16 v[16:19], v[80:83], v[144:147], v[16:19]
    ds_read_b64_tr_b16 v[108:109], v210 offset:40960
    ds_read_b64_tr_b16 v[110:111], v210 offset:41984
    v_mfma_f32_16x16x32_bf16 v[20:23], v[84:87], v[144:147], v[20:23]
    ds_read_b64_tr_b16 v[112:113], v211 offset:40960
    buffer_load_dwordx4 v[140:143], v224, s[8:11], s37 offen sc1
    v_mfma_f32_16x16x32_bf16 v[24:27], v[88:91], v[144:147], v[24:27]
    ds_read_b64_tr_b16 v[114:115], v211 offset:41984
    v_mfma_f32_16x16x32_bf16 v[28:31], v[92:95], v[144:147], v[28:31]
    ds_read_b64_tr_b16 v[116:117], v212 offset:40960
    ds_read_b64_tr_b16 v[118:119], v212 offset:41984
    v_mfma_f32_16x16x32_bf16 v[32:35], v[64:67], v[148:151], v[32:35]
    ds_read_b64_tr_b16 v[120:121], v213 offset:40960
    v_mfma_f32_16x16x32_bf16 v[36:39], v[68:71], v[148:151], v[36:39]
    ds_read_b64_tr_b16 v[122:123], v213 offset:41984
    ds_read_b64_tr_b16 v[124:125], v214 offset:40960
    v_mfma_f32_16x16x32_bf16 v[40:43], v[72:75], v[148:151], v[40:43]
    ds_read_b64_tr_b16 v[126:127], v214 offset:41984
    s_add_u32 s37, s37, 32768
    v_mfma_f32_16x16x32_bf16 v[44:47], v[76:79], v[148:151], v[44:47]
    v_mfma_f32_16x16x32_bf16 v[48:51], v[80:83], v[148:151], v[48:51]
    v_mfma_f32_16x16x32_bf16 v[52:55], v[84:87], v[148:151], v[52:55]
    v_mfma_f32_16x16x32_bf16 v[56:59], v[88:91], v[148:151], v[56:59]
    v_mfma_f32_16x16x32_bf16 v[60:63], v[92:95], v[148:151], v[60:63]
    s_waitcnt vmcnt(18) lgkmcnt(0)
    s_barrier
    v_mfma_f32_16x16x32_bf16 v[0:3], v[96:99], v[152:155], v[0:3]
    ds_read_b64_tr_b16 v[64:65], v215 offset:0
    ds_read_b64_tr_b16 v[66:67], v215 offset:1024
    v_mfma_f32_16x16x32_bf16 v[4:7], v[100:103], v[152:155], v[4:7]
    ds_read_b64_tr_b16 v[68:69], v216 offset:0
    buffer_load_dwordx4 v[144:147], v223, s[8:11], s35 offen sc1
    v_mfma_f32_16x16x32_bf16 v[8:11], v[104:107], v[152:155], v[8:11]
    ds_read_b64_tr_b16 v[70:71], v216 offset:1024
    ds_read_b64_tr_b16 v[72:73], v217 offset:0
    buffer_load_dwordx4 v[148:151], v224, s[8:11], s35 offen sc1
    v_mfma_f32_16x16x32_bf16 v[12:15], v[108:111], v[152:155], v[12:15]
    ds_read_b64_tr_b16 v[74:75], v217 offset:1024
    s_add_u32 s35, s35, 32768
    v_mfma_f32_16x16x32_bf16 v[16:19], v[112:115], v[152:155], v[16:19]
    ds_read_b64_tr_b16 v[76:77], v218 offset:0
    ds_read_b64_tr_b16 v[78:79], v218 offset:1024
    v_mfma_f32_16x16x32_bf16 v[20:23], v[116:119], v[152:155], v[20:23]
    ds_read_b64_tr_b16 v[80:81], v219 offset:0
    s_add_u32 m0, s34, 32768
    v_mfma_f32_16x16x32_bf16 v[24:27], v[120:123], v[152:155], v[24:27]
    ds_read_b64_tr_b16 v[82:83], v219 offset:1024
    s_nop 0
    v_mfma_f32_16x16x32_bf16 v[28:31], v[124:127], v[152:155], v[28:31]
    ds_read_b64_tr_b16 v[84:85], v220 offset:0
    ds_read_b64_tr_b16 v[86:87], v220 offset:1024
    v_mfma_f32_16x16x32_bf16 v[32:35], v[96:99], v[156:159], v[32:35]
    ds_read_b64_tr_b16 v[88:89], v221 offset:0
    buffer_load_dwordx4 v196, s[12:15], s36 offen offset:0  lds
    v_mfma_f32_16x16x32_bf16 v[36:39], v[100:103], v[156:159], v[36:39]
    ds_read_b64_tr_b16 v[90:91], v221 offset:1024
    ds_read_b64_tr_b16 v[92:93], v222 offset:0
    buffer_load_dwordx4 v197, s[12:15], s36 offen offset:1024  lds
    v_mfma_f32_16x16x32_bf16 v[40:43], v[104:107], v[156:159], v[40:43]
    ds_read_b64_tr_b16 v[94:95], v222 offset:1024
    buffer_load_dwordx4 v198, s[12:15], s36 offen offset:2048  lds
    v_mfma_f32_16x16x32_bf16 v[44:47], v[108:111], v[156:159], v[44:47]
    v_mfma_f32_16x16x32_bf16 v[48:51], v[112:115], v[156:159], v[48:51]
    buffer_load_dwordx4 v199, s[12:15], s36 offen offset:3072  lds
    v_mfma_f32_16x16x32_bf16 v[52:55], v[116:119], v[156:159], v[52:55]
    s_add_u32 s36, s36, 262144
    v_mfma_f32_16x16x32_bf16 v[56:59], v[120:123], v[156:159], v[56:59]
    v_mfma_f32_16x16x32_bf16 v[60:63], v[124:127], v[156:159], v[60:63]
    s_waitcnt vmcnt(28) lgkmcnt(0)
    v_mfma_f32_16x16x32_bf16 v[0:3], v[64:67], v[160:163], v[0:3]
    ds_read_b64_tr_b16 v[96:97], v215 offset:8192
    ds_read_b64_tr_b16 v[98:99], v215 offset:9216
    v_mfma_f32_16x16x32_bf16 v[4:7], v[68:71], v[160:163], v[4:7]
    ds_read_b64_tr_b16 v[100:101], v216 offset:8192
    buffer_load_dwordx4 v[152:155], v223, s[8:11], s37 offen sc1
    v_mfma_f32_16x16x32_bf16 v[8:11], v[72:75], v[160:163], v[8:11]
    ds_read_b64_tr_b16 v[102:103], v216 offset:9216
    ds_read_b64_tr_b16 v[104:105], v217 offset:8192
    v_mfma_f32_16x16x32_bf16 v[12:15], v[76:79], v[160:163], v[12:15]
    ds_read_b64_tr_b16 v[106:107], v217 offset:9216
    v_mfma_f32_16x16x32_bf16 v[16:19], v[80:83], v[160:163], v[16:19]
    ds_read_b64_tr_b16 v[108:109], v218 offset:8192
    ds_read_b64_tr_b16 v[110:111], v218 offset:9216
    v_mfma_f32_16x16x32_bf16 v[20:23], v[84:87], v[160:163], v[20:23]
    ds_read_b64_tr_b16 v[112:113], v219 offset:8192
    buffer_load_dwordx4 v[156:159], v224, s[8:11], s37 offen sc1
    v_mfma_f32_16x16x32_bf16 v[24:27], v[88:91], v[160:163], v[24:27]
    ds_read_b64_tr_b16 v[114:115], v219 offset:9216
    v_mfma_f32_16x16x32_bf16 v[28:31], v[92:95], v[160:163], v[28:31]
    ds_read_b64_tr_b16 v[116:117], v220 offset:8192
    ds_read_b64_tr_b16 v[118:119], v220 offset:9216
    v_mfma_f32_16x16x32_bf16 v[32:35], v[64:67], v[164:167], v[32:35]
    ds_read_b64_tr_b16 v[120:121], v221 offset:8192
    v_mfma_f32_16x16x32_bf16 v[36:39], v[68:71], v[164:167], v[36:39]
    ds_read_b64_tr_b16 v[122:123], v221 offset:9216
    ds_read_b64_tr_b16 v[124:125], v222 offset:8192
    v_mfma_f32_16x16x32_bf16 v[40:43], v[72:75], v[164:167], v[40:43]
    ds_read_b64_tr_b16 v[126:127], v222 offset:9216
    s_add_u32 s37, s37, 32768
    v_mfma_f32_16x16x32_bf16 v[44:47], v[76:79], v[164:167], v[44:47]
    v_mfma_f32_16x16x32_bf16 v[48:51], v[80:83], v[164:167], v[48:51]
    v_mfma_f32_16x16x32_bf16 v[52:55], v[84:87], v[164:167], v[52:55]
    v_mfma_f32_16x16x32_bf16 v[56:59], v[88:91], v[164:167], v[56:59]
    v_mfma_f32_16x16x32_bf16 v[60:63], v[92:95], v[164:167], v[60:63]
    s_waitcnt vmcnt(18) lgkmcnt(0)
    s_barrier
    v_mfma_f32_16x16x32_bf16 v[0:3], v[96:99], v[168:171], v[0:3]
    ds_read_b64_tr_b16 v[64:65], v215 offset:32768
    ds_read_b64_tr_b16 v[66:67], v215 offset:33792
    v_mfma_f32_16x16x32_bf16 v[4:7], v[100:103], v[168:171], v[4:7]
    ds_read_b64_tr_b16 v[68:69], v216 offset:32768
    v_mfma_f32_16x16x32_bf16 v[8:11], v[104:107], v[168:171], v[8:11]
    ds_read_b64_tr_b16 v[70:71], v216 offset:33792
    ds_read_b64_tr_b16 v[72:73], v217 offset:32768
    v_mfma_f32_16x16x32_bf16 v[12:15], v[108:111], v[168:171], v[12:15]
    ds_read_b64_tr_b16 v[74:75], v217 offset:33792
    v_mfma_f32_16x16x32_bf16 v[16:19], v[112:115], v[168:171], v[16:19]
    ds_read_b64_tr_b16 v[76:77], v218 offset:32768
    ds_read_b64_tr_b16 v[78:79], v218 offset:33792
    v_mfma_f32_16x16x32_bf16 v[20:23], v[116:119], v[168:171], v[20:23]
    ds_read_b64_tr_b16 v[80:81], v219 offset:32768
    v_mfma_f32_16x16x32_bf16 v[24:27], v[120:123], v[168:171], v[24:27]
    ds_read_b64_tr_b16 v[82:83], v219 offset:33792
    v_mfma_f32_16x16x32_bf16 v[28:31], v[124:127], v[168:171], v[28:31]
    ds_read_b64_tr_b16 v[84:85], v220 offset:32768
    ds_read_b64_tr_b16 v[86:87], v220 offset:33792
    v_mfma_f32_16x16x32_bf16 v[32:35], v[96:99], v[172:175], v[32:35]
    ds_read_b64_tr_b16 v[88:89], v221 offset:32768
    v_mfma_f32_16x16x32_bf16 v[36:39], v[100:103], v[172:175], v[36:39]
    ds_read_b64_tr_b16 v[90:91], v221 offset:33792
    ds_read_b64_tr_b16 v[92:93], v222 offset:32768
    v_mfma_f32_16x16x32_bf16 v[40:43], v[104:107], v[172:175], v[40:43]
    ds_read_b64_tr_b16 v[94:95], v222 offset:33792
    v_mfma_f32_16x16x32_bf16 v[44:47], v[108:111], v[172:175], v[44:47]
    v_mfma_f32_16x16x32_bf16 v[48:51], v[112:115], v[172:175], v[48:51]
    v_mfma_f32_16x16x32_bf16 v[52:55], v[116:119], v[172:175], v[52:55]
    v_mfma_f32_16x16x32_bf16 v[56:59], v[120:123], v[172:175], v[56:59]
    v_mfma_f32_16x16x32_bf16 v[60:63], v[124:127], v[172:175], v[60:63]
    s_waitcnt vmcnt(22) lgkmcnt(0)
    v_mfma_f32_16x16x32_bf16 v[0:3], v[64:67], v[176:179], v[0:3]
    ds_read_b64_tr_b16 v[96:97], v215 offset:40960
    ds_read_b64_tr_b16 v[98:99], v215 offset:41984
    v_mfma_f32_16x16x32_bf16 v[4:7], v[68:71], v[176:179], v[4:7]
    ds_read_b64_tr_b16 v[100:101], v216 offset:40960
    v_mfma_f32_16x16x32_bf16 v[8:11], v[72:75], v[176:179], v[8:11]
    ds_read_b64_tr_b16 v[102:103], v216 offset:41984
    ds_read_b64_tr_b16 v[104:105], v217 offset:40960
    v_mfma_f32_16x16x32_bf16 v[12:15], v[76:79], v[176:179], v[12:15]
    ds_read_b64_tr_b16 v[106:107], v217 offset:41984
    v_mfma_f32_16x16x32_bf16 v[16:19], v[80:83], v[176:179], v[16:19]
    ds_read_b64_tr_b16 v[108:109], v218 offset:40960
    ds_read_b64_tr_b16 v[110:111], v218 offset:41984
    v_mfma_f32_16x16x32_bf16 v[20:23], v[84:87], v[176:179], v[20:23]
    ds_read_b64_tr_b16 v[112:113], v219 offset:40960
    v_mfma_f32_16x16x32_bf16 v[24:27], v[88:91], v[176:179], v[24:27]
    ds_read_b64_tr_b16 v[114:115], v219 offset:41984
    v_mfma_f32_16x16x32_bf16 v[28:31], v[92:95], v[176:179], v[28:31]
    ds_read_b64_tr_b16 v[116:117], v220 offset:40960
    ds_read_b64_tr_b16 v[118:119], v220 offset:41984
    v_mfma_f32_16x16x32_bf16 v[32:35], v[64:67], v[180:183], v[32:35]
    ds_read_b64_tr_b16 v[120:121], v221 offset:40960
    v_mfma_f32_16x16x32_bf16 v[36:39], v[68:71], v[180:183], v[36:39]
    ds_read_b64_tr_b16 v[122:123], v221 offset:41984
    ds_read_b64_tr_b16 v[124:125], v222 offset:40960
    v_mfma_f32_16x16x32_bf16 v[40:43], v[72:75], v[180:183], v[40:43]
    ds_read_b64_tr_b16 v[126:127], v222 offset:41984
    v_mfma_f32_16x16x32_bf16 v[44:47], v[76:79], v[180:183], v[44:47]
    v_mfma_f32_16x16x32_bf16 v[48:51], v[80:83], v[180:183], v[48:51]
    v_mfma_f32_16x16x32_bf16 v[52:55], v[84:87], v[180:183], v[52:55]
    v_mfma_f32_16x16x32_bf16 v[56:59], v[88:91], v[180:183], v[56:59]
    v_mfma_f32_16x16x32_bf16 v[60:63], v[92:95], v[180:183], v[60:63]
    s_waitcnt vmcnt(10) lgkmcnt(0)
    s_barrier
    s_cmp_lg_u32 s38, 0
    s_cbranch_scc1 kb_sk_42
    v_and_b32 v200, 3, v192
    v_lshlrev_b32 v200, 7, v200
    v_add_u32 v195, s52, v200
    v_mov_b32 v201, 495616
    v_cmp_gt_u32 vcc, 4, v192
    v_and_b32 v202, 0xfffff800, v193
    v_lshrrev_b32 v203, 5, v192
    v_cndmask_b32 v195, v201, v195, vcc
    global_load_dwordx2 v[200:201], v195, s[96:97] sc1
    v_lshl_add_u32 v202, v203, 10, v202
    v_and_b32 v203, 16, v192
    v_lshl_add_u32 v202, v203, 5, v202
    s_lshl_b32 s26, s32, 6
    v_add_u32 v202, s26, v202
    s_add_u32 s84, s24, 0x4400000
    s_addc_u32 s85, s25, 0
    s_and_b32 s85, s85, 0xffff
    s_mov_b32 s86, 0x1000
    s_mov_b32 s87, 0x20000
    s_lshr_b32 s26, s52, 7
    s_sub_u32 s26, s26, 3904
    s_lshl_b32 s26, s26, 4
    s_bfe_u32 s27, s31, 0x10002
    s_lshl_b32 s27, s27, 3
    s_add_u32 s52, s26, s27
    v_bfe_u32 v203, v192, 2, 2
    v_and_b32 v198, 3, v192
    v_lshlrev_b32 v198, 1, v198
    v_lshl_add_u32 v203, v203, 4, v198
kb_sk_42:
    v_mfma_f32_16x16x32_bf16 v[0:3], v[96:99], v[184:187], v[0:3]
    ds_read_b64_tr_b16 v[64:65], v207 offset:0
    ds_read_b64_tr_b16 v[66:67], v207 offset:1024
    v_mfma_f32_16x16x32_bf16 v[4:7], v[100:103], v[184:187], v[4:7]
    ds_read_b64_tr_b16 v[68:69], v208 offset:0
    v_mfma_f32_16x16x32_bf16 v[8:11], v[104:107], v[184:187], v[8:11]
    ds_read_b64_tr_b16 v[70:71], v208 offset:1024
    ds_read_b64_tr_b16 v[72:73], v209 offset:0
    v_mfma_f32_16x16x32_bf16 v[12:15], v[108:111], v[184:187], v[12:15]
    ds_read_b64_tr_b16 v[74:75], v209 offset:1024
    v_mfma_f32_16x16x32_bf16 v[16:19], v[112:115], v[184:187], v[16:19]
    ds_read_b64_tr_b16 v[76:77], v210 offset:0
    ds_read_b64_tr_b16 v[78:79], v210 offset:1024
    v_mfma_f32_16x16x32_bf16 v[20:23], v[116:119], v[184:187], v[20:23]
    ds_read_b64_tr_b16 v[80:81], v211 offset:0
    v_mfma_f32_16x16x32_bf16 v[24:27], v[120:123], v[184:187], v[24:27]
    ds_read_b64_tr_b16 v[82:83], v211 offset:1024
    v_mfma_f32_16x16x32_bf16 v[28:31], v[124:127], v[184:187], v[28:31]
    ds_read_b64_tr_b16 v[84:85], v212 offset:0
    ds_read_b64_tr_b16 v[86:87], v212 offset:1024
    v_mfma_f32_16x16x32_bf16 v[32:35], v[96:99], v[188:191], v[32:35]
    ds_read_b64_tr_b16 v[88:89], v213 offset:0
    v_mfma_f32_16x16x32_bf16 v[36:39], v[100:103], v[188:191], v[36:39]
    ds_read_b64_tr_b16 v[90:91], v213 offset:1024
    ds_read_b64_tr_b16 v[92:93], v214 offset:0
    v_mfma_f32_16x16x32_bf16 v[40:43], v[104:107], v[188:191], v[40:43]
    ds_read_b64_tr_b16 v[94:95], v214 offset:1024
    v_mfma_f32_16x16x32_bf16 v[44:47], v[108:111], v[188:191], v[44:47]
    v_mfma_f32_16x16x32_bf16 v[48:51], v[112:115], v[188:191], v[48:51]
    v_mfma_f32_16x16x32_bf16 v[52:55], v[116:119], v[188:191], v[52:55]
    v_mfma_f32_16x16x32_bf16 v[56:59], v[120:123], v[188:191], v[56:59]
    v_mfma_f32_16x16x32_bf16 v[60:63], v[124:127], v[188:191], v[60:63]
    s_waitcnt vmcnt(14) lgkmcnt(0)
    v_mfma_f32_16x16x32_bf16 v[0:3], v[64:67], v[128:131], v[0:3]
    ds_read_b64_tr_b16 v[96:97], v207 offset:8192
    ds_read_b64_tr_b16 v[98:99], v207 offset:9216
    v_mfma_f32_16x16x32_bf16 v[4:7], v[68:71], v[128:131], v[4:7]
    ds_read_b64_tr_b16 v[100:101], v208 offset:8192
    v_mfma_f32_16x16x32_bf16 v[8:11], v[72:75], v[128:131], v[8:11]
    ds_read_b64_tr_b16 v[102:103], v208 offset:9216
    ds_read_b64_tr_b16 v[104:105], v209 offset:8192
    v_mfma_f32_16x16x32_bf16 v[12:15], v[76:79], v[128:131], v[12:15]
    ds_read_b64_tr_b16 v[106:107], v209 offset:9216
    v_mfma_f32_16x16x32_bf16 v[16:19], v[80:83], v[128:131], v[16:19]
    ds_read_b64_tr_b16 v[108:109], v210 offset:8192
    ds_read_b64_tr_b16 v[110:111], v210 offset:9216
    v_mfma_f32_16x16x32_bf16 v[20:23], v[84:87], v[128:131], v[20:23]
    ds_read_b64_tr_b16 v[112:113], v211 offset:8192
    v_mfma_f32_16x16x32_bf16 v[24:27], v[88:91], v[128:131], v[24:27]
    ds_read_b64_tr_b16 v[114:115], v211 offset:9216
    v_mfma_f32_16x16x32_bf16 v[28:31], v[92:95], v[128:131], v[28:31]
    ds_read_b64_tr_b16 v[116:117], v212 offset:8192
    ds_read_b64_tr_b16 v[118:119], v212 offset:9216
    v_mfma_f32_16x16x32_bf16 v[32:35], v[64:67], v[132:135], v[32:35]
    ds_read_b64_tr_b16 v[120:121], v213 offset:8192
    v_mfma_f32_16x16x32_bf16 v[36:39], v[68:71], v[132:135], v[36:39]
    ds_read_b64_tr_b16 v[122:123], v213 offset:9216
    ds_read_b64_tr_b16 v[124:125], v214 offset:8192
    v_mfma_f32_16x16x32_bf16 v[40:43], v[72:75], v[132:135], v[40:43]
    ds_read_b64_tr_b16 v[126:127], v214 offset:9216
    v_mfma_f32_16x16x32_bf16 v[44:47], v[76:79], v[132:135], v[44:47]
    v_mfma_f32_16x16x32_bf16 v[48:51], v[80:83], v[132:135], v[48:51]
    v_mfma_f32_16x16x32_bf16 v[52:55], v[84:87], v[132:135], v[52:55]
    v_mfma_f32_16x16x32_bf16 v[56:59], v[88:91], v[132:135], v[56:59]
    v_mfma_f32_16x16x32_bf16 v[60:63], v[92:95], v[132:135], v[60:63]
    s_waitcnt vmcnt(0) lgkmcnt(0)
    s_barrier
    s_cmp_lg_u32 s38, 0
    s_cbranch_scc1 kb_sk_43
    v_cmp_eq_u64 vcc, s[94:95], v[200:201]
    s_nop 1
    s_cmp_eq_u64 vcc, -1
    s_cbranch_scc1 kb_yo_44
pollf_45:
    global_load_dwordx2 v[200:201], v195, s[96:97] offset:0 sc1
    s_waitcnt vmcnt(0)
    v_cmp_eq_u64 vcc, s[94:95], v[200:201]
    s_nop 1
    s_cmp_eq_u64 vcc, -1
    s_cbranch_scc0 pollf_45
kb_yo_44:
    buffer_load_dwordx4 v[160:163], v193, s[88:91], 0 offen offset:0
    buffer_load_dwordx4 v[164:167], v193, s[88:91], 0 offen offset:64
    buffer_load_dwordx4 v[168:171], v193, s[88:91], 0 offen offset:128
    buffer_load_dwordx4 v[172:175], v193, s[88:91], 0 offen offset:192
    buffer_load_dwordx4 v[176:179], v202, s[20:23], 0 offen offset:0 sc1
    buffer_load_dwordx4 v[180:183], v202, s[20:23], 0 offen offset:16 sc1
    buffer_load_dwordx4 v[184:187], v202, s[20:23], 0 offen offset:32 sc1
    buffer_load_dwordx4 v[188:191], v202, s[20:23], 0 offen offset:48 sc1
    buffer_load_ushort v196, v203, s[84:87], s52 offen sc1
kb_sk_43:
    v_mfma_f32_16x16x32_bf16 v[0:3], v[96:99], v[136:139], v[0:3]
    ds_read_b64_tr_b16 v[64:65], v207 offset:32768
    ds_read_b64_tr_b16 v[66:67], v207 offset:33792
    v_mfma_f32_16x16x32_bf16 v[4:7], v[100:103], v[136:139], v[4:7]
    ds_read_b64_tr_b16 v[68:69], v208 offset:32768
    v_mfma_f32_16x16x32_bf16 v[8:11], v[104:107], v[136:139], v[8:11]
    ds_read_b64_tr_b16 v[70:71], v208 offset:33792
    ds_read_b64_tr_b16 v[72:73], v209 offset:32768
    v_mfma_f32_16x16x32_bf16 v[12:15], v[108:111], v[136:139], v[12:15]
    ds_read_b64_tr_b16 v[74:75], v209 offset:33792
    v_mfma_f32_16x16x32_bf16 v[16:19], v[112:115], v[136:139], v[16:19]
    ds_read_b64_tr_b16 v[76:77], v210 offset:32768
    ds_read_b64_tr_b16 v[78:79], v210 offset:33792
    v_mfma_f32_16x16x32_bf16 v[20:23], v[116:119], v[136:139], v[20:23]
    ds_read_b64_tr_b16 v[80:81], v211 offset:32768
    v_mfma_f32_16x16x32_bf16 v[24:27], v[120:123], v[136:139], v[24:27]
    ds_read_b64_tr_b16 v[82:83], v211 offset:33792
    v_mfma_f32_16x16x32_bf16 v[28:31], v[124:127], v[136:139], v[28:31]
    ds_read_b64_tr_b16 v[84:85], v212 offset:32768
    ds_read_b64_tr_b16 v[86:87], v212 offset:33792
    v_mfma_f32_16x16x32_bf16 v[32:35], v[96:99], v[140:143], v[32:35]
    ds_read_b64_tr_b16 v[88:89], v213 offset:32768
    v_mfma_f32_16x16x32_bf16 v[36:39], v[100:103], v[140:143], v[36:39]
    ds_read_b64_tr_b16 v[90:91], v213 offset:33792
    ds_read_b64_tr_b16 v[92:93], v214 offset:32768
    v_mfma_f32_16x16x32_bf16 v[40:43], v[104:107], v[140:143], v[40:43]
    ds_read_b64_tr_b16 v[94:95], v214 offset:33792
    v_mfma_f32_16x16x32_bf16 v[44:47], v[108:111], v[140:143], v[44:47]
    v_mfma_f32_16x16x32_bf16 v[48:51], v[112:115], v[140:143], v[48:51]
    v_mfma_f32_16x16x32_bf16 v[52:55], v[116:119], v[140:143], v[52:55]
    v_mfma_f32_16x16x32_bf16 v[56:59], v[120:123], v[140:143], v[56:59]
    v_mfma_f32_16x16x32_bf16 v[60:63], v[124:127], v[140:143], v[60:63]
    s_waitcnt lgkmcnt(0)
    v_mfma_f32_16x16x32_bf16 v[0:3], v[64:67], v[144:147], v[0:3]
    ds_read_b64_tr_b16 v[96:97], v207 offset:40960
    ds_read_b64_tr_b16 v[98:99], v207 offset:41984
    v_mfma_f32_16x16x32_bf16 v[4:7], v[68:71], v[144:147], v[4:7]
    ds_read_b64_tr_b16 v[100:101], v208 offset:40960
    v_mfma_f32_16x16x32_bf16 v[8:11], v[72:75], v[144:147], v[8:11]
    ds_read_b64_tr_b16 v[102:103], v208 offset:41984
    ds_read_b64_tr_b16 v[104:105], v209 offset:40960
    v_mfma_f32_16x16x32_bf16 v[12:15], v[76:79], v[144:147], v[12:15]
    ds_read_b64_tr_b16 v[106:107], v209 offset:41984
    v_mfma_f32_16x16x32_bf16 v[16:19], v[80:83], v[144:147], v[16:19]
    ds_read_b64_tr_b16 v[108:109], v210 offset:40960
    ds_read_b64_tr_b16 v[110:111], v210 offset:41984
    v_mfma_f32_16x16x32_bf16 v[20:23], v[84:87], v[144:147], v[20:23]
    ds_read_b64_tr_b16 v[112:113], v211 offset:40960
    v_mfma_f32_16x16x32_bf16 v[24:27], v[88:91], v[144:147], v[24:27]
    ds_read_b64_tr_b16 v[114:115], v211 offset:41984
    v_mfma_f32_16x16x32_bf16 v[28:31], v[92:95], v[144:147], v[28:31]
    ds_read_b64_tr_b16 v[116:117], v212 offset:40960
    ds_read_b64_tr_b16 v[118:119], v212 offset:41984
    v_mfma_f32_16x16x32_bf16 v[32:35], v[64:67], v[148:151], v[32:35]
    ds_read_b64_tr_b16 v[120:121], v213 offset:40960
    v_mfma_f32_16x16x32_bf16 v[36:39], v[68:71], v[148:151], v[36:39]
    ds_read_b64_tr_b16 v[122:123], v213 offset:41984
    ds_read_b64_tr_b16 v[124:125], v214 offset:40960
    v_mfma_f32_16x16x32_bf16 v[40:43], v[72:75], v[148:151], v[40:43]
    ds_read_b64_tr_b16 v[126:127], v214 offset:41984
    v_mfma_f32_16x16x32_bf16 v[44:47], v[76:79], v[148:151], v[44:47]
    v_mfma_f32_16x16x32_bf16 v[48:51], v[80:83], v[148:151], v[48:51]
    v_mfma_f32_16x16x32_bf16 v[52:55], v[84:87], v[148:151], v[52:55]
    v_mfma_f32_16x16x32_bf16 v[56:59], v[88:91], v[148:151], v[56:59]
    v_mfma_f32_16x16x32_bf16 v[60:63], v[92:95], v[148:151], v[60:63]
    s_waitcnt lgkmcnt(0)
    s_barrier
    v_mfma_f32_16x16x32_bf16 v[0:3], v[96:99], v[152:155], v[0:3]
    v_mfma_f32_16x16x32_bf16 v[4:7], v[100:103], v[152:155], v[4:7]
    v_mfma_f32_16x16x32_bf16 v[8:11], v[104:107], v[152:155], v[8:11]
    v_mfma_f32_16x16x32_bf16 v[12:15], v[108:111], v[152:155], v[12:15]
    v_mfma_f32_16x16x32_bf16 v[16:19], v[112:115], v[152:155], v[16:19]
    v_mfma_f32_16x16x32_bf16 v[20:23], v[116:119], v[152:155], v[20:23]
    v_mfma_f32_16x16x32_bf16 v[24:27], v[120:123], v[152:155], v[24:27]
    v_mfma_f32_16x16x32_bf16 v[28:31], v[124:127], v[152:155], v[28:31]
    v_mfma_f32_16x16x32_bf16 v[32:35], v[96:99], v[156:159], v[32:35]
    v_mfma_f32_16x16x32_bf16 v[36:39], v[100:103], v[156:159], v[36:39]
    v_mfma_f32_16x16x32_bf16 v[40:43], v[104:107], v[156:159], v[40:43]
    v_mfma_f32_16x16x32_bf16 v[44:47], v[108:111], v[156:159], v[44:47]
    v_mfma_f32_16x16x32_bf16 v[48:51], v[112:115], v[156:159], v[48:51]
    v_mfma_f32_16x16x32_bf16 v[52:55], v[116:119], v[156:159], v[52:55]
    v_mfma_f32_16x16x32_bf16 v[56:59], v[120:123], v[156:159], v[56:59]
    v_mfma_f32_16x16x32_bf16 v[60:63], v[124:127], v[156:159], v[60:63]
    s_nop 7
    s_cmp_lg_u32 s38, 0
    s_cbranch_scc1 kb_g1_46
    ds_write_b128 v206, v[32:35] offset:0
    ds_write_b128 v206, v[36:39] offset:1024
    ds_write_b128 v206, v[40:43] offset:2048
    ds_write_b128 v206, v[44:47] offset:3072
    ds_write_b128 v206, v[48:51] offset:4096
    ds_write_b128 v206, v[52:55] offset:5120
    ds_write_b128 v206, v[56:59] offset:6144
    ds_write_b128 v206, v[60:63] offset:7168
    s_waitcnt lgkmcnt(0)
    s_barrier
    ds_read_b128 v[64:67], v206 offset:32768
    ds_read_b128 v[68:71], v206 offset:33792
    ds_read_b128 v[72:75], v206 offset:34816
    ds_read_b128 v[76:79], v206 offset:35840
    ds_read_b128 v[80:83], v206 offset:36864
    ds_read_b128 v[84:87], v206 offset:37888
    ds_read_b128 v[88:91], v206 offset:38912
    ds_read_b128 v[92:95], v206 offset:39936
    s_waitcnt vmcnt(0)
    v_lshlrev_b32 v32, 16, v160
    v_and_b32 v33, 0xffff0000, v160
    v_lshlrev_b32 v34, 16, v161
    v_and_b32 v35, 0xffff0000, v161
    v_lshlrev_b32 v36, 16, v162
    v_and_b32 v37, 0xffff0000, v162
    v_lshlrev_b32 v38, 16, v163
    v_and_b32 v39, 0xffff0000, v163
    v_lshlrev_b32 v40, 16, v164
    v_and_b32 v41, 0xffff0000, v164
    v_lshlrev_b32 v42, 16, v165
    v_and_b32 v43, 0xffff0000, v165
    v_lshlrev_b32 v44, 16, v166
    v_and_b32 v45, 0xffff0000, v166
    v_lshlrev_b32 v46, 16, v167
    v_and_b32 v47, 0xffff0000, v167
    v_lshlrev_b32 v48, 16, v168
    v_and_b32 v49, 0xffff0000, v168
    v_lshlrev_b32 v50, 16, v169
    v_and_b32 v51, 0xffff0000, v169
    v_lshlrev_b32 v52, 16, v170
    v_and_b32 v53, 0xffff0000, v170
    v_lshlrev_b32 v54, 16, v171
    v_and_b32 v55, 0xffff0000, v171
    v_lshlrev_b32 v56, 16, v172
    v_and_b32 v57, 0xffff0000, v172
    v_lshlrev_b32 v58, 16, v173
    v_and_b32 v59, 0xffff0000, v173
    v_lshlrev_b32 v60, 16, v174
    v_and_b32 v61, 0xffff0000, v174
    v_lshlrev_b32 v62, 16, v175
    v_and_b32 v63, 0xffff0000, v175
    s_waitcnt lgkmcnt(0)
    v_pk_add_f32 v[0:1], v[0:1], v[64:65]
    v_pk_add_f32 v[2:3], v[2:3], v[66:67]
    v_pk_add_f32 v[4:5], v[4:5], v[68:69]
    v_pk_add_f32 v[6:7], v[6:7], v[70:71]
    v_pk_add_f32 v[8:9], v[8:9], v[72:73]
    v_pk_add_f32 v[10:11], v[10:11], v[74:75]
    v_pk_add_f32 v[12:13], v[12:13], v[76:77]
    v_pk_add_f32 v[14:15], v[14:15], v[78:79]
    v_pk_add_f32 v[16:17], v[16:17], v[80:81]
    v_pk_add_f32 v[18:19], v[18:19], v[82:83]
    v_pk_add_f32 v[20:21], v[20:21], v[84:85]
    v_pk_add_f32 v[22:23], v[22:23], v[86:87]
    v_pk_add_f32 v[24:25], v[24:25], v[88:89]
    v_pk_add_f32 v[26:27], v[26:27], v[90:91]
    v_pk_add_f32 v[28:29], v[28:29], v[92:93]
    v_pk_add_f32 v[30:31], v[30:31], v[94:95]
    s_add_u32 s29, s49, 8192
    v_lshlrev_b32 v196, 16, v196
    v_xor_b32 v197, 0x80000000, v196
    v_lshlrev_b32 v112, 16, v176
    v_and_b32 v113, 0xffff0000, v176
    v_lshlrev_b32 v114, 16, v177
    v_and_b32 v115, 0xffff0000, v177
    v_lshlrev_b32 v116, 16, v178
    v_and_b32 v117, 0xffff0000, v178
    v_lshlrev_b32 v118, 16, v179
    v_and_b32 v119, 0xffff0000, v179
    v_lshlrev_b32 v120, 16, v180
    v_and_b32 v121, 0xffff0000, v180
    v_lshlrev_b32 v122, 16, v181
    v_and_b32 v123, 0xffff0000, v181
    v_lshlrev_b32 v124, 16, v182
    v_and_b32 v125, 0xffff0000, v182
    v_lshlrev_b32 v126, 16, v183
    v_and_b32 v127, 0xffff0000, v183
    v_pk_add_f32 v[112:113], v[112:113], v[196:197]
    v_pk_add_f32 v[114:115], v[114:115], v[196:197]
    v_pk_add_f32 v[116:117], v[116:117], v[196:197]
    v_pk_add_f32 v[118:119], v[118:119], v[196:197]
    v_pk_add_f32 v[120:121], v[120:121], v[196:197]
    v_pk_add_f32 v[122:123], v[122:123], v[196:197]
    v_pk_add_f32 v[124:125], v[124:125], v[196:197]
    v_pk_add_f32 v[126:127], v[126:127], v[196:197]
    v_pk_add_f32 v[32:33], v[32:33], v[112:113]
    v_pk_add_f32 v[34:35], v[34:35], v[114:115]
    v_pk_add_f32 v[36:37], v[36:37], v[116:117]
    v_pk_add_f32 v[38:39], v[38:39], v[118:119]
    v_pk_add_f32 v[40:41], v[40:41], v[120:121]
    v_pk_add_f32 v[42:43], v[42:43], v[122:123]
    v_pk_add_f32 v[44:45], v[44:45], v[124:125]
    v_pk_add_f32 v[46:47], v[46:47], v[126:127]
    v_cvt_pk_bf16_f32 v176, v32, v33
    v_cvt_pk_bf16_f32 v177, v34, v35
    v_cvt_pk_bf16_f32 v178, v36, v37
    v_cvt_pk_bf16_f32 v179, v38, v39
    v_cvt_pk_bf16_f32 v180, v40, v41
    v_cvt_pk_bf16_f32 v181, v42, v43
    v_cvt_pk_bf16_f32 v182, v44, v45
    v_cvt_pk_bf16_f32 v183, v46, v47
    v_lshlrev_b32 v32, 16, v176
    v_and_b32 v33, 0xffff0000, v176
    v_lshlrev_b32 v34, 16, v177
    v_and_b32 v35, 0xffff0000, v177
    v_lshlrev_b32 v36, 16, v178
    v_and_b32 v37, 0xffff0000, v178
    v_lshlrev_b32 v38, 16, v179
    v_and_b32 v39, 0xffff0000, v179
    v_lshlrev_b32 v40, 16, v180
    v_and_b32 v41, 0xffff0000, v180
    v_lshlrev_b32 v42, 16, v181
    v_and_b32 v43, 0xffff0000, v181
    v_lshlrev_b32 v44, 16, v182
    v_and_b32 v45, 0xffff0000, v182
    v_lshlrev_b32 v46, 16, v183
    v_and_b32 v47, 0xffff0000, v183
    v_lshlrev_b32 v112, 16, v184
    v_and_b32 v113, 0xffff0000, v184
    v_lshlrev_b32 v114, 16, v185
    v_and_b32 v115, 0xffff0000, v185
    v_lshlrev_b32 v116, 16, v186
    v_and_b32 v117, 0xffff0000, v186
    v_lshlrev_b32 v118, 16, v187
    v_and_b32 v119, 0xffff0000, v187
    v_lshlrev_b32 v120, 16, v188
    v_and_b32 v121, 0xffff0000, v188
    v_lshlrev_b32 v122, 16, v189
    v_and_b32 v123, 0xffff0000, v189
    v_lshlrev_b32 v124, 16, v190
    v_and_b32 v125, 0xffff0000, v190
    v_lshlrev_b32 v126, 16, v191
    v_and_b32 v127, 0xffff0000, v191
    v_pk_add_f32 v[112:113], v[112:113], v[196:197]
    v_pk_add_f32 v[114:115], v[114:115], v[196:197]
    v_pk_add_f32 v[116:117], v[116:117], v[196:197]
    v_pk_add_f32 v[118:119], v[118:119], v[196:197]
    v_pk_add_f32 v[120:121], v[120:121], v[196:197]
    v_pk_add_f32 v[122:123], v[122:123], v[196:197]
    v_pk_add_f32 v[124:125], v[124:125], v[196:197]
    v_pk_add_f32 v[126:127], v[126:127], v[196:197]
    v_pk_add_f32 v[48:49], v[48:49], v[112:113]
    v_pk_add_f32 v[50:51], v[50:51], v[114:115]
    v_pk_add_f32 v[52:53], v[52:53], v[116:117]
    v_pk_add_f32 v[54:55], v[54:55], v[118:119]
    v_pk_add_f32 v[56:57], v[56:57], v[120:121]
    v_pk_add_f32 v[58:59], v[58:59], v[122:123]
    v_pk_add_f32 v[60:61], v[60:61], v[124:125]
    v_pk_add_f32 v[62:63], v[62:63], v[126:127]
    v_cvt_pk_bf16_f32 v184, v48, v49
    v_cvt_pk_bf16_f32 v185, v50, v51
    v_cvt_pk_bf16_f32 v186, v52, v53
    v_cvt_pk_bf16_f32 v187, v54, v55
    v_cvt_pk_bf16_f32 v188, v56, v57
    v_cvt_pk_bf16_f32 v189, v58, v59
    v_cvt_pk_bf16_f32 v190, v60, v61
    v_cvt_pk_bf16_f32 v191, v62, v63
    v_lshlrev_b32 v48, 16, v184
    v_and_b32 v49, 0xffff0000, v184
    v_lshlrev_b32 v50, 16, v185
    v_and_b32 v51, 0xffff0000, v185
    v_lshlrev_b32 v52, 16, v186
    v_and_b32 v53, 0xffff0000, v186
    v_lshlrev_b32 v54, 16, v187
    v_and_b32 v55, 0xffff0000, v187
    v_lshlrev_b32 v56, 16, v188
    v_and_b32 v57, 0xffff0000, v188
    v_lshlrev_b32 v58, 16, v189
    v_and_b32 v59, 0xffff0000, v189
    v_lshlrev_b32 v60, 16, v190
    v_and_b32 v61, 0xffff0000, v190
    v_lshlrev_b32 v62, 16, v191
    v_and_b32 v63, 0xffff0000, v191
    v_mov_b32 v195, s51
pollf_49:
    global_load_dwordx2 v[200:201], v195, s[96:97] offset:0 sc1
    s_waitcnt vmcnt(0)
    v_cmp_eq_u64 vcc, s[94:95], v[200:201]
    s_nop 1
    s_cmp_eq_u64 vcc, -1
    s_cbranch_scc0 pollf_49
    buffer_load_dwordx4 v[64:67], v204, s[44:47], s49 offen offset:0 sc1
    buffer_load_dwordx4 v[68:71], v204, s[44:47], s49 offen offset:1024 sc1
    buffer_load_dwordx4 v[72:75], v204, s[44:47], s49 offen offset:2048 sc1
    buffer_load_dwordx4 v[76:79], v204, s[44:47], s49 offen offset:3072 sc1
    s_waitcnt vmcnt(3)
    v_lshlrev_b32 v132, 16, v64
    v_and_b32 v133, 0xffff0000, v64
    v_lshlrev_b32 v134, 16, v65
    v_and_b32 v135, 0xffff0000, v65
    v_lshlrev_b32 v136, 16, v66
    v_and_b32 v137, 0xffff0000, v66
    v_lshlrev_b32 v138, 16, v67
    v_and_b32 v139, 0xffff0000, v67
    v_pk_add_f32 v[0:1], v[0:1], v[132:133]
    v_pk_add_f32 v[2:3], v[2:3], v[134:135]
    v_pk_add_f32 v[4:5], v[4:5], v[136:137]
    v_pk_add_f32 v[6:7], v[6:7], v[138:139]
    v_cvt_pk_bf16_f32 v128, v0, v1
    v_cvt_pk_bf16_f32 v129, v2, v3
    v_cvt_pk_bf16_f32 v130, v4, v5
    v_cvt_pk_bf16_f32 v131, v6, v7
    s_nop 1
    v_permlane16_swap_b32 v128, v130
    v_permlane16_swap_b32 v129, v131
    s_nop 0
    v_lshlrev_b32 v132, 16, v128
    v_and_b32 v133, 0xffff0000, v128
    v_lshlrev_b32 v134, 16, v129
    v_and_b32 v135, 0xffff0000, v129
    v_lshlrev_b32 v136, 16, v130
    v_and_b32 v137, 0xffff0000, v130
    v_lshlrev_b32 v138, 16, v131
    v_and_b32 v139, 0xffff0000, v131
    v_pk_add_f32 v[132:133], v[132:133], v[32:33]
    v_pk_add_f32 v[134:135], v[134:135], v[34:35]
    v_pk_add_f32 v[136:137], v[136:137], v[36:37]
    v_pk_add_f32 v[138:139], v[138:139], v[38:39]
    v_cvt_pk_bf16_f32 v176, v132, v133
    v_cvt_pk_bf16_f32 v177, v134, v135
    v_cvt_pk_bf16_f32 v178, v136, v137
    v_cvt_pk_bf16_f32 v179, v138, v139
    buffer_store_dwordx4 v[176:179], v193, s[16:19], 0 offen offset:0
    s_waitcnt vmcnt(3)
    v_lshlrev_b32 v148, 16, v68
    v_and_b32 v149, 0xffff0000, v68
    v_lshlrev_b32 v150, 16, v69
    v_and_b32 v151, 0xffff0000, v69
    v_lshlrev_b32 v152, 16, v70
    v_and_b32 v153, 0xffff0000, v70
    v_lshlrev_b32 v154, 16, v71
    v_and_b32 v155, 0xffff0000, v71
    v_pk_add_f32 v[8:9], v[8:9], v[148:149]
    v_pk_add_f32 v[10:11], v[10:11], v[150:151]
    v_pk_add_f32 v[12:13], v[12:13], v[152:153]
    v_pk_add_f32 v[14:15], v[14:15], v[154:155]
    v_cvt_pk_bf16_f32 v144, v8, v9
    v_cvt_pk_bf16_f32 v145, v10, v11
    v_cvt_pk_bf16_f32 v146, v12, v13
    v_cvt_pk_bf16_f32 v147, v14, v15
    s_nop 1
    v_permlane16_swap_b32 v144, v146
    v_permlane16_swap_b32 v145, v147
    s_nop 0
    v_lshlrev_b32 v148, 16, v144
    v_and_b32 v149, 0xffff0000, v144
    v_lshlrev_b32 v150, 16, v145
    v_and_b32 v151, 0xffff0000, v145
    v_lshlrev_b32 v152, 16, v146
    v_and_b32 v153, 0xffff0000, v146
    v_lshlrev_b32 v154, 16, v147
    v_and_b32 v155, 0xffff0000, v147
    v_pk_add_f32 v[148:149], v[148:149], v[40:41]
    v_pk_add_f32 v[150:151], v[150:151], v[42:43]
    v_pk_add_f32 v[152:153], v[152:153], v[44:45]
    v_pk_add_f32 v[154:155], v[154:155], v[46:47]
    v_cvt_pk_bf16_f32 v180, v148, v149
    v_cvt_pk_bf16_f32 v181, v150, v151
    v_cvt_pk_bf16_f32 v182, v152, v153
    v_cvt_pk_bf16_f32 v183, v154, v155
    buffer_store_dwordx4 v[180:183], v193, s[16:19], 0 offen offset:64
    s_waitcnt vmcnt(3)
    v_lshlrev_b32 v132, 16, v72
    v_and_b32 v133, 0xffff0000, v72
    v_lshlrev_b32 v134, 16, v73
    v_and_b32 v135, 0xffff0000, v73
    v_lshlrev_b32 v136, 16, v74
    v_and_b32 v137, 0xffff0000, v74
    v_lshlrev_b32 v138, 16, v75
    v_and_b32 v139, 0xffff0000, v75
    v_pk_add_f32 v[16:17], v[16:17], v[132:133]
    v_pk_add_f32 v[18:19], v[18:19], v[134:135]
    v_pk_add_f32 v[20:21], v[20:21], v[136:137]
    v_pk_add_f32 v[22:23], v[22:23], v[138:139]
    v_cvt_pk_bf16_f32 v128, v16, v17
    v_cvt_pk_bf16_f32 v129, v18, v19
    v_cvt_pk_bf16_f32 v130, v20, v21
    v_cvt_pk_bf16_f32 v131, v22, v23
    s_nop 1
    v_permlane16_swap_b32 v128, v130
    v_permlane16_swap_b32 v129, v131
    s_nop 0
    v_lshlrev_b32 v132, 16, v128
    v_and_b32 v133, 0xffff0000, v128
    v_lshlrev_b32 v134, 16, v129
    v_and_b32 v135, 0xffff0000, v129
    v_lshlrev_b32 v136, 16, v130
    v_and_b32 v137, 0xffff0000, v130
    v_lshlrev_b32 v138, 16, v131
    v_and_b32 v139, 0xffff0000, v131
    v_pk_add_f32 v[132:133], v[132:133], v[48:49]
    v_pk_add_f32 v[134:135], v[134:135], v[50:51]
    v_pk_add_f32 v[136:137], v[136:137], v[52:53]
    v_pk_add_f32 v[138:139], v[138:139], v[54:55]
    v_cvt_pk_bf16_f32 v184, v132, v133
    v_cvt_pk_bf16_f32 v185, v134, v135
    v_cvt_pk_bf16_f32 v186, v136, v137
    v_cvt_pk_bf16_f32 v187, v138, v139
    buffer_store_dwordx4 v[184:187], v193, s[16:19], 0 offen offset:128
    s_waitcnt vmcnt(3)
    v_lshlrev_b32 v148, 16, v76
    v_and_b32 v149, 0xffff0000, v76
    v_lshlrev_b32 v150, 16, v77
    v_and_b32 v151, 0xffff0000, v77
    v_lshlrev_b32 v152, 16, v78
    v_and_b32 v153, 0xffff0000, v78
    v_lshlrev_b32 v154, 16, v79
    v_and_b32 v155, 0xffff0000, v79
    v_pk_add_f32 v[24:25], v[24:25], v[148:149]
    v_pk_add_f32 v[26:27], v[26:27], v[150:151]
    v_pk_add_f32 v[28:29], v[28:29], v[152:153]
    v_pk_add_f32 v[30:31], v[30:31], v[154:155]
    v_cvt_pk_bf16_f32 v144, v24, v25
    v_cvt_pk_bf16_f32 v145, v26, v27
    v_cvt_pk_bf16_f32 v146, v28, v29
    v_cvt_pk_bf16_f32 v147, v30, v31
    s_nop 1
    v_permlane16_swap_b32 v144, v146
    v_permlane16_swap_b32 v145, v147
    s_nop 0
    v_lshlrev_b32 v148, 16, v144
    v_and_b32 v149, 0xffff0000, v144
    v_lshlrev_b32 v150, 16, v145
    v_and_b32 v151, 0xffff0000, v145
    v_lshlrev_b32 v152, 16, v146
    v_and_b32 v153, 0xffff0000, v146
    v_lshlrev_b32 v154, 16, v147
    v_and_b32 v155, 0xffff0000, v147
    v_pk_add_f32 v[148:149], v[148:149], v[56:57]
    v_pk_add_f32 v[150:151], v[150:151], v[58:59]
    v_pk_add_f32 v[152:153], v[152:153], v[60:61]
    v_pk_add_f32 v[154:155], v[154:155], v[62:63]
    v_cvt_pk_bf16_f32 v188, v148, v149
    v_cvt_pk_bf16_f32 v189, v150, v151
    v_cvt_pk_bf16_f32 v190, v152, v153
    v_cvt_pk_bf16_f32 v191, v154, v155
    buffer_store_dwordx4 v[188:191], v193, s[16:19], 0 offen offset:192
    s_endpgm
kb_g1_46:
    s_setprio 3
    ds_write_b128 v206, v[0:3] offset:0
    ds_write_b128 v206, v[4:7] offset:1024
    ds_write_b128 v206, v[8:11] offset:2048
    ds_write_b128 v206, v[12:15] offset:3072
    ds_write_b128 v206, v[16:19] offset:4096
    ds_write_b128 v206, v[20:23] offset:5120
    ds_write_b128 v206, v[24:27] offset:6144
    ds_write_b128 v206, v[28:31] offset:7168
    v_subrev_u32 v206, 32768, v206
    s_add_u32 s29, s48, 8192
    s_waitcnt lgkmcnt(0)
    s_barrier
    ds_read_b128 v[64:67], v206 offset:0
    ds_read_b128 v[68:71], v206 offset:1024
    ds_read_b128 v[72:75], v206 offset:2048
    ds_read_b128 v[76:79], v206 offset:3072
    ds_read_b128 v[80:83], v206 offset:4096
    ds_read_b128 v[84:87], v206 offset:5120
    ds_read_b128 v[88:91], v206 offset:6144
    ds_read_b128 v[92:95], v206 offset:7168
    s_waitcnt lgkmcnt(7)
    v_pk_add_f32 v[64:65], v[64:65], v[32:33]
    v_pk_add_f32 v[66:67], v[66:67], v[34:35]
    v_cvt_pk_bf16_f32 v128, v64, v65
    v_cvt_pk_bf16_f32 v129, v66, v67
    s_waitcnt lgkmcnt(6)
    v_pk_add_f32 v[68:69], v[68:69], v[36:37]
    v_pk_add_f32 v[70:71], v[70:71], v[38:39]
    v_cvt_pk_bf16_f32 v130, v68, v69
    v_cvt_pk_bf16_f32 v131, v70, v71
    buffer_store_dwordx4 v[128:131], v204, s[44:47], s48 offen offset:0 sc1
    s_waitcnt lgkmcnt(5)
    v_pk_add_f32 v[72:73], v[72:73], v[40:41]
    v_pk_add_f32 v[74:75], v[74:75], v[42:43]
    v_cvt_pk_bf16_f32 v132, v72, v73
    v_cvt_pk_bf16_f32 v133, v74, v75
    s_waitcnt lgkmcnt(4)
    v_pk_add_f32 v[76:77], v[76:77], v[44:45]
    v_pk_add_f32 v[78:79], v[78:79], v[46:47]
    v_cvt_pk_bf16_f32 v134, v76, v77
    v_cvt_pk_bf16_f32 v135, v78, v79
    buffer_store_dwordx4 v[132:135], v204, s[44:47], s48 offen offset:1024 sc1
    s_waitcnt lgkmcnt(3)
    v_pk_add_f32 v[80:81], v[80:81], v[48:49]
    v_pk_add_f32 v[82:83], v[82:83], v[50:51]
    v_cvt_pk_bf16_f32 v136, v80, v81
    v_cvt_pk_bf16_f32 v137, v82, v83
    s_waitcnt lgkmcnt(2)
    v_pk_add_f32 v[84:85], v[84:85], v[52:53]
    v_pk_add_f32 v[86:87], v[86:87], v[54:55]
    v_cvt_pk_bf16_f32 v138, v84, v85
    v_cvt_pk_bf16_f32 v139, v86, v87
    buffer_store_dwordx4 v[136:139], v204, s[44:47], s48 offen offset:2048 sc1
    s_waitcnt lgkmcnt(1)
    v_pk_add_f32 v[88:89], v[88:89], v[56:57]
    v_pk_add_f32 v[90:91], v[90:91], v[58:59]
    v_cvt_pk_bf16_f32 v140, v88, v89
    v_cvt_pk_bf16_f32 v141, v90, v91
    s_waitcnt lgkmcnt(0)
    v_pk_add_f32 v[92:93], v[92:93], v[60:61]
    v_pk_add_f32 v[94:95], v[94:95], v[62:63]
    v_cvt_pk_bf16_f32 v142, v92, v93
    v_cvt_pk_bf16_f32 v143, v94, v95
    buffer_store_dwordx4 v[140:143], v204, s[44:47], s48 offen offset:3072 sc1
    s_waitcnt vmcnt(0)
    v_mov_b32 v200, s94
    v_mov_b32 v201, s95
    v_mov_b32 v202, s50
    s_mov_b64 exec, 1
    global_store_dwordx2 v202, v[200:201], s[96:97] sc1
    s_mov_b64 exec, -1
    s_endpgm
ka_done_1:
    s_endpgm
ka_fft_2:
    s_sub_u32 s42, s54, 28
    s_lshl_b32 s26, s55, 2
    s_add_u32 s42, s42, s26
    s_mov_b32 s40, s30
    s_mov_b64 s[26:27], s[48:49]
    s_mov_b64 s[88:89], s[52:53]
    s_mov_b64 s[90:91], s[50:51]
    v_lshlrev_b32 v2, 4, v1
    s_waitcnt vmcnt(0)
    s_load_dwordx2 s[78:79], s[0:1], 48
    s_lshl_b32 s76, s40, 5
    s_add_u32 s76, s76, s42
    s_lshl_b32 s76, s76, 13
    s_mov_b32 s77, 2097152
    s_waitcnt lgkmcnt(0)
    s_mov_b32 s72, s78
    s_mov_b32 s73, s79
    s_and_b32 s73, s73, 0xffff
    s_mov_b32 s74, 0x700000
    s_mov_b32 s75, 0x20000
    v_lshlrev_b32 v4, 3, v2
    buffer_load_dword v111, v4, s[72:75], s76 offen
    s_add_u32 s76, s76, s77
    v_lshlrev_b32 v4, 3, v2
    buffer_load_dword v111, v4, s[72:75], s76 offen
    s_add_u32 s76, s76, s77
    v_lshlrev_b32 v4, 3, v2
    buffer_load_dword v111, v4, s[72:75], s76 offen
    s_add_u32 s76, s76, s77
    v_lshlrev_b32 v4, 3, v2
    buffer_load_dword v111, v4, s[72:75], s76 offen
    s_add_u32 s76, s76, s77
    s_add_u32 s8, s24, 0x1800000
    s_addc_u32 s9, s25, 0
    s_and_b32 s9, s9, 0xffff
    s_mov_b32 s10, 0x400000
    s_mov_b32 s11, 0x20000
    s_add_u32 s16, s24, 0x2000000
    s_addc_u32 s17, s25, 0
    s_and_b32 s17, s17, 0xffff
    s_mov_b32 s18, 0x402000
    s_mov_b32 s19, 0x20000
    s_add_u32 s12, s24, 0x4000000
    s_addc_u32 s13, s25, 0
    s_and_b32 s13, s13, 0xffff
    s_mov_b32 s14, 0x400000
    s_mov_b32 s15, 0x20000
    s_lshl_b32 s48, s42, 3
    s_add_u32 s48, s48, s40
    s_mul_i32 s34, s48, 8192
    s_add_u32 s35, s34, 4096
    s_cmp_eq_u32 s48, 0
    s_cselect_b32 s31, 1, 0
    s_mov_b32 s30, 0
    v_lshrrev_b32 v116, 4, v1
    v_and_b32 v117, 15, v1
    v_xor_b32 v117, v117, v116
    v_lshlrev_b32 v117, 4, v117
    v_lshl_add_u32 v112, v116, 14, v117
    v_xor_b32 v113, 64, v112
    v_xor_b32 v114, 128, v112
    v_xor_b32 v115, 192, v112
    s_lshl_b32 s41, s40, 13
    s_add_u32 s41, s41, 32768
    s_lshl_b32 s43, s40, 19
    s_lshl_b32 s48, s42, 8
    s_add_u32 s43, s43, s48
    s_lshl_b32 s48, s40, 1
    v_and_b32 v4, 15, v1
    v_xor_b32 v4, s48, v4
    v_lshlrev_b32 v4, 4, v4
    v_lshl_add_u32 v4, v1, 8, v4
    v_add_u32 v3, 32768, v4
    v_xor_b32 v0, 16, v3
    v_and_b32 v240, 31, v1
    v_lshrrev_b32 v246, 5, v1
    v_lshlrev_b32 v246, 2, v246
    v_mul_u32_u24 v241, v246, v240
    v_add_u32 v242, 32, v240
    v_mul_u32_u24 v243, v246, v242
    s_cmp_lg_u32 s40, 0
    s_cbranch_scc1 jobs_51
    v_mad_u32_u24 v176, 0, v240, v241
    v_and_b32 v176, 2047, v176
    v_cvt_f32_u32 v176, v176
    v_mul_f32 v176, 0x3a000000, v176
    v_mad_u32_u24 v177, 1, v240, v241
    v_and_b32 v177, 2047, v177
    v_cvt_f32_u32 v177, v177
    v_mul_f32 v177, 0x3a000000, v177
    v_mad_u32_u24 v178, 2, v240, v241
    v_and_b32 v178, 2047, v178
    v_cvt_f32_u32 v178, v178
    v_mul_f32 v178, 0x3a000000, v178
    v_mad_u32_u24 v179, 3, v240, v241
    v_and_b32 v179, 2047, v179
    v_cvt_f32_u32 v179, v179
    v_mul_f32 v179, 0x3a000000, v179
    v_mad_u32_u24 v180, 8, v240, v241
    v_and_b32 v180, 2047, v180
    v_cvt_f32_u32 v180, v180
    v_mul_f32 v180, 0x3a000000, v180
    v_mad_u32_u24 v181, 9, v240, v241
    v_and_b32 v181, 2047, v181
    v_cvt_f32_u32 v181, v181
    v_mul_f32 v181, 0x3a000000, v181
    v_mad_u32_u24 v182, 10, v240, v241
    v_and_b32 v182, 2047, v182
    v_cvt_f32_u32 v182, v182
    v_mul_f32 v182, 0x3a000000, v182
    v_mad_u32_u24 v183, 11, v240, v241
    v_and_b32 v183, 2047, v183
    v_cvt_f32_u32 v183, v183
    v_mul_f32 v183, 0x3a000000, v183
    v_cos_f32 v184, v176
    v_cos_f32 v185, v177
    v_cos_f32 v186, v178
    v_cos_f32 v187, v179
    v_cos_f32 v188, v180
    v_cos_f32 v189, v181
    v_cos_f32 v190, v182
    v_cos_f32 v191, v183
    v_sin_f32 v192, v176
    v_sin_f32 v193, v177
    v_sin_f32 v194, v178
    v_sin_f32 v195, v179
    v_sin_f32 v196, v180
    v_sin_f32 v197, v181
    v_sin_f32 v198, v182
    v_sin_f32 v199, v183
    s_nop 0
    v_mul_f32 v184, 0x35800000, v184
    v_mul_f32 v185, 0x35800000, v185
    v_mul_f32 v186, 0x35800000, v186
    v_mul_f32 v187, 0x35800000, v187
    v_mul_f32 v188, 0x35800000, v188
    v_mul_f32 v189, 0x35800000, v189
    v_mul_f32 v190, 0x35800000, v190
    v_mul_f32 v191, 0x35800000, v191
    v_mul_f32 v192, 0x35800000, v192
    v_mul_f32 v193, 0x35800000, v193
    v_mul_f32 v194, 0x35800000, v194
    v_mul_f32 v195, 0x35800000, v195
    v_mul_f32 v196, 0x35800000, v196
    v_mul_f32 v197, 0x35800000, v197
    v_mul_f32 v198, 0x35800000, v198
    v_mul_f32 v199, 0x35800000, v199
    ds_write_b128 v2, v[184:187] offset:16384
    ds_write_b128 v2, v[192:195] offset:20480
    ds_write_b128 v2, v[188:191] offset:17408
    ds_write_b128 v2, v[196:199] offset:21504
    v_mad_u32_u24 v176, 32, v240, v241
    v_and_b32 v176, 2047, v176
    v_cvt_f32_u32 v176, v176
    v_mul_f32 v176, 0xba000000, v176
    v_mad_u32_u24 v177, 33, v240, v241
    v_and_b32 v177, 2047, v177
    v_cvt_f32_u32 v177, v177
    v_mul_f32 v177, 0xba000000, v177
    v_mad_u32_u24 v178, 34, v240, v241
    v_and_b32 v178, 2047, v178
    v_cvt_f32_u32 v178, v178
    v_mul_f32 v178, 0xba000000, v178
    v_mad_u32_u24 v179, 35, v240, v241
    v_and_b32 v179, 2047, v179
    v_cvt_f32_u32 v179, v179
    v_mul_f32 v179, 0xba000000, v179
    v_mad_u32_u24 v180, 40, v240, v241
    v_and_b32 v180, 2047, v180
    v_cvt_f32_u32 v180, v180
    v_mul_f32 v180, 0xba000000, v180
    v_mad_u32_u24 v181, 41, v240, v241
    v_and_b32 v181, 2047, v181
    v_cvt_f32_u32 v181, v181
    v_mul_f32 v181, 0xba000000, v181
    v_mad_u32_u24 v182, 42, v240, v241
    v_and_b32 v182, 2047, v182
    v_cvt_f32_u32 v182, v182
    v_mul_f32 v182, 0xba000000, v182
    v_mad_u32_u24 v183, 43, v240, v241
    v_and_b32 v183, 2047, v183
    v_cvt_f32_u32 v183, v183
    v_mul_f32 v183, 0xba000000, v183
    v_cos_f32 v184, v176
    v_cos_f32 v185, v177
    v_cos_f32 v186, v178
    v_cos_f32 v187, v179
    v_cos_f32 v188, v180
    v_cos_f32 v189, v181
    v_cos_f32 v190, v182
    v_cos_f32 v191, v183
    v_sin_f32 v192, v176
    v_sin_f32 v193, v177
    v_sin_f32 v194, v178
    v_sin_f32 v195, v179
    v_sin_f32 v196, v180
    v_sin_f32 v197, v181
    v_sin_f32 v198, v182
    v_sin_f32 v199, v183
    s_nop 0
    ds_write_b128 v2, v[184:187] offset:8192
    ds_write_b128 v2, v[192:195] offset:12288
    ds_write_b128 v2, v[188:191] offset:9216
    ds_write_b128 v2, v[196:199] offset:13312
    s_branch jobs_end_50
jobs_51:
    s_cmp_lg_u32 s40, 1
    s_cbranch_scc1 jobs_52
    v_mad_u32_u24 v176, 16, v240, v241
    v_and_b32 v176, 2047, v176
    v_cvt_f32_u32 v176, v176
    v_mul_f32 v176, 0x3a000000, v176
    v_mad_u32_u24 v177, 17, v240, v241
    v_and_b32 v177, 2047, v177
    v_cvt_f32_u32 v177, v177
    v_mul_f32 v177, 0x3a000000, v177
    v_mad_u32_u24 v178, 18, v240, v241
    v_and_b32 v178, 2047, v178
    v_cvt_f32_u32 v178, v178
    v_mul_f32 v178, 0x3a000000, v178
    v_mad_u32_u24 v179, 19, v240, v241
    v_and_b32 v179, 2047, v179
    v_cvt_f32_u32 v179, v179
    v_mul_f32 v179, 0x3a000000, v179
    v_mad_u32_u24 v180, 24, v240, v241
    v_and_b32 v180, 2047, v180
    v_cvt_f32_u32 v180, v180
    v_mul_f32 v180, 0x3a000000, v180
    v_mad_u32_u24 v181, 25, v240, v241
    v_and_b32 v181, 2047, v181
    v_cvt_f32_u32 v181, v181
    v_mul_f32 v181, 0x3a000000, v181
    v_mad_u32_u24 v182, 26, v240, v241
    v_and_b32 v182, 2047, v182
    v_cvt_f32_u32 v182, v182
    v_mul_f32 v182, 0x3a000000, v182
    v_mad_u32_u24 v183, 27, v240, v241
    v_and_b32 v183, 2047, v183
    v_cvt_f32_u32 v183, v183
    v_mul_f32 v183, 0x3a000000, v183
    v_cos_f32 v184, v176
    v_cos_f32 v185, v177
    v_cos_f32 v186, v178
    v_cos_f32 v187, v179
    v_cos_f32 v188, v180
    v_cos_f32 v189, v181
    v_cos_f32 v190, v182
    v_cos_f32 v191, v183
    v_sin_f32 v192, v176
    v_sin_f32 v193, v177
    v_sin_f32 v194, v178
    v_sin_f32 v195, v179
    v_sin_f32 v196, v180
    v_sin_f32 v197, v181
    v_sin_f32 v198, v182
    v_sin_f32 v199, v183
    s_nop 0
    v_mul_f32 v184, 0x35800000, v184
    v_mul_f32 v185, 0x35800000, v185
    v_mul_f32 v186, 0x35800000, v186
    v_mul_f32 v187, 0x35800000, v187
    v_mul_f32 v188, 0x35800000, v188
    v_mul_f32 v189, 0x35800000, v189
    v_mul_f32 v190, 0x35800000, v190
    v_mul_f32 v191, 0x35800000, v191
    v_mul_f32 v192, 0x35800000, v192
    v_mul_f32 v193, 0x35800000, v193
    v_mul_f32 v194, 0x35800000, v194
    v_mul_f32 v195, 0x35800000, v195
    v_mul_f32 v196, 0x35800000, v196
    v_mul_f32 v197, 0x35800000, v197
    v_mul_f32 v198, 0x35800000, v198
    v_mul_f32 v199, 0x35800000, v199
    ds_write_b128 v2, v[184:187] offset:18432
    ds_write_b128 v2, v[192:195] offset:22528
    ds_write_b128 v2, v[188:191] offset:19456
    ds_write_b128 v2, v[196:199] offset:23552
    v_mad_u32_u24 v176, 48, v240, v241
    v_and_b32 v176, 2047, v176
    v_cvt_f32_u32 v176, v176
    v_mul_f32 v176, 0xba000000, v176
    v_mad_u32_u24 v177, 49, v240, v241
    v_and_b32 v177, 2047, v177
    v_cvt_f32_u32 v177, v177
    v_mul_f32 v177, 0xba000000, v177
    v_mad_u32_u24 v178, 50, v240, v241
    v_and_b32 v178, 2047, v178
    v_cvt_f32_u32 v178, v178
    v_mul_f32 v178, 0xba000000, v178
    v_mad_u32_u24 v179, 51, v240, v241
    v_and_b32 v179, 2047, v179
    v_cvt_f32_u32 v179, v179
    v_mul_f32 v179, 0xba000000, v179
    v_mad_u32_u24 v180, 56, v240, v241
    v_and_b32 v180, 2047, v180
    v_cvt_f32_u32 v180, v180
    v_mul_f32 v180, 0xba000000, v180
    v_mad_u32_u24 v181, 57, v240, v241
    v_and_b32 v181, 2047, v181
    v_cvt_f32_u32 v181, v181
    v_mul_f32 v181, 0xba000000, v181
    v_mad_u32_u24 v182, 58, v240, v241
    v_and_b32 v182, 2047, v182
    v_cvt_f32_u32 v182, v182
    v_mul_f32 v182, 0xba000000, v182
    v_mad_u32_u24 v183, 59, v240, v241
    v_and_b32 v183, 2047, v183
    v_cvt_f32_u32 v183, v183
    v_mul_f32 v183, 0xba000000, v183
    v_cos_f32 v184, v176
    v_cos_f32 v185, v177
    v_cos_f32 v186, v178
    v_cos_f32 v187, v179
    v_cos_f32 v188, v180
    v_cos_f32 v189, v181
    v_cos_f32 v190, v182
    v_cos_f32 v191, v183
    v_sin_f32 v192, v176
    v_sin_f32 v193, v177
    v_sin_f32 v194, v178
    v_sin_f32 v195, v179
    v_sin_f32 v196, v180
    v_sin_f32 v197, v181
    v_sin_f32 v198, v182
    v_sin_f32 v199, v183
    s_nop 0
    ds_write_b128 v2, v[184:187] offset:10240
    ds_write_b128 v2, v[192:195] offset:14336
    ds_write_b128 v2, v[188:191] offset:11264
    ds_write_b128 v2, v[196:199] offset:15360
    s_branch jobs_end_50
jobs_52:
    s_cmp_lg_u32 s40, 2
    s_cbranch_scc1 jobs_53
    v_mad_u32_u24 v176, 0, v242, v243
    v_and_b32 v176, 2047, v176
    v_cvt_f32_u32 v176, v176
    v_mul_f32 v176, 0x3a000000, v176
    v_mad_u32_u24 v177, 1, v242, v243
    v_and_b32 v177, 2047, v177
    v_cvt_f32_u32 v177, v177
    v_mul_f32 v177, 0x3a000000, v177
    v_mad_u32_u24 v178, 2, v242, v243
    v_and_b32 v178, 2047, v178
    v_cvt_f32_u32 v178, v178
    v_mul_f32 v178, 0x3a000000, v178
    v_mad_u32_u24 v179, 3, v242, v243
    v_and_b32 v179, 2047, v179
    v_cvt_f32_u32 v179, v179
    v_mul_f32 v179, 0x3a000000, v179
    v_mad_u32_u24 v180, 8, v242, v243
    v_and_b32 v180, 2047, v180
    v_cvt_f32_u32 v180, v180
    v_mul_f32 v180, 0x3a000000, v180
    v_mad_u32_u24 v181, 9, v242, v243
    v_and_b32 v181, 2047, v181
    v_cvt_f32_u32 v181, v181
    v_mul_f32 v181, 0x3a000000, v181
    v_mad_u32_u24 v182, 10, v242, v243
    v_and_b32 v182, 2047, v182
    v_cvt_f32_u32 v182, v182
    v_mul_f32 v182, 0x3a000000, v182
    v_mad_u32_u24 v183, 11, v242, v243
    v_and_b32 v183, 2047, v183
    v_cvt_f32_u32 v183, v183
    v_mul_f32 v183, 0x3a000000, v183
    v_cos_f32 v184, v176
    v_cos_f32 v185, v177
    v_cos_f32 v186, v178
    v_cos_f32 v187, v179
    v_cos_f32 v188, v180
    v_cos_f32 v189, v181
    v_cos_f32 v190, v182
    v_cos_f32 v191, v183
    v_sin_f32 v192, v176
    v_sin_f32 v193, v177
    v_sin_f32 v194, v178
    v_sin_f32 v195, v179
    v_sin_f32 v196, v180
    v_sin_f32 v197, v181
    v_sin_f32 v198, v182
    v_sin_f32 v199, v183
    s_nop 0
    v_mul_f32 v184, 0x35800000, v184
    v_mul_f32 v185, 0x35800000, v185
    v_mul_f32 v186, 0x35800000, v186
    v_mul_f32 v187, 0x35800000, v187
    v_mul_f32 v188, 0x35800000, v188
    v_mul_f32 v189, 0x35800000, v189
    v_mul_f32 v190, 0x35800000, v190
    v_mul_f32 v191, 0x35800000, v191
    v_mul_f32 v192, 0x35800000, v192
    v_mul_f32 v193, 0x35800000, v193
    v_mul_f32 v194, 0x35800000, v194
    v_mul_f32 v195, 0x35800000, v195
    v_mul_f32 v196, 0x35800000, v196
    v_mul_f32 v197, 0x35800000, v197
    v_mul_f32 v198, 0x35800000, v198
    v_mul_f32 v199, 0x35800000, v199
    ds_write_b128 v2, v[184:187] offset:24576
    ds_write_b128 v2, v[192:195] offset:28672
    ds_write_b128 v2, v[188:191] offset:25600
    ds_write_b128 v2, v[196:199] offset:29696
    s_branch jobs_end_50
jobs_53:
    s_cmp_lg_u32 s40, 3
    s_cbranch_scc1 jobs_54
    v_mad_u32_u24 v176, 16, v242, v243
    v_and_b32 v176, 2047, v176
    v_cvt_f32_u32 v176, v176
    v_mul_f32 v176, 0x3a000000, v176
    v_mad_u32_u24 v177, 17, v242, v243
    v_and_b32 v177, 2047, v177
    v_cvt_f32_u32 v177, v177
    v_mul_f32 v177, 0x3a000000, v177
    v_mad_u32_u24 v178, 18, v242, v243
    v_and_b32 v178, 2047, v178
    v_cvt_f32_u32 v178, v178
    v_mul_f32 v178, 0x3a000000, v178
    v_mad_u32_u24 v179, 19, v242, v243
    v_and_b32 v179, 2047, v179
    v_cvt_f32_u32 v179, v179
    v_mul_f32 v179, 0x3a000000, v179
    v_mad_u32_u24 v180, 24, v242, v243
    v_and_b32 v180, 2047, v180
    v_cvt_f32_u32 v180, v180
    v_mul_f32 v180, 0x3a000000, v180
    v_mad_u32_u24 v181, 25, v242, v243
    v_and_b32 v181, 2047, v181
    v_cvt_f32_u32 v181, v181
    v_mul_f32 v181, 0x3a000000, v181
    v_mad_u32_u24 v182, 26, v242, v243
    v_and_b32 v182, 2047, v182
    v_cvt_f32_u32 v182, v182
    v_mul_f32 v182, 0x3a000000, v182
    v_mad_u32_u24 v183, 27, v242, v243
    v_and_b32 v183, 2047, v183
    v_cvt_f32_u32 v183, v183
    v_mul_f32 v183, 0x3a000000, v183
    v_cos_f32 v184, v176
    v_cos_f32 v185, v177
    v_cos_f32 v186, v178
    v_cos_f32 v187, v179
    v_cos_f32 v188, v180
    v_cos_f32 v189, v181
    v_cos_f32 v190, v182
    v_cos_f32 v191, v183
    v_sin_f32 v192, v176
    v_sin_f32 v193, v177
    v_sin_f32 v194, v178
    v_sin_f32 v195, v179
    v_sin_f32 v196, v180
    v_sin_f32 v197, v181
    v_sin_f32 v198, v182
    v_sin_f32 v199, v183
    s_nop 0
    v_mul_f32 v184, 0x35800000, v184
    v_mul_f32 v185, 0x35800000, v185
    v_mul_f32 v186, 0x35800000, v186
    v_mul_f32 v187, 0x35800000, v187
    v_mul_f32 v188, 0x35800000, v188
    v_mul_f32 v189, 0x35800000, v189
    v_mul_f32 v190, 0x35800000, v190
    v_mul_f32 v191, 0x35800000, v191
    v_mul_f32 v192, 0x35800000, v192
    v_mul_f32 v193, 0x35800000, v193
    v_mul_f32 v194, 0x35800000, v194
    v_mul_f32 v195, 0x35800000, v195
    v_mul_f32 v196, 0x35800000, v196
    v_mul_f32 v197, 0x35800000, v197
    v_mul_f32 v198, 0x35800000, v198
    v_mul_f32 v199, 0x35800000, v199
    ds_write_b128 v2, v[184:187] offset:26624
    ds_write_b128 v2, v[192:195] offset:30720
    ds_write_b128 v2, v[188:191] offset:27648
    ds_write_b128 v2, v[196:199] offset:31744
    s_branch jobs_end_50
jobs_54:
    s_cmp_lg_u32 s40, 4
    s_cbranch_scc1 jobs_55
    v_mad_u32_u24 v176, 0, v240, v241
    v_and_b32 v176, 31, v176
    v_cvt_f32_u32 v176, v176
    v_mul_f32 v176, 0x3d000000, v176
    v_mad_u32_u24 v177, 1, v240, v241
    v_and_b32 v177, 31, v177
    v_cvt_f32_u32 v177, v177
    v_mul_f32 v177, 0x3d000000, v177
    v_mad_u32_u24 v178, 2, v240, v241
    v_and_b32 v178, 31, v178
    v_cvt_f32_u32 v178, v178
    v_mul_f32 v178, 0x3d000000, v178
    v_mad_u32_u24 v179, 3, v240, v241
    v_and_b32 v179, 31, v179
    v_cvt_f32_u32 v179, v179
    v_mul_f32 v179, 0x3d000000, v179
    v_mad_u32_u24 v180, 8, v240, v241
    v_and_b32 v180, 31, v180
    v_cvt_f32_u32 v180, v180
    v_mul_f32 v180, 0x3d000000, v180
    v_mad_u32_u24 v181, 9, v240, v241
    v_and_b32 v181, 31, v181
    v_cvt_f32_u32 v181, v181
    v_mul_f32 v181, 0x3d000000, v181
    v_mad_u32_u24 v182, 10, v240, v241
    v_and_b32 v182, 31, v182
    v_cvt_f32_u32 v182, v182
    v_mul_f32 v182, 0x3d000000, v182
    v_mad_u32_u24 v183, 11, v240, v241
    v_and_b32 v183, 31, v183
    v_cvt_f32_u32 v183, v183
    v_mul_f32 v183, 0x3d000000, v183
    v_cos_f32 v184, v176
    v_cos_f32 v185, v177
    v_cos_f32 v186, v178
    v_cos_f32 v187, v179
    v_cos_f32 v188, v180
    v_cos_f32 v189, v181
    v_cos_f32 v190, v182
    v_cos_f32 v191, v183
    v_sin_f32 v192, v176
    v_sin_f32 v193, v177
    v_sin_f32 v194, v178
    v_sin_f32 v195, v179
    v_sin_f32 v196, v180
    v_sin_f32 v197, v181
    v_sin_f32 v198, v182
    v_sin_f32 v199, v183
    s_nop 0
    v_cvt_pk_bf16_f32 v200, v184, v185
    v_cvt_pk_bf16_f32 v201, v186, v187
    v_cvt_pk_bf16_f32 v202, v188, v189
    v_cvt_pk_bf16_f32 v203, v190, v191
    ds_write_b128 v2, v[200:203] offset:32768
    v_cvt_pk_bf16_f32 v204, v192, v193
    v_cvt_pk_bf16_f32 v205, v194, v195
    v_cvt_pk_bf16_f32 v206, v196, v197
    v_cvt_pk_bf16_f32 v207, v198, v199
    ds_write_b128 v2, v[204:207] offset:34816
    v_cvt_pk_bf16_f32 v208, -v192, -v193
    v_cvt_pk_bf16_f32 v209, -v194, -v195
    v_cvt_pk_bf16_f32 v210, -v196, -v197
    v_cvt_pk_bf16_f32 v211, -v198, -v199
    ds_write_b128 v2, v[208:211] offset:36864
    v_mad_u32_u24 v176, 1, v240, v241
    v_and_b32 v176, 63, v176
    v_cvt_f32_u32 v176, v176
    v_mul_f32 v176, 0x3c800000, v176
    v_mad_u32_u24 v177, 3, v240, v241
    v_and_b32 v177, 63, v177
    v_cvt_f32_u32 v177, v177
    v_mul_f32 v177, 0x3c800000, v177
    v_mad_u32_u24 v178, 9, v240, v241
    v_and_b32 v178, 63, v178
    v_cvt_f32_u32 v178, v178
    v_mul_f32 v178, 0x3c800000, v178
    v_mad_u32_u24 v179, 11, v240, v241
    v_and_b32 v179, 63, v179
    v_cvt_f32_u32 v179, v179
    v_mul_f32 v179, 0x3c800000, v179
    v_mad_u32_u24 v180, 17, v240, v241
    v_and_b32 v180, 63, v180
    v_cvt_f32_u32 v180, v180
    v_mul_f32 v180, 0x3c800000, v180
    v_mad_u32_u24 v181, 19, v240, v241
    v_and_b32 v181, 63, v181
    v_cvt_f32_u32 v181, v181
    v_mul_f32 v181, 0x3c800000, v181
    v_mad_u32_u24 v182, 25, v240, v241
    v_and_b32 v182, 63, v182
    v_cvt_f32_u32 v182, v182
    v_mul_f32 v182, 0x3c800000, v182
    v_mad_u32_u24 v183, 27, v240, v241
    v_and_b32 v183, 63, v183
    v_cvt_f32_u32 v183, v183
    v_mul_f32 v183, 0x3c800000, v183
    v_cos_f32 v184, v176
    v_cos_f32 v185, v177
    v_cos_f32 v186, v178
    v_cos_f32 v187, v179
    v_cos_f32 v188, v180
    v_cos_f32 v189, v181
    v_cos_f32 v190, v182
    v_cos_f32 v191, v183
    v_sin_f32 v192, v176
    v_sin_f32 v193, v177
    v_sin_f32 v194, v178
    v_sin_f32 v195, v179
    v_sin_f32 v196, v180
    v_sin_f32 v197, v181
    v_sin_f32 v198, v182
    v_sin_f32 v199, v183
    s_nop 0
    v_cvt_pk_bf16_f32 v200, v184, v185
    v_cvt_pk_bf16_f32 v201, v186, v187
    v_cvt_pk_bf16_f32 v202, v188, v189
    v_cvt_pk_bf16_f32 v203, v190, v191
    ds_write_b128 v2, v[200:203] offset:45056
    v_cvt_pk_bf16_f32 v204, v192, v193
    v_cvt_pk_bf16_f32 v205, v194, v195
    v_cvt_pk_bf16_f32 v206, v196, v197
    v_cvt_pk_bf16_f32 v207, v198, v199
    ds_write_b128 v2, v[204:207] offset:47104
    v_cvt_pk_bf16_f32 v208, -v192, -v193
    v_cvt_pk_bf16_f32 v209, -v194, -v195
    v_cvt_pk_bf16_f32 v210, -v196, -v197
    v_cvt_pk_bf16_f32 v211, -v198, -v199
    ds_write_b128 v2, v[208:211] offset:49152
    s_branch jobs_end_50
jobs_55:
    s_cmp_lg_u32 s40, 5
    s_cbranch_scc1 jobs_56
    v_mad_u32_u24 v176, 16, v240, v241
    v_and_b32 v176, 31, v176
    v_cvt_f32_u32 v176, v176
    v_mul_f32 v176, 0x3d000000, v176
    v_mad_u32_u24 v177, 17, v240, v241
    v_and_b32 v177, 31, v177
    v_cvt_f32_u32 v177, v177
    v_mul_f32 v177, 0x3d000000, v177
    v_mad_u32_u24 v178, 18, v240, v241
    v_and_b32 v178, 31, v178
    v_cvt_f32_u32 v178, v178
    v_mul_f32 v178, 0x3d000000, v178
    v_mad_u32_u24 v179, 19, v240, v241
    v_and_b32 v179, 31, v179
    v_cvt_f32_u32 v179, v179
    v_mul_f32 v179, 0x3d000000, v179
    v_mad_u32_u24 v180, 24, v240, v241
    v_and_b32 v180, 31, v180
    v_cvt_f32_u32 v180, v180
    v_mul_f32 v180, 0x3d000000, v180
    v_mad_u32_u24 v181, 25, v240, v241
    v_and_b32 v181, 31, v181
    v_cvt_f32_u32 v181, v181
    v_mul_f32 v181, 0x3d000000, v181
    v_mad_u32_u24 v182, 26, v240, v241
    v_and_b32 v182, 31, v182
    v_cvt_f32_u32 v182, v182
    v_mul_f32 v182, 0x3d000000, v182
    v_mad_u32_u24 v183, 27, v240, v241
    v_and_b32 v183, 31, v183
    v_cvt_f32_u32 v183, v183
    v_mul_f32 v183, 0x3d000000, v183
    v_cos_f32 v184, v176
    v_cos_f32 v185, v177
    v_cos_f32 v186, v178
    v_cos_f32 v187, v179
    v_cos_f32 v188, v180
    v_cos_f32 v189, v181
    v_cos_f32 v190, v182
    v_cos_f32 v191, v183
    v_sin_f32 v192, v176
    v_sin_f32 v193, v177
    v_sin_f32 v194, v178
    v_sin_f32 v195, v179
    v_sin_f32 v196, v180
    v_sin_f32 v197, v181
    v_sin_f32 v198, v182
    v_sin_f32 v199, v183
    s_nop 0
    v_cvt_pk_bf16_f32 v200, v184, v185
    v_cvt_pk_bf16_f32 v201, v186, v187
    v_cvt_pk_bf16_f32 v202, v188, v189
    v_cvt_pk_bf16_f32 v203, v190, v191
    ds_write_b128 v2, v[200:203] offset:33792
    v_cvt_pk_bf16_f32 v204, v192, v193
    v_cvt_pk_bf16_f32 v205, v194, v195
    v_cvt_pk_bf16_f32 v206, v196, v197
    v_cvt_pk_bf16_f32 v207, v198, v199
    ds_write_b128 v2, v[204:207] offset:35840
    v_cvt_pk_bf16_f32 v208, -v192, -v193
    v_cvt_pk_bf16_f32 v209, -v194, -v195
    v_cvt_pk_bf16_f32 v210, -v196, -v197
    v_cvt_pk_bf16_f32 v211, -v198, -v199
    ds_write_b128 v2, v[208:211] offset:37888
    v_mad_u32_u24 v176, 33, v240, v241
    v_and_b32 v176, 63, v176
    v_cvt_f32_u32 v176, v176
    v_mul_f32 v176, 0x3c800000, v176
    v_mad_u32_u24 v177, 35, v240, v241
    v_and_b32 v177, 63, v177
    v_cvt_f32_u32 v177, v177
    v_mul_f32 v177, 0x3c800000, v177
    v_mad_u32_u24 v178, 41, v240, v241
    v_and_b32 v178, 63, v178
    v_cvt_f32_u32 v178, v178
    v_mul_f32 v178, 0x3c800000, v178
    v_mad_u32_u24 v179, 43, v240, v241
    v_and_b32 v179, 63, v179
    v_cvt_f32_u32 v179, v179
    v_mul_f32 v179, 0x3c800000, v179
    v_mad_u32_u24 v180, 49, v240, v241
    v_and_b32 v180, 63, v180
    v_cvt_f32_u32 v180, v180
    v_mul_f32 v180, 0x3c800000, v180
    v_mad_u32_u24 v181, 51, v240, v241
    v_and_b32 v181, 63, v181
    v_cvt_f32_u32 v181, v181
    v_mul_f32 v181, 0x3c800000, v181
    v_mad_u32_u24 v182, 57, v240, v241
    v_and_b32 v182, 63, v182
    v_cvt_f32_u32 v182, v182
    v_mul_f32 v182, 0x3c800000, v182
    v_mad_u32_u24 v183, 59, v240, v241
    v_and_b32 v183, 63, v183
    v_cvt_f32_u32 v183, v183
    v_mul_f32 v183, 0x3c800000, v183
    v_cos_f32 v184, v176
    v_cos_f32 v185, v177
    v_cos_f32 v186, v178
    v_cos_f32 v187, v179
    v_cos_f32 v188, v180
    v_cos_f32 v189, v181
    v_cos_f32 v190, v182
    v_cos_f32 v191, v183
    v_sin_f32 v192, v176
    v_sin_f32 v193, v177
    v_sin_f32 v194, v178
    v_sin_f32 v195, v179
    v_sin_f32 v196, v180
    v_sin_f32 v197, v181
    v_sin_f32 v198, v182
    v_sin_f32 v199, v183
    s_nop 0
    v_cvt_pk_bf16_f32 v200, v184, v185
    v_cvt_pk_bf16_f32 v201, v186, v187
    v_cvt_pk_bf16_f32 v202, v188, v189
    v_cvt_pk_bf16_f32 v203, v190, v191
    ds_write_b128 v2, v[200:203] offset:46080
    v_cvt_pk_bf16_f32 v204, v192, v193
    v_cvt_pk_bf16_f32 v205, v194, v195
    v_cvt_pk_bf16_f32 v206, v196, v197
    v_cvt_pk_bf16_f32 v207, v198, v199
    ds_write_b128 v2, v[204:207] offset:48128
    v_cvt_pk_bf16_f32 v208, -v192, -v193
    v_cvt_pk_bf16_f32 v209, -v194, -v195
    v_cvt_pk_bf16_f32 v210, -v196, -v197
    v_cvt_pk_bf16_f32 v211, -v198, -v199
    ds_write_b128 v2, v[208:211] offset:50176
    s_branch jobs_end_50
jobs_56:
    s_cmp_lg_u32 s40, 6
    s_cbranch_scc1 jobs_57
    v_mad_u32_u24 v176, 0, v240, v241
    v_and_b32 v176, 63, v176
    v_cvt_f32_u32 v176, v176
    v_mul_f32 v176, 0x3c800000, v176
    v_mad_u32_u24 v177, 2, v240, v241
    v_and_b32 v177, 63, v177
    v_cvt_f32_u32 v177, v177
    v_mul_f32 v177, 0x3c800000, v177
    v_mad_u32_u24 v178, 8, v240, v241
    v_and_b32 v178, 63, v178
    v_cvt_f32_u32 v178, v178
    v_mul_f32 v178, 0x3c800000, v178
    v_mad_u32_u24 v179, 10, v240, v241
    v_and_b32 v179, 63, v179
    v_cvt_f32_u32 v179, v179
    v_mul_f32 v179, 0x3c800000, v179
    v_mad_u32_u24 v180, 16, v240, v241
    v_and_b32 v180, 63, v180
    v_cvt_f32_u32 v180, v180
    v_mul_f32 v180, 0x3c800000, v180
    v_mad_u32_u24 v181, 18, v240, v241
    v_and_b32 v181, 63, v181
    v_cvt_f32_u32 v181, v181
    v_mul_f32 v181, 0x3c800000, v181
    v_mad_u32_u24 v182, 24, v240, v241
    v_and_b32 v182, 63, v182
    v_cvt_f32_u32 v182, v182
    v_mul_f32 v182, 0x3c800000, v182
    v_mad_u32_u24 v183, 26, v240, v241
    v_and_b32 v183, 63, v183
    v_cvt_f32_u32 v183, v183
    v_mul_f32 v183, 0x3c800000, v183
    v_cos_f32 v184, v176
    v_cos_f32 v185, v177
    v_cos_f32 v186, v178
    v_cos_f32 v187, v179
    v_cos_f32 v188, v180
    v_cos_f32 v189, v181
    v_cos_f32 v190, v182
    v_cos_f32 v191, v183
    v_sin_f32 v192, v176
    v_sin_f32 v193, v177
    v_sin_f32 v194, v178
    v_sin_f32 v195, v179
    v_sin_f32 v196, v180
    v_sin_f32 v197, v181
    v_sin_f32 v198, v182
    v_sin_f32 v199, v183
    s_nop 0
    v_cvt_pk_bf16_f32 v200, v184, v185
    v_cvt_pk_bf16_f32 v201, v186, v187
    v_cvt_pk_bf16_f32 v202, v188, v189
    v_cvt_pk_bf16_f32 v203, v190, v191
    ds_write_b128 v2, v[200:203] offset:38912
    v_cvt_pk_bf16_f32 v204, v192, v193
    v_cvt_pk_bf16_f32 v205, v194, v195
    v_cvt_pk_bf16_f32 v206, v196, v197
    v_cvt_pk_bf16_f32 v207, v198, v199
    ds_write_b128 v2, v[204:207] offset:40960
    v_cvt_pk_bf16_f32 v208, -v192, -v193
    v_cvt_pk_bf16_f32 v209, -v194, -v195
    v_cvt_pk_bf16_f32 v210, -v196, -v197
    v_cvt_pk_bf16_f32 v211, -v198, -v199
    ds_write_b128 v2, v[208:211] offset:43008
    v_mad_u32_u24 v176, 0, v240, v241
    v_and_b32 v176, 2047, v176
    v_cvt_f32_u32 v176, v176
    v_mul_f32 v176, 0xba000000, v176
    v_mad_u32_u24 v177, 1, v240, v241
    v_and_b32 v177, 2047, v177
    v_cvt_f32_u32 v177, v177
    v_mul_f32 v177, 0xba000000, v177
    v_mad_u32_u24 v178, 2, v240, v241
    v_and_b32 v178, 2047, v178
    v_cvt_f32_u32 v178, v178
    v_mul_f32 v178, 0xba000000, v178
    v_mad_u32_u24 v179, 3, v240, v241
    v_and_b32 v179, 2047, v179
    v_cvt_f32_u32 v179, v179
    v_mul_f32 v179, 0xba000000, v179
    v_mad_u32_u24 v180, 8, v240, v241
    v_and_b32 v180, 2047, v180
    v_cvt_f32_u32 v180, v180
    v_mul_f32 v180, 0xba000000, v180
    v_mad_u32_u24 v181, 9, v240, v241
    v_and_b32 v181, 2047, v181
    v_cvt_f32_u32 v181, v181
    v_mul_f32 v181, 0xba000000, v181
    v_mad_u32_u24 v182, 10, v240, v241
    v_and_b32 v182, 2047, v182
    v_cvt_f32_u32 v182, v182
    v_mul_f32 v182, 0xba000000, v182
    v_mad_u32_u24 v183, 11, v240, v241
    v_and_b32 v183, 2047, v183
    v_cvt_f32_u32 v183, v183
    v_mul_f32 v183, 0xba000000, v183
    v_cos_f32 v184, v176
    v_cos_f32 v185, v177
    v_cos_f32 v186, v178
    v_cos_f32 v187, v179
    v_cos_f32 v188, v180
    v_cos_f32 v189, v181
    v_cos_f32 v190, v182
    v_cos_f32 v191, v183
    v_sin_f32 v192, v176
    v_sin_f32 v193, v177
    v_sin_f32 v194, v178
    v_sin_f32 v195, v179
    v_sin_f32 v196, v180
    v_sin_f32 v197, v181
    v_sin_f32 v198, v182
    v_sin_f32 v199, v183
    s_nop 0
    ds_write_b128 v2, v[184:187] offset:0
    ds_write_b128 v2, v[192:195] offset:4096
    ds_write_b128 v2, v[188:191] offset:1024
    ds_write_b128 v2, v[196:199] offset:5120
    s_branch jobs_end_50
jobs_57:
    s_cmp_lg_u32 s40, 7
    s_cbranch_scc1 jobs_58
    v_mad_u32_u24 v176, 32, v240, v241
    v_and_b32 v176, 63, v176
    v_cvt_f32_u32 v176, v176
    v_mul_f32 v176, 0x3c800000, v176
    v_mad_u32_u24 v177, 34, v240, v241
    v_and_b32 v177, 63, v177
    v_cvt_f32_u32 v177, v177
    v_mul_f32 v177, 0x3c800000, v177
    v_mad_u32_u24 v178, 40, v240, v241
    v_and_b32 v178, 63, v178
    v_cvt_f32_u32 v178, v178
    v_mul_f32 v178, 0x3c800000, v178
    v_mad_u32_u24 v179, 42, v240, v241
    v_and_b32 v179, 63, v179
    v_cvt_f32_u32 v179, v179
    v_mul_f32 v179, 0x3c800000, v179
    v_mad_u32_u24 v180, 48, v240, v241
    v_and_b32 v180, 63, v180
    v_cvt_f32_u32 v180, v180
    v_mul_f32 v180, 0x3c800000, v180
    v_mad_u32_u24 v181, 50, v240, v241
    v_and_b32 v181, 63, v181
    v_cvt_f32_u32 v181, v181
    v_mul_f32 v181, 0x3c800000, v181
    v_mad_u32_u24 v182, 56, v240, v241
    v_and_b32 v182, 63, v182
    v_cvt_f32_u32 v182, v182
    v_mul_f32 v182, 0x3c800000, v182
    v_mad_u32_u24 v183, 58, v240, v241
    v_and_b32 v183, 63, v183
    v_cvt_f32_u32 v183, v183
    v_mul_f32 v183, 0x3c800000, v183
    v_cos_f32 v184, v176
    v_cos_f32 v185, v177
    v_cos_f32 v186, v178
    v_cos_f32 v187, v179
    v_cos_f32 v188, v180
    v_cos_f32 v189, v181
    v_cos_f32 v190, v182
    v_cos_f32 v191, v183
    v_sin_f32 v192, v176
    v_sin_f32 v193, v177
    v_sin_f32 v194, v178
    v_sin_f32 v195, v179
    v_sin_f32 v196, v180
    v_sin_f32 v197, v181
    v_sin_f32 v198, v182
    v_sin_f32 v199, v183
    s_nop 0
    v_cvt_pk_bf16_f32 v200, v184, v185
    v_cvt_pk_bf16_f32 v201, v186, v187
    v_cvt_pk_bf16_f32 v202, v188, v189
    v_cvt_pk_bf16_f32 v203, v190, v191
    ds_write_b128 v2, v[200:203] offset:39936
    v_cvt_pk_bf16_f32 v204, v192, v193
    v_cvt_pk_bf16_f32 v205, v194, v195
    v_cvt_pk_bf16_f32 v206, v196, v197
    v_cvt_pk_bf16_f32 v207, v198, v199
    ds_write_b128 v2, v[204:207] offset:41984
    v_cvt_pk_bf16_f32 v208, -v192, -v193
    v_cvt_pk_bf16_f32 v209, -v194, -v195
    v_cvt_pk_bf16_f32 v210, -v196, -v197
    v_cvt_pk_bf16_f32 v211, -v198, -v199
    ds_write_b128 v2, v[208:211] offset:44032
    v_mad_u32_u24 v176, 16, v240, v241
    v_and_b32 v176, 2047, v176
    v_cvt_f32_u32 v176, v176
    v_mul_f32 v176, 0xba000000, v176
    v_mad_u32_u24 v177, 17, v240, v241
    v_and_b32 v177, 2047, v177
    v_cvt_f32_u32 v177, v177
    v_mul_f32 v177, 0xba000000, v177
    v_mad_u32_u24 v178, 18, v240, v241
    v_and_b32 v178, 2047, v178
    v_cvt_f32_u32 v178, v178
    v_mul_f32 v178, 0xba000000, v178
    v_mad_u32_u24 v179, 19, v240, v241
    v_and_b32 v179, 2047, v179
    v_cvt_f32_u32 v179, v179
    v_mul_f32 v179, 0xba000000, v179
    v_mad_u32_u24 v180, 24, v240, v241
    v_and_b32 v180, 2047, v180
    v_cvt_f32_u32 v180, v180
    v_mul_f32 v180, 0xba000000, v180
    v_mad_u32_u24 v181, 25, v240, v241
    v_and_b32 v181, 2047, v181
    v_cvt_f32_u32 v181, v181
    v_mul_f32 v181, 0xba000000, v181
    v_mad_u32_u24 v182, 26, v240, v241
    v_and_b32 v182, 2047, v182
    v_cvt_f32_u32 v182, v182
    v_mul_f32 v182, 0xba000000, v182
    v_mad_u32_u24 v183, 27, v240, v241
    v_and_b32 v183, 2047, v183
    v_cvt_f32_u32 v183, v183
    v_mul_f32 v183, 0xba000000, v183
    v_cos_f32 v184, v176
    v_cos_f32 v185, v177
    v_cos_f32 v186, v178
    v_cos_f32 v187, v179
    v_cos_f32 v188, v180
    v_cos_f32 v189, v181
    v_cos_f32 v190, v182
    v_cos_f32 v191, v183
    v_sin_f32 v192, v176
    v_sin_f32 v193, v177
    v_sin_f32 v194, v178
    v_sin_f32 v195, v179
    v_sin_f32 v196, v180
    v_sin_f32 v197, v181
    v_sin_f32 v198, v182
    v_sin_f32 v199, v183
    s_nop 0
    ds_write_b128 v2, v[184:187] offset:2048
    ds_write_b128 v2, v[192:195] offset:6144
    ds_write_b128 v2, v[188:191] offset:3072
    ds_write_b128 v2, v[196:199] offset:7168
    s_branch jobs_end_50
jobs_58:
jobs_end_50:
    s_waitcnt lgkmcnt(0)
    s_barrier
    s_cmp_lg_u32 s40, 4
    s_cbranch_scc1 r3_yf_59
    s_add_u32 s48, s81, 1024
    s_lshl_b32 s48, s48, 7
    v_mov_b32 v4, s90
    v_mov_b32 v5, s91
    v_mov_b32 v6, s48
    s_mov_b64 exec, 1
    global_store_dwordx2 v6, v[4:5], s[88:89] sc1
    s_mov_b64 exec, -1
r3_yf_59:
    ds_read_b128 v[8:11], v2 offset:32768
    ds_read_b128 v[12:15], v2 offset:33792
    ds_read_b128 v[16:19], v2 offset:34816
    ds_read_b128 v[20:23], v2 offset:35840
    ds_read_b128 v[24:27], v2 offset:36864
    ds_read_b128 v[28:31], v2 offset:37888
    ds_read_b128 v[32:35], v2 offset:38912
    ds_read_b128 v[36:39], v2 offset:39936
    ds_read_b128 v[40:43], v2 offset:40960
    ds_read_b128 v[44:47], v2 offset:41984
    ds_read_b128 v[48:51], v2 offset:43008
    ds_read_b128 v[52:55], v2 offset:44032
    ds_read_b128 v[56:59], v2 offset:45056
    ds_read_b128 v[60:63], v2 offset:46080
    ds_read_b128 v[64:67], v2 offset:47104
    ds_read_b128 v[68:71], v2 offset:48128
    ds_read_b128 v[72:75], v2 offset:49152
    ds_read_b128 v[76:79], v2 offset:50176
    s_waitcnt lgkmcnt(0)
    s_barrier
    s_lshl_b32 s48, s40, 12
    s_add_u32 s48, s48, 131072
    v_and_b32 v4, 31, v1
    v_lshl_add_u32 v4, v4, 7, s48
pollf_60:
    s_sleep 3
    global_load_dwordx2 v[80:81], v4, s[88:89] offset:0 sc1
    s_waitcnt vmcnt(0)
    v_cmp_eq_u64 vcc, s[90:91], v[80:81]
    s_nop 1
    s_cmp_eq_u64 vcc, -1
    s_cbranch_scc0 pollf_60
    s_add_u32 m0, s41, 0
    s_add_u32 s48, s43, 0
    buffer_load_dwordx4 v112, s[8:11], s48 offen sc1 lds
    s_add_u32 m0, s41, 1024
    s_add_u32 s48, s43, 65536
    buffer_load_dwordx4 v113, s[8:11], s48 offen sc1 lds
    s_add_u32 m0, s41, 2048
    s_add_u32 s48, s43, 131072
    buffer_load_dwordx4 v114, s[8:11], s48 offen sc1 lds
    s_add_u32 m0, s41, 3072
    s_add_u32 s48, s43, 196608
    buffer_load_dwordx4 v115, s[8:11], s48 offen sc1 lds
    s_add_u32 m0, s41, 4096
    s_add_u32 s48, s43, 262144
    buffer_load_dwordx4 v112, s[8:11], s48 offen sc1 lds
    s_add_u32 m0, s41, 5120
    s_add_u32 s48, s43, 327680
    buffer_load_dwordx4 v113, s[8:11], s48 offen sc1 lds
    s_add_u32 m0, s41, 6144
    s_add_u32 s48, s43, 393216
    buffer_load_dwordx4 v114, s[8:11], s48 offen sc1 lds
    s_add_u32 m0, s41, 7168
    s_add_u32 s48, s43, 458752
    buffer_load_dwordx4 v115, s[8:11], s48 offen sc1 lds
    s_waitcnt vmcnt(0)
    s_barrier
    buffer_load_dwordx4 v[144:147], v2, s[16:19], s34 offen offset:0 sc1
    buffer_load_dwordx4 v[148:151], v2, s[16:19], s34 offen offset:1024 sc1
    buffer_load_dwordx4 v[152:155], v2, s[16:19], s34 offen offset:2048 sc1
    buffer_load_dwordx4 v[156:159], v2, s[16:19], s34 offen offset:3072 sc1
    buffer_load_dwordx4 v[160:163], v2, s[16:19], s35 offen offset:0 sc1
    buffer_load_dwordx4 v[164:167], v2, s[16:19], s35 offen offset:1024 sc1
    buffer_load_dwordx4 v[168:171], v2, s[16:19], s35 offen offset:2048 sc1
    buffer_load_dwordx4 v[172:175], v2, s[16:19], s35 offen offset:3072 sc1
    s_add_u32 m0, s41, 65536
    s_add_u32 s48, s43, 8192
    buffer_load_dwordx4 v112, s[8:11], s48 offen sc1 lds
    s_add_u32 m0, s41, 66560
    s_add_u32 s48, s43, 73728
    buffer_load_dwordx4 v113, s[8:11], s48 offen sc1 lds
    s_add_u32 m0, s41, 67584
    s_add_u32 s48, s43, 139264
    buffer_load_dwordx4 v114, s[8:11], s48 offen sc1 lds
    s_add_u32 m0, s41, 68608
    s_add_u32 s48, s43, 204800
    buffer_load_dwordx4 v115, s[8:11], s48 offen sc1 lds
    s_add_u32 m0, s41, 69632
    s_add_u32 s48, s43, 270336
    buffer_load_dwordx4 v112, s[8:11], s48 offen sc1 lds
    s_add_u32 m0, s41, 70656
    s_add_u32 s48, s43, 335872
    buffer_load_dwordx4 v113, s[8:11], s48 offen sc1 lds
    s_add_u32 m0, s41, 71680
    s_add_u32 s48, s43, 401408
    buffer_load_dwordx4 v114, s[8:11], s48 offen sc1 lds
    s_add_u32 m0, s41, 72704
    s_add_u32 s48, s43, 466944
    buffer_load_dwordx4 v115, s[8:11], s48 offen sc1 lds
r3_loop_61:
    s_cmp_lg_u32 s30, 1
    s_cselect_b32 s32, s31, 0
    ds_read_b128 v[80:83], v3 offset:0
    ds_read_b128 v[84:87], v3 offset:16384
    ds_read_b128 v[88:91], v3 offset:32768
    ds_read_b128 v[92:95], v3 offset:49152
    ds_read_b128 v[96:99], v0 offset:0
    ds_read_b128 v[100:103], v0 offset:16384
    ds_read_b128 v[104:107], v0 offset:32768
    ds_read_b128 v[108:111], v0 offset:49152
    ds_read_b128 v[240:243], v2 offset:0
    ds_read_b128 v[244:247], v2 offset:4096
    ds_read_b128 v[248:251], v2 offset:1024
    ds_read_b128 v[252:255], v2 offset:5120
    s_waitcnt lgkmcnt(4)
    s_cmp_eq_u32 s32, 0
    s_cbranch_scc1 r3_z_63
    v_mov_b32 v96, 0
    v_mov_b32 v97, 0
    v_mov_b32 v98, 0
    v_mov_b32 v99, 0
    v_mov_b32 v100, 0
    v_mov_b32 v101, 0
    v_mov_b32 v102, 0
    v_mov_b32 v103, 0
    v_mov_b32 v104, 0
    v_mov_b32 v105, 0
    v_mov_b32 v106, 0
    v_mov_b32 v107, 0
    v_mov_b32 v108, 0
    v_mov_b32 v109, 0
    v_mov_b32 v110, 0
    v_mov_b32 v111, 0
    s_nop 1
r3_z_63:
    v_mfma_f32_32x32x16_bf16 v[176:191], v[80:83], v[8:11], 0
    v_mfma_f32_32x32x16_bf16 v[208:223], v[96:99], v[8:11], 0
    v_mfma_f32_32x32x16_bf16 v[176:191], v[84:87], v[12:15], v[176:191]
    v_mfma_f32_32x32x16_bf16 v[208:223], v[100:103], v[12:15], v[208:223]
    v_mfma_f32_32x32x16_bf16 v[176:191], v[96:99], v[16:19], v[176:191]
    v_mfma_f32_32x32x16_bf16 v[208:223], v[80:83], v[24:27], v[208:223]
    v_mfma_f32_32x32x16_bf16 v[176:191], v[100:103], v[20:23], v[176:191]
    v_mfma_f32_32x32x16_bf16 v[208:223], v[84:87], v[28:31], v[208:223]
    v_mfma_f32_32x32x16_bf16 v[192:207], v[88:91], v[8:11], 0
    v_mfma_f32_32x32x16_bf16 v[224:239], v[104:107], v[8:11], 0
    v_mfma_f32_32x32x16_bf16 v[192:207], v[92:95], v[12:15], v[192:207]
    v_mfma_f32_32x32x16_bf16 v[224:239], v[108:111], v[12:15], v[224:239]
    v_mfma_f32_32x32x16_bf16 v[192:207], v[104:107], v[16:19], v[192:207]
    v_mfma_f32_32x32x16_bf16 v[224:239], v[88:91], v[24:27], v[224:239]
    v_mfma_f32_32x32x16_bf16 v[192:207], v[108:111], v[20:23], v[192:207]
    v_mfma_f32_32x32x16_bf16 v[224:239], v[92:95], v[28:31], v[224:239]
    s_nop 3
    s_waitcnt lgkmcnt(2)
    v_mul_f32 v4, v176, v240
    v_mul_f32 v5, v177, v241
    v_mul_f32 v6, v178, v242
    v_mul_f32 v7, v179, v243
    v_mul_f32 v176, v176, v244
    v_mul_f32 v177, v177, v245
    v_mul_f32 v178, v178, v246
    v_mul_f32 v179, v179, v247
    v_fma_f32 v4, -v208, v244, v4
    v_fma_f32 v5, -v209, v245, v5
    v_fma_f32 v6, -v210, v246, v6
    v_fma_f32 v7, -v211, v247, v7
    v_fma_f32 v208, v208, v240, v176
    v_fma_f32 v209, v209, v241, v177
    v_fma_f32 v210, v210, v242, v178
    v_fma_f32 v211, v211, v243, v179
    v_cvt_pk_bf16_f32 v112, v4, v6
    v_cvt_pk_bf16_f32 v120, v5, v7
    v_cvt_pk_bf16_f32 v128, v208, v210
    v_cvt_pk_bf16_f32 v136, v209, v211
    ds_read_b128 v[240:243], v2 offset:2048
    ds_read_b128 v[244:247], v2 offset:6144
    s_waitcnt lgkmcnt(2)
    v_mul_f32 v4, v180, v248
    v_mul_f32 v5, v181, v249
    v_mul_f32 v6, v182, v250
    v_mul_f32 v7, v183, v251
    v_mul_f32 v180, v180, v252
    v_mul_f32 v181, v181, v253
    v_mul_f32 v182, v182, v254
    v_mul_f32 v183, v183, v255
    v_fma_f32 v4, -v212, v252, v4
    v_fma_f32 v5, -v213, v253, v5
    v_fma_f32 v6, -v214, v254, v6
    v_fma_f32 v7, -v215, v255, v7
    v_fma_f32 v212, v212, v248, v180
    v_fma_f32 v213, v213, v249, v181
    v_fma_f32 v214, v214, v250, v182
    v_fma_f32 v215, v215, v251, v183
    v_cvt_pk_bf16_f32 v113, v4, v6
    v_cvt_pk_bf16_f32 v121, v5, v7
    v_cvt_pk_bf16_f32 v129, v212, v214
    v_cvt_pk_bf16_f32 v137, v213, v215
    ds_read_b128 v[248:251], v2 offset:3072
    ds_read_b128 v[252:255], v2 offset:7168
    s_waitcnt lgkmcnt(2)
    v_mul_f32 v4, v184, v240
    v_mul_f32 v5, v185, v241
    v_mul_f32 v6, v186, v242
    v_mul_f32 v7, v187, v243
    v_mul_f32 v184, v184, v244
    v_mul_f32 v185, v185, v245
    v_mul_f32 v186, v186, v246
    v_mul_f32 v187, v187, v247
    v_fma_f32 v4, -v216, v244, v4
    v_fma_f32 v5, -v217, v245, v5
    v_fma_f32 v6, -v218, v246, v6
    v_fma_f32 v7, -v219, v247, v7
    v_fma_f32 v216, v216, v240, v184
    v_fma_f32 v217, v217, v241, v185
    v_fma_f32 v218, v218, v242, v186
    v_fma_f32 v219, v219, v243, v187
    v_cvt_pk_bf16_f32 v114, v4, v6
    v_cvt_pk_bf16_f32 v122, v5, v7
    v_cvt_pk_bf16_f32 v130, v216, v218
    v_cvt_pk_bf16_f32 v138, v217, v219
    ds_read_b128 v[240:243], v2 offset:8192
    ds_read_b128 v[244:247], v2 offset:12288
    s_waitcnt lgkmcnt(2)
    v_mul_f32 v4, v188, v248
    v_mul_f32 v5, v189, v249
    v_mul_f32 v6, v190, v250
    v_mul_f32 v7, v191, v251
    v_mul_f32 v188, v188, v252
    v_mul_f32 v189, v189, v253
    v_mul_f32 v190, v190, v254
    v_mul_f32 v191, v191, v255
    v_fma_f32 v4, -v220, v252, v4
    v_fma_f32 v5, -v221, v253, v5
    v_fma_f32 v6, -v222, v254, v6
    v_fma_f32 v7, -v223, v255, v7
    v_fma_f32 v220, v220, v248, v188
    v_fma_f32 v221, v221, v249, v189
    v_fma_f32 v222, v222, v250, v190
    v_fma_f32 v223, v223, v251, v191
    v_cvt_pk_bf16_f32 v115, v4, v6
    v_cvt_pk_bf16_f32 v123, v5, v7
    v_cvt_pk_bf16_f32 v131, v220, v222
    v_cvt_pk_bf16_f32 v139, v221, v223
    ds_read_b128 v[248:251], v2 offset:9216
    ds_read_b128 v[252:255], v2 offset:13312
    s_waitcnt lgkmcnt(2)
    v_mul_f32 v4, v192, v240
    v_mul_f32 v5, v193, v241
    v_mul_f32 v6, v194, v242
    v_mul_f32 v7, v195, v243
    v_mul_f32 v192, v192, v244
    v_mul_f32 v193, v193, v245
    v_mul_f32 v194, v194, v246
    v_mul_f32 v195, v195, v247
    v_fma_f32 v4, -v224, v244, v4
    v_fma_f32 v5, -v225, v245, v5
    v_fma_f32 v6, -v226, v246, v6
    v_fma_f32 v7, -v227, v247, v7
    v_fma_f32 v224, v224, v240, v192
    v_fma_f32 v225, v225, v241, v193
    v_fma_f32 v226, v226, v242, v194
    v_fma_f32 v227, v227, v243, v195
    v_cvt_pk_bf16_f32 v116, v4, v6
    v_cvt_pk_bf16_f32 v124, v5, v7
    v_cvt_pk_bf16_f32 v132, v224, v226
    v_cvt_pk_bf16_f32 v140, v225, v227
    ds_read_b128 v[240:243], v2 offset:10240
    ds_read_b128 v[244:247], v2 offset:14336
    s_waitcnt lgkmcnt(2)
    v_mul_f32 v4, v196, v248
    v_mul_f32 v5, v197, v249
    v_mul_f32 v6, v198, v250
    v_mul_f32 v7, v199, v251
    v_mul_f32 v196, v196, v252
    v_mul_f32 v197, v197, v253
    v_mul_f32 v198, v198, v254
    v_mul_f32 v199, v199, v255
    v_fma_f32 v4, -v228, v252, v4
    v_fma_f32 v5, -v229, v253, v5
    v_fma_f32 v6, -v230, v254, v6
    v_fma_f32 v7, -v231, v255, v7
    v_fma_f32 v228, v228, v248, v196
    v_fma_f32 v229, v229, v249, v197
    v_fma_f32 v230, v230, v250, v198
    v_fma_f32 v231, v231, v251, v199
    v_cvt_pk_bf16_f32 v117, v4, v6
    v_cvt_pk_bf16_f32 v125, v5, v7
    v_cvt_pk_bf16_f32 v133, v228, v230
    v_cvt_pk_bf16_f32 v141, v229, v231
    ds_read_b128 v[248:251], v2 offset:11264
    ds_read_b128 v[252:255], v2 offset:15360
    s_waitcnt lgkmcnt(2)
    v_mul_f32 v4, v200, v240
    v_mul_f32 v5, v201, v241
    v_mul_f32 v6, v202, v242
    v_mul_f32 v7, v203, v243
    v_mul_f32 v200, v200, v244
    v_mul_f32 v201, v201, v245
    v_mul_f32 v202, v202, v246
    v_mul_f32 v203, v203, v247
    v_fma_f32 v4, -v232, v244, v4
    v_fma_f32 v5, -v233, v245, v5
    v_fma_f32 v6, -v234, v246, v6
    v_fma_f32 v7, -v235, v247, v7
    v_fma_f32 v232, v232, v240, v200
    v_fma_f32 v233, v233, v241, v201
    v_fma_f32 v234, v234, v242, v202
    v_fma_f32 v235, v235, v243, v203
    v_cvt_pk_bf16_f32 v118, v4, v6
    v_cvt_pk_bf16_f32 v126, v5, v7
    v_cvt_pk_bf16_f32 v134, v232, v234
    v_cvt_pk_bf16_f32 v142, v233, v235
    s_waitcnt lgkmcnt(0)
    v_mul_f32 v4, v204, v248
    v_mul_f32 v5, v205, v249
    v_mul_f32 v6, v206, v250
    v_mul_f32 v7, v207, v251
    v_mul_f32 v204, v204, v252
    v_mul_f32 v205, v205, v253
    v_mul_f32 v206, v206, v254
    v_mul_f32 v207, v207, v255
    v_fma_f32 v4, -v236, v252, v4
    v_fma_f32 v5, -v237, v253, v5
    v_fma_f32 v6, -v238, v254, v6
    v_fma_f32 v7, -v239, v255, v7
    v_fma_f32 v236, v236, v248, v204
    v_fma_f32 v237, v237, v249, v205
    v_fma_f32 v238, v238, v250, v206
    v_fma_f32 v239, v239, v251, v207
    v_cvt_pk_bf16_f32 v119, v4, v6
    v_cvt_pk_bf16_f32 v127, v5, v7
    v_cvt_pk_bf16_f32 v135, v236, v238
    v_cvt_pk_bf16_f32 v143, v237, v239
    s_nop 1
    v_mfma_f32_32x32x16_bf16 v[176:191], v[32:35], v[112:115], 0
    v_mfma_f32_32x32x16_bf16 v[208:223], v[32:35], v[128:131], 0
    v_mfma_f32_32x32x16_bf16 v[176:191], v[36:39], v[116:119], v[176:191]
    v_mfma_f32_32x32x16_bf16 v[208:223], v[36:39], v[132:135], v[208:223]
    v_mfma_f32_32x32x16_bf16 v[176:191], v[40:43], v[128:131], v[176:191]
    v_mfma_f32_32x32x16_bf16 v[208:223], v[48:51], v[112:115], v[208:223]
    v_mfma_f32_32x32x16_bf16 v[176:191], v[44:47], v[132:135], v[176:191]
    v_mfma_f32_32x32x16_bf16 v[208:223], v[52:55], v[116:119], v[208:223]
    v_mfma_f32_32x32x16_bf16 v[192:207], v[56:59], v[120:123], 0
    v_mfma_f32_32x32x16_bf16 v[224:239], v[56:59], v[136:139], 0
    v_mfma_f32_32x32x16_bf16 v[192:207], v[60:63], v[124:127], v[192:207]
    v_mfma_f32_32x32x16_bf16 v[224:239], v[60:63], v[140:143], v[224:239]
    v_mfma_f32_32x32x16_bf16 v[192:207], v[64:67], v[136:139], v[192:207]
    v_mfma_f32_32x32x16_bf16 v[224:239], v[72:75], v[120:123], v[224:239]
    v_mfma_f32_32x32x16_bf16 v[192:207], v[68:71], v[140:143], v[192:207]
    v_mfma_f32_32x32x16_bf16 v[224:239], v[76:79], v[124:127], v[224:239]
    s_waitcnt vmcnt(0)
    s_cmp_lg_u32 s30, 0
    s_cbranch_scc1 r3_c0_64
    v_mov_b32 v4, 4096
    v_mov_b32 v5, 1
    s_mov_b64 exec, 1
    ds_add_u32 v4, v5
    s_mov_b64 exec, -1
r3_c0_64:
    v_lshlrev_b32 v240, 16, v144
    v_and_b32 v241, 0xffff0000, v144
    v_lshlrev_b32 v244, 16, v160
    v_and_b32 v245, 0xffff0000, v160
    v_lshlrev_b32 v242, 16, v145
    v_and_b32 v243, 0xffff0000, v145
    v_lshlrev_b32 v246, 16, v161
    v_and_b32 v247, 0xffff0000, v161
    v_lshlrev_b32 v248, 16, v146
    v_and_b32 v249, 0xffff0000, v146
    v_lshlrev_b32 v252, 16, v162
    v_and_b32 v253, 0xffff0000, v162
    v_lshlrev_b32 v250, 16, v147
    v_and_b32 v251, 0xffff0000, v147
    v_lshlrev_b32 v254, 16, v163
    v_and_b32 v255, 0xffff0000, v163
    v_add_f32 v176, v176, v192
    v_add_f32 v177, v177, v193
    v_add_f32 v178, v178, v194
    v_add_f32 v179, v179, v195
    v_add_f32 v180, v180, v196
    v_add_f32 v181, v181, v197
    v_add_f32 v182, v182, v198
    v_add_f32 v183, v183, v199
    v_add_f32 v184, v184, v200
    v_add_f32 v185, v185, v201
    v_add_f32 v186, v186, v202
    v_add_f32 v187, v187, v203
    v_add_f32 v188, v188, v204
    v_add_f32 v189, v189, v205
    v_add_f32 v190, v190, v206
    v_add_f32 v191, v191, v207
    v_fma_f32 v192, v192, -2.0, v176
    v_fma_f32 v193, v193, -2.0, v177
    v_fma_f32 v194, v194, -2.0, v178
    v_fma_f32 v195, v195, -2.0, v179
    v_fma_f32 v196, v196, -2.0, v180
    v_fma_f32 v197, v197, -2.0, v181
    v_fma_f32 v198, v198, -2.0, v182
    v_fma_f32 v199, v199, -2.0, v183
    v_fma_f32 v200, v200, -2.0, v184
    v_fma_f32 v201, v201, -2.0, v185
    v_fma_f32 v202, v202, -2.0, v186
    v_fma_f32 v203, v203, -2.0, v187
    v_fma_f32 v204, v204, -2.0, v188
    v_fma_f32 v205, v205, -2.0, v189
    v_fma_f32 v206, v206, -2.0, v190
    v_fma_f32 v207, v207, -2.0, v191
    v_add_f32 v208, v208, v224
    v_add_f32 v209, v209, v225
    v_add_f32 v210, v210, v226
    v_add_f32 v211, v211, v227
    v_add_f32 v212, v212, v228
    v_add_f32 v213, v213, v229
    v_add_f32 v214, v214, v230
    v_add_f32 v215, v215, v231
    v_add_f32 v216, v216, v232
    v_add_f32 v217, v217, v233
    v_add_f32 v218, v218, v234
    v_add_f32 v219, v219, v235
    v_add_f32 v220, v220, v236
    v_add_f32 v221, v221, v237
    v_add_f32 v222, v222, v238
    v_add_f32 v223, v223, v239
    v_fma_f32 v224, v224, -2.0, v208
    v_fma_f32 v225, v225, -2.0, v209
    v_fma_f32 v226, v226, -2.0, v210
    v_fma_f32 v227, v227, -2.0, v211
    v_fma_f32 v228, v228, -2.0, v212
    v_fma_f32 v229, v229, -2.0, v213
    v_fma_f32 v230, v230, -2.0, v214
    v_fma_f32 v231, v231, -2.0, v215
    v_fma_f32 v232, v232, -2.0, v216
    v_fma_f32 v233, v233, -2.0, v217
    v_fma_f32 v234, v234, -2.0, v218
    v_fma_f32 v235, v235, -2.0, v219
    v_fma_f32 v236, v236, -2.0, v220
    v_fma_f32 v237, v237, -2.0, v221
    v_fma_f32 v238, v238, -2.0, v222
    v_fma_f32 v239, v239, -2.0, v223
    v_mul_f32 v4, v176, v240
    v_mul_f32 v5, v177, v241
    v_mul_f32 v6, v178, v242
    v_mul_f32 v7, v179, v243
    v_mul_f32 v176, v176, v244
    v_mul_f32 v177, v177, v245
    v_mul_f32 v178, v178, v246
    v_mul_f32 v179, v179, v247
    v_fma_f32 v4, -v208, v244, v4
    v_fma_f32 v5, -v209, v245, v5
    v_fma_f32 v6, -v210, v246, v6
    v_fma_f32 v7, -v211, v247, v7
    v_fma_f32 v208, v208, v240, v176
    v_fma_f32 v209, v209, v241, v177
    v_fma_f32 v210, v210, v242, v178
    v_fma_f32 v211, v211, v243, v179
    v_cvt_pk_bf16_f32 v112, v4, v6
    v_cvt_pk_bf16_f32 v120, v5, v7
    v_cvt_pk_bf16_f32 v128, v208, v210
    v_cvt_pk_bf16_f32 v136, v209, v211
    v_lshlrev_b32 v240, 16, v148
    v_and_b32 v241, 0xffff0000, v148
    v_lshlrev_b32 v244, 16, v164
    v_and_b32 v245, 0xffff0000, v164
    v_lshlrev_b32 v242, 16, v149
    v_and_b32 v243, 0xffff0000, v149
    v_lshlrev_b32 v246, 16, v165
    v_and_b32 v247, 0xffff0000, v165
    v_mul_f32 v4, v180, v248
    v_mul_f32 v5, v181, v249
    v_mul_f32 v6, v182, v250
    v_mul_f32 v7, v183, v251
    v_mul_f32 v180, v180, v252
    v_mul_f32 v181, v181, v253
    v_mul_f32 v182, v182, v254
    v_mul_f32 v183, v183, v255
    v_fma_f32 v4, -v212, v252, v4
    v_fma_f32 v5, -v213, v253, v5
    v_fma_f32 v6, -v214, v254, v6
    v_fma_f32 v7, -v215, v255, v7
    v_fma_f32 v212, v212, v248, v180
    v_fma_f32 v213, v213, v249, v181
    v_fma_f32 v214, v214, v250, v182
    v_fma_f32 v215, v215, v251, v183
    v_cvt_pk_bf16_f32 v113, v4, v6
    v_cvt_pk_bf16_f32 v121, v5, v7
    v_cvt_pk_bf16_f32 v129, v212, v214
    v_cvt_pk_bf16_f32 v137, v213, v215
    v_lshlrev_b32 v248, 16, v150
    v_and_b32 v249, 0xffff0000, v150
    v_lshlrev_b32 v252, 16, v166
    v_and_b32 v253, 0xffff0000, v166
    v_lshlrev_b32 v250, 16, v151
    v_and_b32 v251, 0xffff0000, v151
    v_lshlrev_b32 v254, 16, v167
    v_and_b32 v255, 0xffff0000, v167
    v_mul_f32 v4, v184, v240
    v_mul_f32 v5, v185, v241
    v_mul_f32 v6, v186, v242
    v_mul_f32 v7, v187, v243
    v_mul_f32 v184, v184, v244
    v_mul_f32 v185, v185, v245
    v_mul_f32 v186, v186, v246
    v_mul_f32 v187, v187, v247
    v_fma_f32 v4, -v216, v244, v4
    v_fma_f32 v5, -v217, v245, v5
    v_fma_f32 v6, -v218, v246, v6
    v_fma_f32 v7, -v219, v247, v7
    v_fma_f32 v216, v216, v240, v184
    v_fma_f32 v217, v217, v241, v185
    v_fma_f32 v218, v218, v242, v186
    v_fma_f32 v219, v219, v243, v187
    v_cvt_pk_bf16_f32 v114, v4, v6
    v_cvt_pk_bf16_f32 v122, v5, v7
    v_cvt_pk_bf16_f32 v130, v216, v218
    v_cvt_pk_bf16_f32 v138, v217, v219
    v_lshlrev_b32 v240, 16, v152
    v_and_b32 v241, 0xffff0000, v152
    v_lshlrev_b32 v244, 16, v168
    v_and_b32 v245, 0xffff0000, v168
    v_lshlrev_b32 v242, 16, v153
    v_and_b32 v243, 0xffff0000, v153
    v_lshlrev_b32 v246, 16, v169
    v_and_b32 v247, 0xffff0000, v169
    v_mul_f32 v4, v188, v248
    v_mul_f32 v5, v189, v249
    v_mul_f32 v6, v190, v250
    v_mul_f32 v7, v191, v251
    v_mul_f32 v188, v188, v252
    v_mul_f32 v189, v189, v253
    v_mul_f32 v190, v190, v254
    v_mul_f32 v191, v191, v255
    v_fma_f32 v4, -v220, v252, v4
    v_fma_f32 v5, -v221, v253, v5
    v_fma_f32 v6, -v222, v254, v6
    v_fma_f32 v7, -v223, v255, v7
    v_fma_f32 v220, v220, v248, v188
    v_fma_f32 v221, v221, v249, v189
    v_fma_f32 v222, v222, v250, v190
    v_fma_f32 v223, v223, v251, v191
    v_cvt_pk_bf16_f32 v115, v4, v6
    v_cvt_pk_bf16_f32 v123, v5, v7
    v_cvt_pk_bf16_f32 v131, v220, v222
    v_cvt_pk_bf16_f32 v139, v221, v223
    v_lshlrev_b32 v248, 16, v154
    v_and_b32 v249, 0xffff0000, v154
    v_lshlrev_b32 v252, 16, v170
    v_and_b32 v253, 0xffff0000, v170
    v_lshlrev_b32 v250, 16, v155
    v_and_b32 v251, 0xffff0000, v155
    v_lshlrev_b32 v254, 16, v171
    v_and_b32 v255, 0xffff0000, v171
    v_mul_f32 v4, v192, v240
    v_mul_f32 v5, v193, v241
    v_mul_f32 v6, v194, v242
    v_mul_f32 v7, v195, v243
    v_mul_f32 v192, v192, v244
    v_mul_f32 v193, v193, v245
    v_mul_f32 v194, v194, v246
    v_mul_f32 v195, v195, v247
    v_fma_f32 v4, -v224, v244, v4
    v_fma_f32 v5, -v225, v245, v5
    v_fma_f32 v6, -v226, v246, v6
    v_fma_f32 v7, -v227, v247, v7
    v_fma_f32 v224, v224, v240, v192
    v_fma_f32 v225, v225, v241, v193
    v_fma_f32 v226, v226, v242, v194
    v_fma_f32 v227, v227, v243, v195
    v_cvt_pk_bf16_f32 v116, v4, v6
    v_cvt_pk_bf16_f32 v124, v5, v7
    v_cvt_pk_bf16_f32 v132, v224, v226
    v_cvt_pk_bf16_f32 v140, v225, v227
    v_lshlrev_b32 v240, 16, v156
    v_and_b32 v241, 0xffff0000, v156
    v_lshlrev_b32 v244, 16, v172
    v_and_b32 v245, 0xffff0000, v172
    v_lshlrev_b32 v242, 16, v157
    v_and_b32 v243, 0xffff0000, v157
    v_lshlrev_b32 v246, 16, v173
    v_and_b32 v247, 0xffff0000, v173
    v_mul_f32 v4, v196, v248
    v_mul_f32 v5, v197, v249
    v_mul_f32 v6, v198, v250
    v_mul_f32 v7, v199, v251
    v_mul_f32 v196, v196, v252
    v_mul_f32 v197, v197, v253
    v_mul_f32 v198, v198, v254
    v_mul_f32 v199, v199, v255
    v_fma_f32 v4, -v228, v252, v4
    v_fma_f32 v5, -v229, v253, v5
    v_fma_f32 v6, -v230, v254, v6
    v_fma_f32 v7, -v231, v255, v7
    v_fma_f32 v228, v228, v248, v196
    v_fma_f32 v229, v229, v249, v197
    v_fma_f32 v230, v230, v250, v198
    v_fma_f32 v231, v231, v251, v199
    v_cvt_pk_bf16_f32 v117, v4, v6
    v_cvt_pk_bf16_f32 v125, v5, v7
    v_cvt_pk_bf16_f32 v133, v228, v230
    v_cvt_pk_bf16_f32 v141, v229, v231
    v_lshlrev_b32 v248, 16, v158
    v_and_b32 v249, 0xffff0000, v158
    v_lshlrev_b32 v252, 16, v174
    v_and_b32 v253, 0xffff0000, v174
    v_lshlrev_b32 v250, 16, v159
    v_and_b32 v251, 0xffff0000, v159
    v_lshlrev_b32 v254, 16, v175
    v_and_b32 v255, 0xffff0000, v175
    v_mul_f32 v4, v200, v240
    v_mul_f32 v5, v201, v241
    v_mul_f32 v6, v202, v242
    v_mul_f32 v7, v203, v243
    v_mul_f32 v200, v200, v244
    v_mul_f32 v201, v201, v245
    v_mul_f32 v202, v202, v246
    v_mul_f32 v203, v203, v247
    v_fma_f32 v4, -v232, v244, v4
    v_fma_f32 v5, -v233, v245, v5
    v_fma_f32 v6, -v234, v246, v6
    v_fma_f32 v7, -v235, v247, v7
    v_fma_f32 v232, v232, v240, v200
    v_fma_f32 v233, v233, v241, v201
    v_fma_f32 v234, v234, v242, v202
    v_fma_f32 v235, v235, v243, v203
    v_cvt_pk_bf16_f32 v118, v4, v6
    v_cvt_pk_bf16_f32 v126, v5, v7
    v_cvt_pk_bf16_f32 v134, v232, v234
    v_cvt_pk_bf16_f32 v142, v233, v235
    v_mul_f32 v4, v204, v248
    v_mul_f32 v5, v205, v249
    v_mul_f32 v6, v206, v250
    v_mul_f32 v7, v207, v251
    v_mul_f32 v204, v204, v252
    v_mul_f32 v205, v205, v253
    v_mul_f32 v206, v206, v254
    v_mul_f32 v207, v207, v255
    v_fma_f32 v4, -v236, v252, v4
    v_fma_f32 v5, -v237, v253, v5
    v_fma_f32 v6, -v238, v254, v6
    v_fma_f32 v7, -v239, v255, v7
    v_fma_f32 v236, v236, v248, v204
    v_fma_f32 v237, v237, v249, v205
    v_fma_f32 v238, v238, v250, v206
    v_fma_f32 v239, v239, v251, v207
    v_cvt_pk_bf16_f32 v119, v4, v6
    v_cvt_pk_bf16_f32 v127, v5, v7
    v_cvt_pk_bf16_f32 v135, v236, v238
    v_cvt_pk_bf16_f32 v143, v237, v239
    ds_read_b128 v[240:243], v2 offset:16384
    ds_read_b128 v[244:247], v2 offset:20480
    ds_read_b128 v[248:251], v2 offset:17408
    ds_read_b128 v[252:255], v2 offset:21504
    v_mfma_f32_32x32x16_bf16 v[176:191], v[112:115], v[32:35], 0
    v_mfma_f32_32x32x16_bf16 v[208:223], v[128:131], v[32:35], 0
    v_mfma_f32_32x32x16_bf16 v[176:191], v[116:119], v[36:39], v[176:191]
    v_mfma_f32_32x32x16_bf16 v[208:223], v[132:135], v[36:39], v[208:223]
    v_mfma_f32_32x32x16_bf16 v[176:191], v[128:131], v[48:51], v[176:191]
    v_mfma_f32_32x32x16_bf16 v[208:223], v[112:115], v[40:43], v[208:223]
    v_mfma_f32_32x32x16_bf16 v[176:191], v[132:135], v[52:55], v[176:191]
    v_mfma_f32_32x32x16_bf16 v[208:223], v[116:119], v[44:47], v[208:223]
    v_mfma_f32_32x32x16_bf16 v[192:207], v[120:123], v[56:59], 0
    v_mfma_f32_32x32x16_bf16 v[224:239], v[136:139], v[56:59], 0
    v_mfma_f32_32x32x16_bf16 v[192:207], v[124:127], v[60:63], v[192:207]
    v_mfma_f32_32x32x16_bf16 v[224:239], v[140:143], v[60:63], v[224:239]
    v_mfma_f32_32x32x16_bf16 v[192:207], v[136:139], v[72:75], v[192:207]
    v_mfma_f32_32x32x16_bf16 v[224:239], v[120:123], v[64:67], v[224:239]
    v_mfma_f32_32x32x16_bf16 v[192:207], v[140:143], v[76:79], v[192:207]
    v_mfma_f32_32x32x16_bf16 v[224:239], v[124:127], v[68:71], v[224:239]
    s_nop 7
    s_nop 3
    v_add_f32 v176, v176, v192
    v_add_f32 v177, v177, v193
    v_add_f32 v178, v178, v194
    v_add_f32 v179, v179, v195
    v_add_f32 v180, v180, v196
    v_add_f32 v181, v181, v197
    v_add_f32 v182, v182, v198
    v_add_f32 v183, v183, v199
    v_add_f32 v184, v184, v200
    v_add_f32 v185, v185, v201
    v_add_f32 v186, v186, v202
    v_add_f32 v187, v187, v203
    v_add_f32 v188, v188, v204
    v_add_f32 v189, v189, v205
    v_add_f32 v190, v190, v206
    v_add_f32 v191, v191, v207
    v_fma_f32 v192, v192, -2.0, v176
    v_fma_f32 v193, v193, -2.0, v177
    v_fma_f32 v194, v194, -2.0, v178
    v_fma_f32 v195, v195, -2.0, v179
    v_fma_f32 v196, v196, -2.0, v180
    v_fma_f32 v197, v197, -2.0, v181
    v_fma_f32 v198, v198, -2.0, v182
    v_fma_f32 v199, v199, -2.0, v183
    v_fma_f32 v200, v200, -2.0, v184
    v_fma_f32 v201, v201, -2.0, v185
    v_fma_f32 v202, v202, -2.0, v186
    v_fma_f32 v203, v203, -2.0, v187
    v_fma_f32 v204, v204, -2.0, v188
    v_fma_f32 v205, v205, -2.0, v189
    v_fma_f32 v206, v206, -2.0, v190
    v_fma_f32 v207, v207, -2.0, v191
    v_add_f32 v208, v208, v224
    v_add_f32 v209, v209, v225
    v_add_f32 v210, v210, v226
    v_add_f32 v211, v211, v227
    v_add_f32 v212, v212, v228
    v_add_f32 v213, v213, v229
    v_add_f32 v214, v214, v230
    v_add_f32 v215, v215, v231
    v_add_f32 v216, v216, v232
    v_add_f32 v217, v217, v233
    v_add_f32 v218, v218, v234
    v_add_f32 v219, v219, v235
    v_add_f32 v220, v220, v236
    v_add_f32 v221, v221, v237
    v_add_f32 v222, v222, v238
    v_add_f32 v223, v223, v239
    v_fma_f32 v224, v224, -2.0, v208
    v_fma_f32 v225, v225, -2.0, v209
    v_fma_f32 v226, v226, -2.0, v210
    v_fma_f32 v227, v227, -2.0, v211
    v_fma_f32 v228, v228, -2.0, v212
    v_fma_f32 v229, v229, -2.0, v213
    v_fma_f32 v230, v230, -2.0, v214
    v_fma_f32 v231, v231, -2.0, v215
    v_fma_f32 v232, v232, -2.0, v216
    v_fma_f32 v233, v233, -2.0, v217
    v_fma_f32 v234, v234, -2.0, v218
    v_fma_f32 v235, v235, -2.0, v219
    v_fma_f32 v236, v236, -2.0, v220
    v_fma_f32 v237, v237, -2.0, v221
    v_fma_f32 v238, v238, -2.0, v222
    v_fma_f32 v239, v239, -2.0, v223
    s_waitcnt lgkmcnt(2)
    v_mul_f32 v4, v176, v240
    v_mul_f32 v5, v177, v241
    v_mul_f32 v6, v178, v242
    v_mul_f32 v7, v179, v243
    v_mul_f32 v176, v176, v244
    v_mul_f32 v177, v177, v245
    v_mul_f32 v178, v178, v246
    v_mul_f32 v179, v179, v247
    v_fma_f32 v4, -v208, v244, v4
    v_fma_f32 v5, -v209, v245, v5
    v_fma_f32 v6, -v210, v246, v6
    v_fma_f32 v7, -v211, v247, v7
    v_fma_f32 v208, v208, v240, v176
    v_fma_f32 v209, v209, v241, v177
    v_fma_f32 v210, v210, v242, v178
    v_fma_f32 v211, v211, v243, v179
    v_cvt_pk_bf16_f32 v144, v4, v5
    v_cvt_pk_bf16_f32 v145, v6, v7
    v_cvt_pk_bf16_f32 v160, v208, v209
    v_cvt_pk_bf16_f32 v161, v210, v211
    ds_read_b128 v[240:243], v2 offset:18432
    ds_read_b128 v[244:247], v2 offset:22528
    s_waitcnt lgkmcnt(2)
    v_mul_f32 v4, v180, v248
    v_mul_f32 v5, v181, v249
    v_mul_f32 v6, v182, v250
    v_mul_f32 v7, v183, v251
    v_mul_f32 v180, v180, v252
    v_mul_f32 v181, v181, v253
    v_mul_f32 v182, v182, v254
    v_mul_f32 v183, v183, v255
    v_fma_f32 v4, -v212, v252, v4
    v_fma_f32 v5, -v213, v253, v5
    v_fma_f32 v6, -v214, v254, v6
    v_fma_f32 v7, -v215, v255, v7
    v_fma_f32 v212, v212, v248, v180
    v_fma_f32 v213, v213, v249, v181
    v_fma_f32 v214, v214, v250, v182
    v_fma_f32 v215, v215, v251, v183
    v_cvt_pk_bf16_f32 v146, v4, v5
    v_cvt_pk_bf16_f32 v147, v6, v7
    v_cvt_pk_bf16_f32 v162, v212, v213
    v_cvt_pk_bf16_f32 v163, v214, v215
    ds_read_b128 v[248:251], v2 offset:19456
    ds_read_b128 v[252:255], v2 offset:23552
    s_waitcnt lgkmcnt(2)
    v_mul_f32 v4, v184, v240
    v_mul_f32 v5, v185, v241
    v_mul_f32 v6, v186, v242
    v_mul_f32 v7, v187, v243
    v_mul_f32 v184, v184, v244
    v_mul_f32 v185, v185, v245
    v_mul_f32 v186, v186, v246
    v_mul_f32 v187, v187, v247
    v_fma_f32 v4, -v216, v244, v4
    v_fma_f32 v5, -v217, v245, v5
    v_fma_f32 v6, -v218, v246, v6
    v_fma_f32 v7, -v219, v247, v7
    v_fma_f32 v216, v216, v240, v184
    v_fma_f32 v217, v217, v241, v185
    v_fma_f32 v218, v218, v242, v186
    v_fma_f32 v219, v219, v243, v187
    v_cvt_pk_bf16_f32 v148, v4, v5
    v_cvt_pk_bf16_f32 v149, v6, v7
    v_cvt_pk_bf16_f32 v164, v216, v217
    v_cvt_pk_bf16_f32 v165, v218, v219
    ds_read_b128 v[240:243], v2 offset:24576
    ds_read_b128 v[244:247], v2 offset:28672
    s_waitcnt lgkmcnt(2)
    v_mul_f32 v4, v188, v248
    v_mul_f32 v5, v189, v249
    v_mul_f32 v6, v190, v250
    v_mul_f32 v7, v191, v251
    v_mul_f32 v188, v188, v252
    v_mul_f32 v189, v189, v253
    v_mul_f32 v190, v190, v254
    v_mul_f32 v191, v191, v255
    v_fma_f32 v4, -v220, v252, v4
    v_fma_f32 v5, -v221, v253, v5
    v_fma_f32 v6, -v222, v254, v6
    v_fma_f32 v7, -v223, v255, v7
    v_fma_f32 v220, v220, v248, v188
    v_fma_f32 v221, v221, v249, v189
    v_fma_f32 v222, v222, v250, v190
    v_fma_f32 v223, v223, v251, v191
    v_cvt_pk_bf16_f32 v150, v4, v5
    v_cvt_pk_bf16_f32 v151, v6, v7
    v_cvt_pk_bf16_f32 v166, v220, v221
    v_cvt_pk_bf16_f32 v167, v222, v223
    ds_read_b128 v[248:251], v2 offset:25600
    ds_read_b128 v[252:255], v2 offset:29696
    s_waitcnt lgkmcnt(2)
    v_mul_f32 v4, v192, v240
    v_mul_f32 v5, v193, v241
    v_mul_f32 v6, v194, v242
    v_mul_f32 v7, v195, v243
    v_mul_f32 v192, v192, v244
    v_mul_f32 v193, v193, v245
    v_mul_f32 v194, v194, v246
    v_mul_f32 v195, v195, v247
    v_fma_f32 v4, -v224, v244, v4
    v_fma_f32 v5, -v225, v245, v5
    v_fma_f32 v6, -v226, v246, v6
    v_fma_f32 v7, -v227, v247, v7
    v_fma_f32 v224, v224, v240, v192
    v_fma_f32 v225, v225, v241, v193
    v_fma_f32 v226, v226, v242, v194
    v_fma_f32 v227, v227, v243, v195
    v_cvt_pk_bf16_f32 v152, v4, v5
    v_cvt_pk_bf16_f32 v153, v6, v7
    v_cvt_pk_bf16_f32 v168, v224, v225
    v_cvt_pk_bf16_f32 v169, v226, v227
    ds_read_b128 v[240:243], v2 offset:26624
    ds_read_b128 v[244:247], v2 offset:30720
    s_waitcnt lgkmcnt(2)
    v_mul_f32 v4, v196, v248
    v_mul_f32 v5, v197, v249
    v_mul_f32 v6, v198, v250
    v_mul_f32 v7, v199, v251
    v_mul_f32 v196, v196, v252
    v_mul_f32 v197, v197, v253
    v_mul_f32 v198, v198, v254
    v_mul_f32 v199, v199, v255
    v_fma_f32 v4, -v228, v252, v4
    v_fma_f32 v5, -v229, v253, v5
    v_fma_f32 v6, -v230, v254, v6
    v_fma_f32 v7, -v231, v255, v7
    v_fma_f32 v228, v228, v248, v196
    v_fma_f32 v229, v229, v249, v197
    v_fma_f32 v230, v230, v250, v198
    v_fma_f32 v231, v231, v251, v199
    v_cvt_pk_bf16_f32 v154, v4, v5
    v_cvt_pk_bf16_f32 v155, v6, v7
    v_cvt_pk_bf16_f32 v170, v228, v229
    v_cvt_pk_bf16_f32 v171, v230, v231
    ds_read_b128 v[248:251], v2 offset:27648
    ds_read_b128 v[252:255], v2 offset:31744
    s_waitcnt lgkmcnt(2)
    v_mul_f32 v4, v200, v240
    v_mul_f32 v5, v201, v241
    v_mul_f32 v6, v202, v242
    v_mul_f32 v7, v203, v243
    v_mul_f32 v200, v200, v244
    v_mul_f32 v201, v201, v245
    v_mul_f32 v202, v202, v246
    v_mul_f32 v203, v203, v247
    v_fma_f32 v4, -v232, v244, v4
    v_fma_f32 v5, -v233, v245, v5
    v_fma_f32 v6, -v234, v246, v6
    v_fma_f32 v7, -v235, v247, v7
    v_fma_f32 v232, v232, v240, v200
    v_fma_f32 v233, v233, v241, v201
    v_fma_f32 v234, v234, v242, v202
    v_fma_f32 v235, v235, v243, v203
    v_cvt_pk_bf16_f32 v156, v4, v5
    v_cvt_pk_bf16_f32 v157, v6, v7
    v_cvt_pk_bf16_f32 v172, v232, v233
    v_cvt_pk_bf16_f32 v173, v234, v235
    s_waitcnt lgkmcnt(0)
    v_mul_f32 v4, v204, v248
    v_mul_f32 v5, v205, v249
    v_mul_f32 v6, v206, v250
    v_mul_f32 v7, v207, v251
    v_mul_f32 v204, v204, v252
    v_mul_f32 v205, v205, v253
    v_mul_f32 v206, v206, v254
    v_mul_f32 v207, v207, v255
    v_fma_f32 v4, -v236, v252, v4
    v_fma_f32 v5, -v237, v253, v5
    v_fma_f32 v6, -v238, v254, v6
    v_fma_f32 v7, -v239, v255, v7
    v_fma_f32 v236, v236, v248, v204
    v_fma_f32 v237, v237, v249, v205
    v_fma_f32 v238, v238, v250, v206
    v_fma_f32 v239, v239, v251, v207
    v_cvt_pk_bf16_f32 v158, v4, v5
    v_cvt_pk_bf16_f32 v159, v6, v7
    v_cvt_pk_bf16_f32 v174, v236, v237
    v_cvt_pk_bf16_f32 v175, v238, v239
    s_nop 1
    v_mfma_f32_32x32x16_bf16 v[176:191], v[8:11], v[144:147], 0
    v_mfma_f32_32x32x16_bf16 v[208:223], v[8:11], v[160:163], 0
    v_mfma_f32_32x32x16_bf16 v[176:191], v[12:15], v[148:151], v[176:191]
    v_mfma_f32_32x32x16_bf16 v[208:223], v[12:15], v[164:167], v[208:223]
    v_mfma_f32_32x32x16_bf16 v[176:191], v[24:27], v[160:163], v[176:191]
    v_mfma_f32_32x32x16_bf16 v[208:223], v[16:19], v[144:147], v[208:223]
    v_mfma_f32_32x32x16_bf16 v[176:191], v[28:31], v[164:167], v[176:191]
    v_mfma_f32_32x32x16_bf16 v[208:223], v[20:23], v[148:151], v[208:223]
    v_mfma_f32_32x32x16_bf16 v[192:207], v[8:11], v[152:155], 0
    v_mfma_f32_32x32x16_bf16 v[224:239], v[8:11], v[168:171], 0
    v_mfma_f32_32x32x16_bf16 v[192:207], v[12:15], v[156:159], v[192:207]
    v_mfma_f32_32x32x16_bf16 v[224:239], v[12:15], v[172:175], v[224:239]
    v_mfma_f32_32x32x16_bf16 v[192:207], v[24:27], v[168:171], v[192:207]
    v_mfma_f32_32x32x16_bf16 v[224:239], v[16:19], v[152:155], v[224:239]
    v_mfma_f32_32x32x16_bf16 v[192:207], v[28:31], v[172:175], v[192:207]
    v_mfma_f32_32x32x16_bf16 v[224:239], v[20:23], v[156:159], v[224:239]
    s_add_u32 s34, s34, 2097152
    s_add_u32 s35, s35, 2097152
    buffer_load_dwordx4 v[144:147], v2, s[16:19], s34 offen offset:0 sc1
    buffer_load_dwordx4 v[148:151], v2, s[16:19], s34 offen offset:1024 sc1
    buffer_load_dwordx4 v[152:155], v2, s[16:19], s34 offen offset:2048 sc1
    buffer_load_dwordx4 v[156:159], v2, s[16:19], s34 offen offset:3072 sc1
    buffer_load_dwordx4 v[160:163], v2, s[16:19], s35 offen offset:0 sc1
    buffer_load_dwordx4 v[164:167], v2, s[16:19], s35 offen offset:1024 sc1
    buffer_load_dwordx4 v[168:171], v2, s[16:19], s35 offen offset:2048 sc1
    buffer_load_dwordx4 v[172:175], v2, s[16:19], s35 offen offset:3072 sc1
    v_cvt_pk_bf16_f32 v112, v176, v177
    v_cvt_pk_bf16_f32 v113, v178, v179
    v_cvt_pk_bf16_f32 v114, v180, v181
    v_cvt_pk_bf16_f32 v115, v182, v183
    v_cvt_pk_bf16_f32 v116, v184, v185
    v_cvt_pk_bf16_f32 v117, v186, v187
    v_cvt_pk_bf16_f32 v118, v188, v189
    v_cvt_pk_bf16_f32 v119, v190, v191
    v_cvt_pk_bf16_f32 v128, v208, v209
    v_cvt_pk_bf16_f32 v129, v210, v211
    v_cvt_pk_bf16_f32 v130, v212, v213
    v_cvt_pk_bf16_f32 v131, v214, v215
    v_cvt_pk_bf16_f32 v132, v216, v217
    v_cvt_pk_bf16_f32 v133, v218, v219
    v_cvt_pk_bf16_f32 v134, v220, v221
    v_cvt_pk_bf16_f32 v135, v222, v223
    s_nop 3
    v_cvt_pk_bf16_f32 v120, v192, v193
    v_cvt_pk_bf16_f32 v121, v194, v195
    v_cvt_pk_bf16_f32 v122, v196, v197
    v_cvt_pk_bf16_f32 v123, v198, v199
    v_cvt_pk_bf16_f32 v124, v200, v201
    v_cvt_pk_bf16_f32 v125, v202, v203
    v_cvt_pk_bf16_f32 v126, v204, v205
    v_cvt_pk_bf16_f32 v127, v206, v207
    v_cvt_pk_bf16_f32 v136, v224, v225
    v_cvt_pk_bf16_f32 v137, v226, v227
    v_cvt_pk_bf16_f32 v138, v228, v229
    v_cvt_pk_bf16_f32 v139, v230, v231
    v_cvt_pk_bf16_f32 v140, v232, v233
    v_cvt_pk_bf16_f32 v141, v234, v235
    v_cvt_pk_bf16_f32 v142, v236, v237
    v_cvt_pk_bf16_f32 v143, v238, v239
    s_cmp_eq_u32 s30, 2
    s_cbranch_scc1 r3_l512_65
    ds_write_b128 v3, v[112:115] offset:0
    ds_write_b128 v3, v[116:119] offset:16384
    ds_write_b128 v3, v[120:123] offset:32768
    ds_write_b128 v3, v[124:127] offset:49152
    s_cmp_eq_u32 s32, 1
    s_cbranch_scc1 r3_ni_66
    ds_write_b128 v0, v[128:131] offset:0
    ds_write_b128 v0, v[132:135] offset:16384
    ds_write_b128 v0, v[136:139] offset:32768
    ds_write_b128 v0, v[140:143] offset:49152
r3_ni_66:
    s_add_u32 s30, s30, 1
    s_cmp_lg_u32 s30, 1
    s_cbranch_scc1 r3_p1_67
    s_waitcnt lgkmcnt(0)
    v_mov_b32 v4, 4100
    v_mov_b32 v5, 1
    s_mov_b64 exec, 1
    ds_add_u32 v4, v5
    s_mov_b64 exec, -1
    v_mov_b32 v4, 4096
r3_cw_68:
    ds_read_b32 v5, v4
    s_waitcnt lgkmcnt(0)
    v_readfirstlane_b32 s48, v5
    s_nop 3
    s_and_b32 s48, s48, 15
    s_cmp_lt_u32 s48, 8
    s_cbranch_scc1 r3_cw_68
    v_add_u32 v3, 0x10000, v3
    v_add_u32 v0, 0x10000, v0
    s_branch r3_loop_61
r3_p1_67:
    s_waitcnt vmcnt(0)
    v_lshrrev_b32 v1, 4, v2
    v_add_u32 v240, s41, v2
    v_add_u32 v241, 0x10000, v240
    v_lshrrev_b32 v246, 4, v1
    v_and_b32 v247, 15, v1
    v_xor_b32 v247, v247, v246
    v_and_b32 v248, 1, v247
    v_lshrrev_b32 v247, 1, v247
    v_lshlrev_b32 v247, 4, v247
    v_lshl_add_u32 v247, v248, 13, v247
    v_lshl_add_u32 v242, v246, 14, v247
    v_xor_b32 v243, 32, v242
    v_xor_b32 v244, 64, v242
    v_xor_b32 v245, 96, v242
    s_lshl_b32 s48, s42, 7
    s_lshl_b32 s49, s40, 19
    s_add_u32 s48, s48, s49
    s_mov_b32 s50, s48
    s_cmp_ge_u32 s40, 4
    s_cbranch_scc1 r3_ya_69
    v_mov_b32 v4, 4100
r3_cw_70:
    ds_read_b32 v5, v4
    s_waitcnt lgkmcnt(0)
    v_readfirstlane_b32 s48, v5
    s_nop 3
    s_and_b32 s48, s48, 15
    s_cmp_lt_u32 s48, 8
    s_cbranch_scc1 r3_cw_70
    ds_read_b128 v[176:179], v240 offset:0
    ds_read_b128 v[180:183], v240 offset:1024
    ds_read_b128 v[184:187], v240 offset:2048
    ds_read_b128 v[188:191], v240 offset:3072
    ds_read_b128 v[192:195], v240 offset:4096
    ds_read_b128 v[196:199], v240 offset:5120
    ds_read_b128 v[200:203], v240 offset:6144
    ds_read_b128 v[204:207], v240 offset:7168
    s_add_u32 s49, s50, 0
    s_waitcnt lgkmcnt(7)
    buffer_store_dwordx4 v[176:179], v242, s[12:15], s49 offen sc1
    s_add_u32 s49, s50, 65536
    s_waitcnt lgkmcnt(6)
    buffer_store_dwordx4 v[180:183], v243, s[12:15], s49 offen sc1
    s_add_u32 s49, s50, 131072
    s_waitcnt lgkmcnt(5)
    buffer_store_dwordx4 v[184:187], v244, s[12:15], s49 offen sc1
    s_add_u32 s49, s50, 196608
    s_waitcnt lgkmcnt(4)
    buffer_store_dwordx4 v[188:191], v245, s[12:15], s49 offen sc1
    s_add_u32 s49, s50, 262144
    s_waitcnt lgkmcnt(3)
    buffer_store_dwordx4 v[192:195], v242, s[12:15], s49 offen sc1
    s_add_u32 s49, s50, 327680
    s_waitcnt lgkmcnt(2)
    buffer_store_dwordx4 v[196:199], v243, s[12:15], s49 offen sc1
    s_add_u32 s49, s50, 393216
    s_waitcnt lgkmcnt(1)
    buffer_store_dwordx4 v[200:203], v244, s[12:15], s49 offen sc1
    s_add_u32 s49, s50, 458752
    s_waitcnt lgkmcnt(0)
    buffer_store_dwordx4 v[204:207], v245, s[12:15], s49 offen sc1
    s_nop 1
    ds_read_b128 v[176:179], v240 offset:32768
    ds_read_b128 v[180:183], v240 offset:33792
    ds_read_b128 v[184:187], v240 offset:34816
    ds_read_b128 v[188:191], v240 offset:35840
    ds_read_b128 v[192:195], v240 offset:36864
    ds_read_b128 v[196:199], v240 offset:37888
    ds_read_b128 v[200:203], v240 offset:38912
    ds_read_b128 v[204:207], v240 offset:39936
    s_add_u32 s49, s50, 2097152
    s_waitcnt lgkmcnt(7)
    buffer_store_dwordx4 v[176:179], v242, s[12:15], s49 offen sc1
    s_add_u32 s49, s50, 2162688
    s_waitcnt lgkmcnt(6)
    buffer_store_dwordx4 v[180:183], v243, s[12:15], s49 offen sc1
    s_add_u32 s49, s50, 2228224
    s_waitcnt lgkmcnt(5)
    buffer_store_dwordx4 v[184:187], v244, s[12:15], s49 offen sc1
    s_add_u32 s49, s50, 2293760
    s_waitcnt lgkmcnt(4)
    buffer_store_dwordx4 v[188:191], v245, s[12:15], s49 offen sc1
    s_add_u32 s49, s50, 2359296
    s_waitcnt lgkmcnt(3)
    buffer_store_dwordx4 v[192:195], v242, s[12:15], s49 offen sc1
    s_add_u32 s49, s50, 2424832
    s_waitcnt lgkmcnt(2)
    buffer_store_dwordx4 v[196:199], v243, s[12:15], s49 offen sc1
    s_add_u32 s49, s50, 2490368
    s_waitcnt lgkmcnt(1)
    buffer_store_dwordx4 v[200:203], v244, s[12:15], s49 offen sc1
    s_add_u32 s49, s50, 2555904
    s_waitcnt lgkmcnt(0)
    buffer_store_dwordx4 v[204:207], v245, s[12:15], s49 offen sc1
r3_ya_69:
    s_waitcnt lgkmcnt(0)
    s_barrier
    ds_read_b128 v[176:179], v241 offset:0
    ds_read_b128 v[180:183], v241 offset:1024
    ds_read_b128 v[184:187], v241 offset:2048
    ds_read_b128 v[188:191], v241 offset:3072
    ds_read_b128 v[192:195], v241 offset:4096
    ds_read_b128 v[196:199], v241 offset:5120
    ds_read_b128 v[200:203], v241 offset:6144
    ds_read_b128 v[204:207], v241 offset:7168
    s_add_u32 s49, s50, 4096
    s_waitcnt lgkmcnt(7)
    buffer_store_dwordx4 v[176:179], v242, s[12:15], s49 offen sc1
    s_add_u32 s49, s50, 69632
    s_waitcnt lgkmcnt(6)
    buffer_store_dwordx4 v[180:183], v243, s[12:15], s49 offen sc1
    s_add_u32 s49, s50, 135168
    s_waitcnt lgkmcnt(5)
    buffer_store_dwordx4 v[184:187], v244, s[12:15], s49 offen sc1
    s_add_u32 s49, s50, 200704
    s_waitcnt lgkmcnt(4)
    buffer_store_dwordx4 v[188:191], v245, s[12:15], s49 offen sc1
    s_add_u32 s49, s50, 266240
    s_waitcnt lgkmcnt(3)
    buffer_store_dwordx4 v[192:195], v242, s[12:15], s49 offen sc1
    s_add_u32 s49, s50, 331776
    s_waitcnt lgkmcnt(2)
    buffer_store_dwordx4 v[196:199], v243, s[12:15], s49 offen sc1
    s_add_u32 s49, s50, 397312
    s_waitcnt lgkmcnt(1)
    buffer_store_dwordx4 v[200:203], v244, s[12:15], s49 offen sc1
    s_add_u32 s49, s50, 462848
    s_waitcnt lgkmcnt(0)
    buffer_store_dwordx4 v[204:207], v245, s[12:15], s49 offen sc1
    s_waitcnt vmcnt(0)
    s_barrier
    s_cmp_lg_u32 s40, 1
    s_cbranch_scc1 r3_zf1_71
    s_add_u32 s48, s42, 3840
    s_lshl_b32 s48, s48, 7
    v_mov_b32 v4, s90
    v_mov_b32 v5, s91
    v_mov_b32 v6, s48
    s_mov_b64 exec, 1
    global_store_dwordx2 v6, v[4:5], s[88:89] sc1
    s_mov_b64 exec, -1
r3_zf1_71:
    s_cmp_eq_u32 s31, 0
    s_cbranch_scc1 r3_fin_62
    v_subrev_u32 v3, 0x10000, v0
    s_branch r3_loop_61
r3_l512_65:
    s_add_u32 s12, s24, 0x4400000
    s_addc_u32 s13, s25, 0
    s_and_b32 s13, s13, 0xffff
    s_mov_b32 s14, 0x1000
    s_mov_b32 s15, 0x20000
    buffer_store_dwordx4 v[112:115], v2, s[12:15], 0 offen offset:0 sc1
    buffer_store_dwordx4 v[116:119], v2, s[12:15], 0 offen offset:1024 sc1
    buffer_store_dwordx4 v[120:123], v2, s[12:15], 0 offen offset:2048 sc1
    buffer_store_dwordx4 v[124:127], v2, s[12:15], 0 offen offset:3072 sc1
    s_waitcnt vmcnt(0)
    v_lshrrev_b32 v1, 4, v2
    s_mov_b32 s48, 495616
    v_mov_b32 v4, s90
    v_mov_b32 v5, s91
    v_mov_b32 v6, s48
    s_mov_b64 exec, 1
    global_store_dwordx2 v6, v[4:5], s[88:89] sc1
    s_mov_b64 exec, -1
r3_fin_62:
    s_barrier
    s_mov_b32 s30, s40
    s_mov_b32 s83, -1
    s_mov_b64 s[94:95], s[90:91]
    s_mov_b64 s[96:97], s[88:89]
    s_load_dwordx4 s[4:7], s[0:1], 48
    s_load_dwordx2 s[92:93], s[0:1], 0
    v_mov_b32 v192, v1
    s_and_b32 s26, s2, 7
    s_lshr_b32 s27, s2, 3
    s_and_b32 s33, s26, 1
    s_lshr_b32 s31, s26, 1
    s_lshl_b32 s31, s31, 2
    s_and_b32 s28, s27, 3
    s_add_u32 s31, s31, s28
    s_lshr_b32 s32, s27, 2
    s_lshr_b32 s38, s30, 2
    s_and_b32 s39, s30, 3
    s_mul_i32 s36, s33, 3670016
    s_mul_i32 s35, s33, 458752
    s_add_u32 s37, s35, 8192
    v_lshlrev_b32 v204, 4, v192
    v_lshrrev_b32 v200, 4, v192
    v_lshlrev_b32 v201, 1, v200
    v_and_b32 v202, 15, v192
    v_xor_b32 v202, v202, v201
    v_lshlrev_b32 v202, 4, v202
    s_lshl_b32 s26, s30, 4
    v_add_u32 v200, s26, v200
    v_lshlrev_b32 v200, 11, v200
    s_lshl_b32 s26, s32, 8
    v_add3_u32 v196, v200, v202, s26
    v_xor_b32 v201, 128, v196
    v_add_u32 v197, 7168, v196
    v_add_u32 v198, 14336, v201
    v_add_u32 v199, 21504, v201
    s_lshl_b32 s34, s30, 12
    s_mul_i32 s26, s31, 917504
    s_lshl_b32 s27, s39, 10
    s_add_u32 s26, s26, s27
    s_lshl_b32 s27, s33, 12
    s_add_u32 s26, s26, s27
    s_lshl_b32 s27, s38, 14
    s_add_u32 s26, s26, s27
    v_add_u32 v223, s26, v204
    v_xor_b32 v224, 0x1000, v223
    v_min_u32 v200, 31, v192
    v_lshlrev_b32 v200, 7, v200
    v_add_u32 v195, 491520, v200
    s_add_u32 s84, s24, 0x4000000
    s_addc_u32 s85, s25, 0
    s_and_b32 s85, s85, 0xffff
    s_mov_b32 s86, 0x400000
    s_mov_b32 s87, 0x20000
    s_mov_b32 s82, 1
    s_cmp_ge_u32 s30, 1
    s_cbranch_scc1 kf_z0_72
    global_load_dwordx2 v[200:201], v195, s[96:97] sc1
    s_mov_b32 s82, 0
kf_z0_72:
    s_waitcnt lgkmcnt(0)
    s_mov_b32 s12, s4
    s_mov_b32 s13, s5
    s_and_b32 s13, s13, 0xffff
    s_mov_b32 s14, 0x700000
    s_mov_b32 s15, 0x20000
    s_add_u32 m0, s34, 0
    s_nop 0
    buffer_load_dwordx4 v196, s[12:15], s36 offen offset:0  lds
    buffer_load_dwordx4 v197, s[12:15], s36 offen offset:1024  lds
    buffer_load_dwordx4 v198, s[12:15], s36 offen offset:2048  lds
    buffer_load_dwordx4 v199, s[12:15], s36 offen offset:3072  lds
    s_add_u32 s36, s36, 262144
    s_branch ka_p2_30
ka_code_end:
.section .rodata,"a"
.p2align 6
.amdhsa_kernel parallel_sum__spectral_gfnet__glu_gated_geglu__prompt_kernel
  .amdhsa_next_free_vgpr 256
  .amdhsa_next_free_sgpr 102
  .amdhsa_accum_offset 256
  .amdhsa_group_segment_fixed_size 0
  .amdhsa_kernarg_size 80
  .amdhsa_user_sgpr_count 2
  .amdhsa_user_sgpr_kernarg_segment_ptr 1
  .amdhsa_system_sgpr_workgroup_id_x 1
  .amdhsa_float_denorm_mode_32 3
  .amdhsa_float_denorm_mode_16_64 3
.end_amdhsa_kernel
```
